```python
import torch

def _softmax(x, axis=-1):
    return torch.softmax(x, dim=axis)
def _gelu(x):
    return torch.nn.functional.gelu(x, approximate="tanh")
def _silu(x):
    return torch.nn.functional.silu(x)
def _sigmoid(x):
    return torch.sigmoid(x)
def _layernorm(x, axis=-1, eps=1e-5):
    m = x.mean(dim=axis, keepdim=True)
    v = x.var(dim=axis, keepdim=True, unbiased=False)
    return (x - m) / torch.sqrt(v + eps)
def _scatter_add(tgt, idx, src, axis=0):
    return tgt.clone().index_add_(axis, idx, src)
def _segment_sum(src, seg, n):
    out = torch.zeros((n,) + src.shape[1:], dtype=src.dtype)
    return out.index_add_(0, seg, src)
def _pad(x, pw):
    flat = tuple(v for pair in reversed(pw) for v in pair)
    return torch.nn.functional.pad(x, flat)

kernel_name = 'interleave_layers__grouped_kv_mqa__glu_gated_bilinear__prompt'

def setup_inputs():

    _w = (lambda a: (lambda t: t.to(torch.bfloat16) if t.is_floating_point() else t)(torch.as_tensor(a)))
    def _A_setup():
        B, S, D, H = 1, 2048, 512, 32
        Dh = D // H
        return {
            "x": _w((lambda *s: torch.randn(*s, dtype=torch.bfloat16) * 0.05)(B, S, D)),
            "wq": _w((lambda *s: torch.randn(*s, dtype=torch.bfloat16) * 0.05)(D, H * Dh)),
            "wk": _w((lambda *s: torch.randn(*s, dtype=torch.bfloat16) * 0.05)(D, Dh)),
            "wv": _w((lambda *s: torch.randn(*s, dtype=torch.bfloat16) * 0.05)(D, Dh)),
            "wo": _w((lambda *s: torch.randn(*s, dtype=torch.bfloat16) * 0.05)(H * Dh, D)),
        }
    _A_in = _A_setup()

    def _B_setup():
        B, S, D, F = 1, 2048, 512, 1792
        return {
            "x": _w((lambda *s: torch.randn(*s, dtype=torch.bfloat16) * 0.05)(B, S, D)),
            "w_gate": _w((lambda *s: torch.randn(*s, dtype=torch.bfloat16) * 0.4)(D, F) * (D ** -0.5)),
            "w_up": _w((lambda *s: torch.randn(*s, dtype=torch.bfloat16) * 0.4)(D, F) * (D ** -0.5)),
            "w_down": _w((lambda *s: torch.randn(*s, dtype=torch.bfloat16) * 0.4)(F, D) * (F ** -0.5)),
        }
    _B_in = _B_setup()

    return {
        "A_x": _A_in["x"],
        "A_wq": _A_in["wq"],
        "A_wk": _A_in["wk"],
        "A_wv": _A_in["wv"],
        "A_wo": _A_in["wo"],
        "B_x": _B_in["x"],
        "B_w_gate": _B_in["w_gate"],
        "B_w_up": _B_in["w_up"],
        "B_w_down": _B_in["w_down"],
    }

def reference(A_x, A_wq, A_wk, A_wv, A_wo, B_x, B_w_gate, B_w_up, B_w_down):
    def _A_ref(x, wq, wk, wv, wo):
        B, S, D = x.shape
        H = 32
        Dh = D // H
        q = (lambda x, *d: x.permute(*d))((x @ wq).reshape(B, S, H, Dh), 0, 2, 1, 3)
        k = x @ wk
        v = x @ wv
        scores = torch.einsum("bhqd,bkd->bhqk", q, k) * (Dh ** -0.5)
        p = _softmax(scores, axis=-1)
        o = torch.einsum("bhqk,bkd->bhqd", p, v)
        return (lambda x, *d: x.permute(*d))(o, 0, 2, 1, 3).reshape(B, S, H * Dh) @ wo

    def _B_ref(x, w_gate, w_up, w_down):
        g = torch.einsum("bsd,df->bsf", x, w_gate)
        u = torch.einsum("bsd,df->bsf", x, w_up)
        h = g * u
        return torch.einsum("bsf,fd->bsd", h, w_down)

    x = A_x
    x = x + _A_ref(_layernorm(x, axis=-1), A_wq, A_wk, A_wv, A_wo)
    x = x + _B_ref(_layernorm(x, axis=-1), B_w_gate, B_w_up, B_w_down)
    x = x + _A_ref(_layernorm(x, axis=-1), A_wq, A_wk, A_wv, A_wo)
    x = x + _B_ref(_layernorm(x, axis=-1), B_w_gate, B_w_up, B_w_down)
    return x
```

```asm
; @launch grid=(256,1,1) block=(512,1,1) lds=163840
.amdgcn_target "amdgcn-amd-amdhsa--gfx950"
.text
.p2align 8
.globl interleave_layers__grouped_kv_mqa__glu_gated_bilinear__prompt_kernel
.type interleave_layers__grouped_kv_mqa__glu_gated_bilinear__prompt_kernel,@function
interleave_layers__grouped_kv_mqa__glu_gated_bilinear__prompt_kernel:
    s_cmp_ge_u32 s2, 256
    s_cbranch_scc1 k_end
    s_load_dwordx2 s[12:13], s[0:1], 0
    s_load_dwordx2 s[16:17], s[0:1], 8
    s_load_dwordx2 s[52:53], s[0:1], 16
    s_load_dwordx2 s[56:57], s[0:1], 24
    s_load_dwordx2 s[4:5], s[0:1], 80
    s_mov_b32 s14, 2097152
    s_mov_b32 s15, 0x20000
    s_mov_b32 s18, 524288
    s_mov_b32 s19, 0x20000
    s_mov_b32 s54, 16384
    s_mov_b32 s55, 0x20000
    s_mov_b32 s58, 16384
    s_mov_b32 s59, 0x20000
    s_mov_b32 s6, 256
    s_mov_b32 s7, 0x20000
    s_cmp_ge_u32 s2, 256
    s_cbranch_scc1 k_end
    s_load_dwordx2 s[8:9], s[0:1], 88
    s_mov_b32 s10, 268435456
    s_mov_b32 s11, 0x20000
    v_and_b32 v1, 63, v0
    v_lshrrev_b32 v2, 6, v0
    v_lshlrev_b32 v3, 4, v1
    v_readfirstlane_b32 s20, v2
    s_and_b32 s21, s2, 7
    s_lshl_b32 s21, s21, 1
    s_bfe_u32 s22, s2, 0x10003
    s_add_u32 s21, s21, s22
    s_lshr_b32 s22, s2, 4
    s_and_b32 s23, s22, 1
    s_lshr_b32 s24, s22, 1
    s_and_b32 s25, s20, 3
    s_lshr_b32 s26, s20, 2
    s_lshl_b32 s27, s21, 2
    s_add_u32 s27, s27, s23
    s_lshl_b32 s28, s24, 1
    s_bfe_u32 s30, s20, 0x10001
    s_add_u32 s28, s28, s30
    s_and_b32 s29, s20, 1
    s_lshl_b32 s30, s29, 1
    s_add_u32 s30, s30, s27
    s_lshl_b32 s49, s30, 15
    s_lshl_b32 s31, s28, 11
    s_add_u32 s49, s49, s31
    s_lshl_b32 s31, s26, 10
    s_add_u32 s49, s49, s31
    s_mov_b32 s41, 4096
    s_mov_b32 s42, 8192
    s_mov_b32 s43, 12288
    s_mov_b32 s44, 16384
    s_mov_b32 s45, 20480
    s_mov_b32 s46, 24576
    s_mov_b32 s47, 28672
    s_waitcnt lgkmcnt(0)
    s_add_u32 s30, s21, 1
    s_and_b32 s30, s30, 3
    s_lshl_b32 s30, s30, 2
    s_xor_b32 s30, s30, s22
    s_add_u32 s30, s30, s20
    s_cmp_lg_u32 s30, 0
    s_cbranch_scc1 pr_z0
    v_mov_b32 v8, 0
    v_mov_b32 v9, 0
    v_mov_b32 v10, 0
    v_mov_b32 v11, 0
    v_lshrrev_b32 v4, 4, v1
    v_and_b32 v5, 15, v1
    v_lshlrev_b32 v5, 4, v5
    v_lshl_add_u32 v4, v4, 12, v5
    s_lshl_b32 s30, s21, 8
    s_add_u32 s30, s30, 24731648
    buffer_store_dwordx4 v[8:11], v4, s[8:11], s30 offen sc0 sc1
    s_add_u32 s30, s30, 16384
    buffer_store_dwordx4 v[8:11], v4, s[8:11], s30 offen sc0 sc1
    s_add_u32 s30, s30, 16384
    buffer_store_dwordx4 v[8:11], v4, s[8:11], s30 offen sc0 sc1
    s_add_u32 s30, s30, 16384
    v_lshlrev_b32 v4, 7, v1
    s_mul_i32 s30, s21, 8192
    s_add_u32 s30, s30, 26501120
    buffer_store_dwordx4 v[8:11], v4, s[8:11], s30 offen sc0 sc1
    v_mov_b32 v5, 1
    s_mov_b64 exec, 1
    s_waitcnt vmcnt(0)
    buffer_atomic_add v5, v8, s[4:7], 0 offen sc1
    s_mov_b64 exec, -1
    s_nop 1
pr_z0:
    s_mov_b64 s[36:37], s[16:17]
    s_mov_b32 s38, 524288
    s_mov_b32 s39, 0x20000
    s_and_b32 s18, s22, 3
    s_lshl_b32 s30, s21, 2
    s_add_u32 s18, s18, s30
    s_and_b32 s30, s22, 12
    s_add_u32 s30, s30, s25
    s_lshl_b32 s30, s30, 1
    s_add_u32 s30, s30, s26
    s_lshl_b32 s19, s18, 5
    s_add_u32 s19, s19, s30
    s_lshl_b32 s19, s19, 10
    s_lshr_b32 s3, s22, 2
    s_and_b32 s30, s21, 3
    s_xor_b32 s3, s3, s30
    s_lshl_b32 s30, s20, 11
    s_cmp_lg_u32 s3, 0
    s_cbranch_scc1 pr_k0
    buffer_load_dwordx4 v[240:243], v3, s[52:55], s30 offen offset:0
    buffer_load_dwordx4 v[244:247], v3, s[52:55], s30 offen offset:1024
    buffer_load_dwordx4 v[248:251], v3, s[56:59], s30 offen offset:0
    buffer_load_dwordx4 v[252:255], v3, s[56:59], s30 offen offset:1024
pr_k0:
    v_lshrrev_b32 v4, 3, v1
    v_and_b32 v5, 7, v1
    v_lshrrev_b32 v6, 4, v1
    v_xor_b32 v6, v6, v5
    v_lshlrev_b32 v7, 10, v4
    v_lshl_add_u32 v8, v6, 4, v7
    v_xor_b32 v9, 64, v8
    s_lshl_b32 s30, s18, 15
    s_lshl_b32 s31, s20, 7
    s_add_u32 s30, s30, s31
    s_lshl_b32 s32, s20, 12
    s_add_u32 m0, s32, 0
    s_nop 0
    buffer_load_dwordx4 v8, s[12:15], s30 offen lds
    s_add_u32 s30, s30, 8192
    s_add_u32 m0, s32, 1024
    s_nop 0
    buffer_load_dwordx4 v9, s[12:15], s30 offen lds
    s_add_u32 s30, s30, 8192
    s_add_u32 m0, s32, 2048
    s_nop 0
    buffer_load_dwordx4 v8, s[12:15], s30 offen lds
    s_add_u32 s30, s30, 8192
    s_add_u32 m0, s32, 3072
    s_nop 0
    buffer_load_dwordx4 v9, s[12:15], s30 offen lds
    s_add_u32 s30, s30, 8192
    v_lshrrev_b32 v4, 2, v1
    v_and_b32 v5, 3, v1
    v_lshlrev_b32 v10, 10, v4
    v_lshl_add_u32 v10, v5, 4, v10
    s_lshl_b32 s31, s26, 18
    s_bfe_u32 s30, s19, 0x4000b
    s_lshl_b32 s30, s30, 6
    s_add_u32 s31, s31, s30
    s_lshl_b32 s51, s20, 13
    s_add_u32 s51, s51, 98304
    s_mov_b32 s50, s31
    v_mov_b32 v88, v10
    s_and_b32 s33, s22, 3
    s_lshl_b32 s33, s33, 16
    s_cmp_eq_u32 s3, 0
    s_cbranch_scc1 pr_w1
    s_barrier
    s_xor_b32 s30, s33, 0
    s_add_u32 s30, s30, s50
    s_add_u32 m0, s51, 0
    s_nop 0
    buffer_load_dwordx4 v88, s[36:39], s30 offen lds
    s_xor_b32 s30, s33, 16384
    s_add_u32 s30, s30, s50
    s_add_u32 m0, s51, 1024
    s_nop 0
    buffer_load_dwordx4 v88, s[36:39], s30 offen lds
    s_xor_b32 s30, s33, 65536
    s_add_u32 s30, s30, s50
    s_add_u32 m0, s51, 2048
    s_nop 0
    buffer_load_dwordx4 v88, s[36:39], s30 offen lds
    s_xor_b32 s30, s33, 81920
    s_add_u32 s30, s30, s50
    s_add_u32 m0, s51, 3072
    s_nop 0
    buffer_load_dwordx4 v88, s[36:39], s30 offen lds
    s_xor_b32 s30, s33, 131072
    s_add_u32 s30, s30, s50
    s_add_u32 m0, s51, 4096
    s_nop 0
    buffer_load_dwordx4 v88, s[36:39], s30 offen lds
    s_xor_b32 s30, s33, 147456
    s_add_u32 s30, s30, s50
    s_add_u32 m0, s51, 5120
    s_nop 0
    buffer_load_dwordx4 v88, s[36:39], s30 offen lds
    s_xor_b32 s30, s33, 196608
    s_add_u32 s30, s30, s50
    s_add_u32 m0, s51, 6144
    s_nop 0
    buffer_load_dwordx4 v88, s[36:39], s30 offen lds
    s_xor_b32 s30, s33, 212992
    s_add_u32 s30, s30, s50
    s_add_u32 m0, s51, 7168
    s_nop 0
    buffer_load_dwordx4 v88, s[36:39], s30 offen lds
    s_xor_b32 s30, s33, 32768
    s_add_u32 s30, s30, s50
    buffer_load_dwordx4 v[160:163], v88, s[36:39], s30 offen
    s_xor_b32 s30, s33, 49152
    s_add_u32 s30, s30, s50
    buffer_load_dwordx4 v[164:167], v88, s[36:39], s30 offen
    s_xor_b32 s30, s33, 98304
    s_add_u32 s30, s30, s50
    buffer_load_dwordx4 v[168:171], v88, s[36:39], s30 offen
    s_xor_b32 s30, s33, 114688
    s_add_u32 s30, s30, s50
    buffer_load_dwordx4 v[172:175], v88, s[36:39], s30 offen
    s_xor_b32 s30, s33, 163840
    s_add_u32 s30, s30, s50
    buffer_load_dwordx4 v[176:179], v88, s[36:39], s30 offen
    s_xor_b32 s30, s33, 180224
    s_add_u32 s30, s30, s50
    buffer_load_dwordx4 v[180:183], v88, s[36:39], s30 offen
    s_xor_b32 s30, s33, 229376
    s_add_u32 s30, s30, s50
    buffer_load_dwordx4 v[184:187], v88, s[36:39], s30 offen
    s_xor_b32 s30, s33, 245760
    s_add_u32 s30, s30, s50
    buffer_load_dwordx4 v[188:191], v88, s[36:39], s30 offen
    s_waitcnt vmcnt(16)
pr_w1:
    v_and_b32 v64, 31, v1
    v_lshrrev_b32 v65, 5, v1
    v_lshlrev_b32 v66, 7, v64
    v_lshl_add_u32 v66, v65, 3, v66
    v_bfe_u32 v67, v1, 1, 3
    v_lshl_add_u32 v66, v67, 4, v66
    s_add_u32 s30, s32, 0
    v_add_u32 v66, s30, v66
    v_bfe_u32 v67, v1, 2, 2
    v_lshl_add_u32 v67, v65, 2, v67
    v_lshlrev_b32 v68, 3, v5
    v_bfe_u32 v69, v1, 4, 1
    v_lshl_add_u32 v70, v67, 5, v68
    v_lshl_add_u32 v70, v69, 11, v70
    v_add_u32 v70, s51, v70
    v_lshl_add_u32 v71, v67, 6, v68
    v_lshl_add_u32 v71, v69, 5, v71
    s_lshl_b32 s30, s26, 5
    v_xor_b32 v71, s30, v71
    v_add_u32 v71, s51, v71
    v_add_u32 v72, s51, v3
    v_mov_b32 v73, 0x3f803f80
    v_lshlrev_b32 v74, 2, v64
    s_lshl_b32 s30, s20, 7
    s_add_u32 s31, s30, 79872
    v_add_u32 v75, s31, v74
    s_lshl_b32 s31, s26, 6
    v_xor_b32 v74, s31, v74
    s_add_u32 s30, s30, 78848
    v_add_u32 v74, s30, v74
    v_lshlrev_b32 v76, 4, v65
    s_add_u32 s30, s30, s31
    v_add_u32 v77, s30, v76
    v_xor_b32 v78, 512, v77
    s_lshl_b32 s30, s25, 5
    s_add_u32 s30, s30, 79872
    v_add_u32 v79, s30, v76
    s_lshl_b32 s30, s18, 15
    s_lshl_b32 s48, s20, 12
    s_add_u32 s30, s30, s48
    s_add_u32 s30, s30, 6758400
    v_add_u32 v5, s30, v3
    s_lshl_b32 s30, s26, 14
    s_add_u32 s30, s30, 36864
    v_add_u32 v6, s30, v3
    v_add_u32 v14, s48, v3
    s_add_u32 s48, s48, 36864
    s_lshl_b32 s30, s20, 11
    s_add_u32 s30, s30, 81920
    v_add_u32 v8, s30, v3
    v_xor_b32 v7, 0x2000, v8
    v_lshrrev_b32 v2, 5, v1
    v_and_b32 v9, 31, v1
    v_lshlrev_b32 v9, 3, v9
    v_add_u32 v11, 69632, v9
    s_lshl_b32 s30, s20, 8
    v_add_u32 v10, s30, v11
    v_lshl_add_u32 v9, v2, 9, v9
    s_lshl_b32 s30, s18, 13
    s_lshl_b32 s31, s20, 10
    s_add_u32 s30, s30, s31
    s_add_u32 s30, s30, 0
    v_add_u32 v9, s30, v9
    v_add_u32 v12, s48, v3
    s_lshl_b32 s30, s25, 10
    s_add_u32 s30, s30, 0
    v_add_u32 v13, s30, v3
    v_bfe_u32 v15, v1, 4, 1
    v_lshlrev_b32 v15, 9, v15
    v_bfe_u32 v4, v1, 2, 1
    v_lshl_add_u32 v15, v4, 8, v15
    v_and_b32 v4, 3, v1
    v_lshl_add_u32 v15, v4, 1, v15
    v_bfe_u32 v4, v1, 3, 1
    v_lshl_add_u32 v15, v4, 3, v15
    v_lshl_add_u32 v15, v2, 6, v15
    s_lshr_b32 s30, s33, 4
    s_lshl_b32 s31, s20, 12
    s_xor_b32 s30, s30, s31
    s_add_u32 s30, s30, 36864
    v_add_u32 v12, s30, v3
    v_mov_b32 v0, 0
    v_mov_b32 v4, 1
    v_xor_b32 v80, 0, v66
    v_xor_b32 v81, 16, v66
    v_xor_b32 v82, 32, v66
    v_xor_b32 v83, 48, v66
    v_xor_b32 v84, 64, v66
    v_xor_b32 v85, 80, v66
    v_xor_b32 v86, 96, v66
    v_xor_b32 v87, 112, v66
    s_add_u32 s35, s3, s26
    s_cmp_lg_u32 s3, 0
    s_cbranch_scc1 pr_w2
    s_waitcnt vmcnt(4)
    ds_write_b128 v72, v[240:243] offset:0
    ds_write_b128 v72, v[244:247] offset:1024
    ds_write_b128 v72, v[248:251] offset:2048
    ds_write_b128 v72, v[252:255] offset:3072
    ds_read_b64_tr_b16 v[192:193], v70 offset:0
    ds_read_b64_tr_b16 v[194:195], v70 offset:256
    ds_read_b64_tr_b16 v[196:197], v70 offset:512
    ds_read_b64_tr_b16 v[198:199], v70 offset:768
    ds_read_b64_tr_b16 v[200:201], v70 offset:1024
    ds_read_b64_tr_b16 v[202:203], v70 offset:1280
    ds_read_b64_tr_b16 v[204:205], v70 offset:1536
    ds_read_b64_tr_b16 v[206:207], v70 offset:1792
    s_waitcnt lgkmcnt(0)
    v_dot2_f32_bf16 v90, v192, v73, 0
    v_dot2_f32_bf16 v91, v193, v73, 0
    v_dot2_f32_bf16 v90, v194, v73, v90
    v_dot2_f32_bf16 v91, v195, v73, v91
    v_dot2_f32_bf16 v90, v196, v73, v90
    v_dot2_f32_bf16 v91, v197, v73, v91
    v_dot2_f32_bf16 v90, v198, v73, v90
    v_dot2_f32_bf16 v91, v199, v73, v91
    v_dot2_f32_bf16 v90, v200, v73, v90
    v_dot2_f32_bf16 v91, v201, v73, v91
    v_dot2_f32_bf16 v90, v202, v73, v90
    v_dot2_f32_bf16 v91, v203, v73, v91
    v_dot2_f32_bf16 v90, v204, v73, v90
    v_dot2_f32_bf16 v91, v205, v73, v91
    v_dot2_f32_bf16 v90, v206, v73, v90
    v_dot2_f32_bf16 v91, v207, v73, v91
    s_nop 2
    v_add_f32 v90, v90, v91
    v_mov_b32 v91, v90
    s_nop 1
    v_permlane32_swap_b32 v90, v91
    v_add_f32 v90, v90, v91
    ds_write_b32 v75, v90
    s_waitcnt vmcnt(0)
pr_w2:
    ds_read_b64 v[224:225], v80
    ds_read_b64 v[226:227], v81
    ds_read_b64 v[228:229], v82
    ds_read_b64 v[230:231], v83
    ds_read_b64 v[232:233], v84
    ds_read_b64 v[234:235], v85
    ds_read_b64 v[236:237], v86
    ds_read_b64 v[238:239], v87
    buffer_load_dword v89, v0, s[4:7], 0 offen sc1
    s_waitcnt lgkmcnt(0)
    s_cmp_lg_u32 s3, 0
    s_cbranch_scc1 pr_k41
    v_mfma_f32_32x32x16_bf16 v[208:223], v[192:195], v[224:227], 0
    v_mfma_f32_32x32x16_bf16 v[208:223], v[196:199], v[228:231], v[208:223]
    v_mfma_f32_32x32x16_bf16 v[208:223], v[200:203], v[232:235], v[208:223]
    v_mfma_f32_32x32x16_bf16 v[208:223], v[204:207], v[236:239], v[208:223]
pr_k41:
    ds_write_b128 v12, v[224:227] offset:0
    ds_write_b128 v12, v[228:231] offset:1024
    ds_write_b128 v12, v[232:235] offset:2048
    ds_write_b128 v12, v[236:239] offset:3072
    v_dot2_f32_bf16 v108, v224, v73, 0
    v_dot2_f32_bf16 v109, v224, v224, 0
    v_dot2_f32_bf16 v110, v225, v73, 0
    v_dot2_f32_bf16 v111, v225, v225, 0
    v_dot2_f32_bf16 v108, v226, v73, v108
    v_dot2_f32_bf16 v109, v226, v226, v109
    v_dot2_f32_bf16 v110, v227, v73, v110
    v_dot2_f32_bf16 v111, v227, v227, v111
    v_dot2_f32_bf16 v108, v228, v73, v108
    v_dot2_f32_bf16 v109, v228, v228, v109
    v_dot2_f32_bf16 v110, v229, v73, v110
    v_dot2_f32_bf16 v111, v229, v229, v111
    v_dot2_f32_bf16 v108, v230, v73, v108
    v_dot2_f32_bf16 v109, v230, v230, v109
    v_dot2_f32_bf16 v110, v231, v73, v110
    v_dot2_f32_bf16 v111, v231, v231, v111
    v_dot2_f32_bf16 v108, v232, v73, v108
    v_dot2_f32_bf16 v109, v232, v232, v109
    v_dot2_f32_bf16 v110, v233, v73, v110
    v_dot2_f32_bf16 v111, v233, v233, v111
    v_dot2_f32_bf16 v108, v234, v73, v108
    v_dot2_f32_bf16 v109, v234, v234, v109
    v_dot2_f32_bf16 v110, v235, v73, v110
    v_dot2_f32_bf16 v111, v235, v235, v111
    v_dot2_f32_bf16 v108, v236, v73, v108
    v_dot2_f32_bf16 v109, v236, v236, v109
    v_dot2_f32_bf16 v110, v237, v73, v110
    v_dot2_f32_bf16 v111, v237, v237, v111
    v_dot2_f32_bf16 v108, v238, v73, v108
    v_dot2_f32_bf16 v109, v238, v238, v109
    v_dot2_f32_bf16 v110, v239, v73, v110
    v_dot2_f32_bf16 v111, v239, v239, v111
    s_nop 2
    v_add_f32 v108, v108, v110
    v_add_f32 v109, v109, v111
    v_mov_b32 v110, v108
    v_mov_b32 v111, v109
    s_nop 1
    v_permlane32_swap_b32 v108, v110
    v_add_f32 v108, v108, v110
    v_permlane32_swap_b32 v109, v111
    v_add_f32 v109, v109, v111
    ds_write_b64 v10, v[108:109]
    v_mov_b32 v110, 0
    v_mov_b32 v9, 77824
    ds_write_b32 v9, v110
    s_cmp_lg_u32 s3, 0
    s_cbranch_scc1 pr_k52
    ds_write_b128 v14, v[208:211] offset:0
    ds_write_b128 v14, v[212:215] offset:1024
    ds_write_b128 v14, v[216:219] offset:2048
    ds_write_b128 v14, v[220:223] offset:3072
pr_k52:
    s_waitcnt lgkmcnt(0)
    s_barrier
    ds_read_b64 v[108:109], v11 offset:0
    ds_read_b64 v[110:111], v11 offset:256
    ds_read_b64 v[112:113], v11 offset:512
    ds_read_b64 v[114:115], v11 offset:768
    ds_read_b64 v[116:117], v11 offset:1024
    ds_read_b64 v[118:119], v11 offset:1280
    ds_read_b64 v[120:121], v11 offset:1536
    ds_read_b64 v[122:123], v11 offset:1792
    s_cmp_lg_u32 s35, 0
    s_cbranch_scc1 pr_e64
    s_setprio 3
    s_waitcnt lgkmcnt(4)
    ds_read_b128 v[224:227], v13 offset:0
    ds_read_b128 v[228:231], v13 offset:4096
    ds_read_b128 v[232:235], v13 offset:8192
    ds_read_b128 v[236:239], v13 offset:12288
    ds_read_b128 v[240:243], v13 offset:16384
    ds_read_b128 v[244:247], v13 offset:20480
    ds_read_b128 v[248:251], v13 offset:24576
    ds_read_b128 v[252:255], v13 offset:28672
    s_waitcnt lgkmcnt(8)
    v_mov_b32 v208, v108
    v_mov_b32 v209, v109
    v_mov_b32 v210, v110
    v_mov_b32 v211, v111
    v_mov_b32 v212, v112
    v_mov_b32 v213, v113
    v_mov_b32 v214, v114
    v_mov_b32 v215, v115
    v_mov_b32 v216, v116
    v_mov_b32 v217, v117
    v_mov_b32 v218, v118
    v_mov_b32 v219, v119
    v_mov_b32 v220, v120
    v_mov_b32 v221, v121
    v_mov_b32 v222, v122
    v_mov_b32 v223, v123
    v_add_f32 v208, v208, v216
    v_add_f32 v209, v209, v217
    v_add_f32 v210, v210, v218
    v_add_f32 v211, v211, v219
    v_add_f32 v212, v212, v220
    v_add_f32 v213, v213, v221
    v_add_f32 v214, v214, v222
    v_add_f32 v215, v215, v223
    v_add_f32 v208, v208, v212
    v_add_f32 v209, v209, v213
    v_add_f32 v210, v210, v214
    v_add_f32 v211, v211, v215
    v_add_f32 v208, v208, v210
    v_add_f32 v209, v209, v211
    v_mul_f32 v208, 0x3b000000, v208
    v_mul_f32 v209, 0x3b000000, v209
    v_fma_f32 v209, -v208, v208, v209
    v_max_f32 v209, 0, v209
    v_add_f32 v209, 0x3727c5ac, v209
    v_rsq_f32 v209, v209
    s_lshl_b32 s30, s18, 11
    s_add_u32 s30, s30, 6610944
    s_waitcnt lgkmcnt(0)
    ds_read_b128 v[32:35], v79 offset:0
    ds_read_b128 v[36:39], v79 offset:128
    ds_read_b128 v[40:43], v79 offset:256
    ds_read_b128 v[44:47], v79 offset:384
    ds_read_b128 v[48:51], v79 offset:512
    ds_read_b128 v[52:55], v79 offset:640
    ds_read_b128 v[56:59], v79 offset:768
    ds_read_b128 v[60:63], v79 offset:896
    v_add_f32 v224, v224, v240
    v_add_f32 v225, v225, v241
    v_add_f32 v226, v226, v242
    v_add_f32 v227, v227, v243
    v_add_f32 v228, v228, v244
    v_add_f32 v229, v229, v245
    v_add_f32 v230, v230, v246
    v_add_f32 v231, v231, v247
    v_add_f32 v232, v232, v248
    v_add_f32 v233, v233, v249
    v_add_f32 v234, v234, v250
    v_add_f32 v235, v235, v251
    v_add_f32 v236, v236, v252
    v_add_f32 v237, v237, v253
    v_add_f32 v238, v238, v254
    v_add_f32 v239, v239, v255
    v_add_f32 v224, v224, v232
    v_add_f32 v225, v225, v233
    v_add_f32 v226, v226, v234
    v_add_f32 v227, v227, v235
    v_add_f32 v228, v228, v236
    v_add_f32 v229, v229, v237
    v_add_f32 v230, v230, v238
    v_add_f32 v231, v231, v239
    v_add_f32 v224, v224, v228
    v_add_f32 v225, v225, v229
    v_add_f32 v226, v226, v230
    v_add_f32 v227, v227, v231
    s_waitcnt lgkmcnt(0)
    v_add_f32 v32, v32, v48
    v_add_f32 v33, v33, v49
    v_add_f32 v34, v34, v50
    v_add_f32 v35, v35, v51
    v_add_f32 v36, v36, v52
    v_add_f32 v37, v37, v53
    v_add_f32 v38, v38, v54
    v_add_f32 v39, v39, v55
    v_add_f32 v40, v40, v56
    v_add_f32 v41, v41, v57
    v_add_f32 v42, v42, v58
    v_add_f32 v43, v43, v59
    v_add_f32 v44, v44, v60
    v_add_f32 v45, v45, v61
    v_add_f32 v46, v46, v62
    v_add_f32 v47, v47, v63
    v_add_f32 v32, v32, v40
    v_add_f32 v33, v33, v41
    v_add_f32 v34, v34, v42
    v_add_f32 v35, v35, v43
    v_add_f32 v36, v36, v44
    v_add_f32 v37, v37, v45
    v_add_f32 v38, v38, v46
    v_add_f32 v39, v39, v47
    v_add_f32 v104, v32, v36
    v_add_f32 v105, v33, v37
    v_add_f32 v106, v34, v38
    v_add_f32 v107, v35, v39
    v_fma_f32 v224, -v208, v104, v224
    v_fma_f32 v225, -v208, v105, v225
    v_fma_f32 v226, -v208, v106, v226
    v_fma_f32 v227, -v208, v107, v227
    v_mul_f32 v224, v209, v224
    v_mul_f32 v225, v209, v225
    v_mul_f32 v226, v209, v226
    v_mul_f32 v227, v209, v227
    v_cvt_pk_bf16_f32 v232, v224, v225
    v_cvt_pk_bf16_f32 v233, v226, v227
    s_cmp_ge_u32 s20, 2
    s_cbranch_scc1 pr_v63
    s_lshl_b32 s31, s20, 3
    s_add_u32 s31, s31, s30
    buffer_store_dwordx2 v[232:233], v3, s[8:11], s31 offen sc0 sc1
    s_branch pr_f65
pr_v63:
    s_lshl_b32 s31, s29, 10
    s_add_u32 s31, s31, 73728
    v_add_u32 v15, s31, v15
    ds_write_b16 v15, v232 offset:0
    ds_write_b16_d16_hi v15, v232 offset:16
    ds_write_b16 v15, v233 offset:32
    ds_write_b16_d16_hi v15, v233 offset:48
    v_lshrrev_b32 v2, 3, v1
    v_lshlrev_b32 v2, 8, v2
    v_and_b32 v224, 7, v1
    v_lshl_add_u32 v2, v224, 4, v2
    v_add_u32 v15, s31, v2
    s_mov_b32 exec_hi, 0
    ds_read_b128 v[236:239], v15
    s_lshl_b32 s31, s29, 7
    s_add_u32 s31, s31, s30
    s_waitcnt lgkmcnt(0)
    buffer_store_dwordx4 v[236:239], v2, s[8:11], s31 offen offset:1024 sc0 sc1
    s_mov_b64 exec, -1
pr_f65:
    s_lshl_b32 s30, s18, 7
    s_add_u32 s30, s30, 26615808
    s_waitcnt vmcnt(0)
    v_cmp_le_u32 vcc, 16, v89
    s_cmp_eq_u64 vcc, -1
    s_cbranch_scc1 pr_zd8
    s_mov_b32 s31, 0
    s_mov_b64 exec, 1
pr_z7:
    buffer_load_dword v2, v0, s[4:7], 0 offen sc1
    s_waitcnt vmcnt(0)
    v_cmp_le_u32 vcc, 16, v2
    s_add_u32 s31, s31, 1
    s_cmp_eq_u64 vcc, 1
    s_cbranch_scc1 pr_zd8
    s_sleep 8
    s_cmp_lt_u32 s31, 1048576
    s_cbranch_scc1 pr_z7
    s_branch k_end
pr_zd8:
    s_mov_b64 exec, -1
    s_mov_b64 exec, 1
    s_waitcnt vmcnt(0)
    ds_add_rtn_u32 v2, v9, v4
    s_waitcnt lgkmcnt(0)
    v_cmp_eq_u32 vcc, 3, v2
    s_cbranch_vccz pr_g66
    buffer_store_dword v4, v0, s[8:11], s30 offen sc0 sc1
pr_g66:
    s_mov_b64 exec, -1
    s_setprio 0
pr_e64:
    s_waitcnt lgkmcnt(0)
    s_cmp_lg_u32 s3, 0
    s_cbranch_scc1 pr_w3
    s_xor_b32 s30, s33, 0
    s_add_u32 s30, s30, s50
    s_add_u32 m0, s51, 0
    s_nop 0
    buffer_load_dwordx4 v88, s[36:39], s30 offen lds
    s_xor_b32 s30, s33, 16384
    s_add_u32 s30, s30, s50
    s_add_u32 m0, s51, 1024
    s_nop 0
    buffer_load_dwordx4 v88, s[36:39], s30 offen lds
    s_xor_b32 s30, s33, 65536
    s_add_u32 s30, s30, s50
    s_add_u32 m0, s51, 2048
    s_nop 0
    buffer_load_dwordx4 v88, s[36:39], s30 offen lds
    s_xor_b32 s30, s33, 81920
    s_add_u32 s30, s30, s50
    s_add_u32 m0, s51, 3072
    s_nop 0
    buffer_load_dwordx4 v88, s[36:39], s30 offen lds
    s_xor_b32 s30, s33, 131072
    s_add_u32 s30, s30, s50
    s_add_u32 m0, s51, 4096
    s_nop 0
    buffer_load_dwordx4 v88, s[36:39], s30 offen lds
    s_xor_b32 s30, s33, 147456
    s_add_u32 s30, s30, s50
    s_add_u32 m0, s51, 5120
    s_nop 0
    buffer_load_dwordx4 v88, s[36:39], s30 offen lds
    s_xor_b32 s30, s33, 196608
    s_add_u32 s30, s30, s50
    s_add_u32 m0, s51, 6144
    s_nop 0
    buffer_load_dwordx4 v88, s[36:39], s30 offen lds
    s_xor_b32 s30, s33, 212992
    s_add_u32 s30, s30, s50
    s_add_u32 m0, s51, 7168
    s_nop 0
    buffer_load_dwordx4 v88, s[36:39], s30 offen lds
    s_xor_b32 s30, s33, 32768
    s_add_u32 s30, s30, s50
    buffer_load_dwordx4 v[160:163], v88, s[36:39], s30 offen
    s_xor_b32 s30, s33, 49152
    s_add_u32 s30, s30, s50
    buffer_load_dwordx4 v[164:167], v88, s[36:39], s30 offen
    s_xor_b32 s30, s33, 98304
    s_add_u32 s30, s30, s50
    buffer_load_dwordx4 v[168:171], v88, s[36:39], s30 offen
    s_xor_b32 s30, s33, 114688
    s_add_u32 s30, s30, s50
    buffer_load_dwordx4 v[172:175], v88, s[36:39], s30 offen
    s_xor_b32 s30, s33, 163840
    s_add_u32 s30, s30, s50
    buffer_load_dwordx4 v[176:179], v88, s[36:39], s30 offen
    s_xor_b32 s30, s33, 180224
    s_add_u32 s30, s30, s50
    buffer_load_dwordx4 v[180:183], v88, s[36:39], s30 offen
    s_xor_b32 s30, s33, 229376
    s_add_u32 s30, s30, s50
    buffer_load_dwordx4 v[184:187], v88, s[36:39], s30 offen
    s_xor_b32 s30, s33, 245760
    s_add_u32 s30, s30, s50
    buffer_load_dwordx4 v[188:191], v88, s[36:39], s30 offen
pr_w3:
    s_waitcnt vmcnt(0)
    v_cmp_le_u32 vcc, 16, v89
    s_cmp_eq_u64 vcc, -1
    s_cbranch_scc1 pr_zd10
    s_mov_b32 s31, 0
    s_mov_b64 exec, 1
pr_z9:
    buffer_load_dword v2, v0, s[4:7], 0 offen sc1
    s_waitcnt vmcnt(0)
    v_cmp_le_u32 vcc, 16, v2
    s_add_u32 s31, s31, 1
    s_cmp_eq_u64 vcc, 1
    s_cbranch_scc1 pr_zd10
    s_sleep 8
    s_cmp_lt_u32 s31, 1048576
    s_cbranch_scc1 pr_z9
    s_branch k_end
pr_zd10:
    s_mov_b64 exec, -1
    ds_read_b64_tr_b16 v[128:129], v71 offset:0
    ds_read_b64_tr_b16 v[130:131], v71 offset:512
    ds_read_b64_tr_b16 v[132:133], v71 offset:1024
    ds_read_b64_tr_b16 v[134:135], v71 offset:1536
    ds_read_b64_tr_b16 v[136:137], v71 offset:2048
    ds_read_b64_tr_b16 v[138:139], v71 offset:2560
    ds_read_b64_tr_b16 v[140:141], v71 offset:3072
    ds_read_b64_tr_b16 v[142:143], v71 offset:3584
    ds_read_b64_tr_b16 v[144:145], v71 offset:4096
    ds_read_b64_tr_b16 v[146:147], v71 offset:4608
    ds_read_b64_tr_b16 v[148:149], v71 offset:5120
    ds_read_b64_tr_b16 v[150:151], v71 offset:5632
    s_waitcnt lgkmcnt(6)
    ds_read_b64_tr_b16 v[152:153], v71 offset:6144
    ds_read_b64_tr_b16 v[154:155], v71 offset:6656
    ds_read_b64_tr_b16 v[156:157], v71 offset:7168
    ds_read_b64_tr_b16 v[158:159], v71 offset:7680
    v_add_f32 v108, v108, v116
    v_add_f32 v109, v109, v117
    v_add_f32 v110, v110, v118
    v_add_f32 v111, v111, v119
    v_add_f32 v112, v112, v120
    v_add_f32 v113, v113, v121
    v_add_f32 v114, v114, v122
    v_add_f32 v115, v115, v123
    v_add_f32 v108, v108, v112
    v_add_f32 v109, v109, v113
    v_add_f32 v110, v110, v114
    v_add_f32 v111, v111, v115
    v_add_f32 v108, v108, v110
    v_add_f32 v109, v109, v111
    v_mul_f32 v108, 0x3b000000, v108
    v_mul_f32 v109, 0x3b000000, v109
    v_fma_f32 v109, -v108, v108, v109
    v_max_f32 v109, 0, v109
    v_add_f32 v109, 0x3727c5ac, v109
    v_rsq_f32 v109, v109
    s_waitcnt lgkmcnt(0)
    ds_read_b128 v[32:35], v6 offset:0
    ds_read_b128 v[36:39], v6 offset:1024
    ds_read_b128 v[40:43], v6 offset:4096
    ds_read_b128 v[44:47], v6 offset:5120
    ds_write_b128 v72, v[160:163] offset:0
    ds_write_b128 v72, v[164:167] offset:1024
    ds_write_b128 v72, v[168:171] offset:2048
    ds_write_b128 v72, v[172:175] offset:3072
    ds_write_b128 v72, v[176:179] offset:4096
    ds_write_b128 v72, v[180:183] offset:5120
    ds_write_b128 v72, v[184:187] offset:6144
    ds_write_b128 v72, v[188:191] offset:7168
    v_dot2_f32_bf16 v80, v128, v73, 0
    v_dot2_f32_bf16 v81, v129, v73, 0
    v_dot2_f32_bf16 v82, v130, v73, 0
    v_dot2_f32_bf16 v83, v131, v73, 0
    v_dot2_f32_bf16 v80, v132, v73, v80
    v_dot2_f32_bf16 v81, v133, v73, v81
    v_dot2_f32_bf16 v82, v134, v73, v82
    v_dot2_f32_bf16 v83, v135, v73, v83
    v_dot2_f32_bf16 v80, v136, v73, v80
    v_dot2_f32_bf16 v81, v137, v73, v81
    v_dot2_f32_bf16 v82, v138, v73, v82
    v_dot2_f32_bf16 v83, v139, v73, v83
    v_dot2_f32_bf16 v80, v140, v73, v80
    v_dot2_f32_bf16 v81, v141, v73, v81
    v_dot2_f32_bf16 v82, v142, v73, v82
    v_dot2_f32_bf16 v83, v143, v73, v83
    v_dot2_f32_bf16 v80, v144, v73, v80
    v_dot2_f32_bf16 v81, v145, v73, v81
    v_dot2_f32_bf16 v82, v146, v73, v82
    v_dot2_f32_bf16 v83, v147, v73, v83
    v_dot2_f32_bf16 v80, v148, v73, v80
    v_dot2_f32_bf16 v81, v149, v73, v81
    v_dot2_f32_bf16 v82, v150, v73, v82
    v_dot2_f32_bf16 v83, v151, v73, v83
    v_dot2_f32_bf16 v80, v152, v73, v80
    v_dot2_f32_bf16 v81, v153, v73, v81
    v_dot2_f32_bf16 v82, v154, v73, v82
    v_dot2_f32_bf16 v83, v155, v73, v83
    v_dot2_f32_bf16 v80, v156, v73, v80
    v_dot2_f32_bf16 v81, v157, v73, v81
    v_dot2_f32_bf16 v82, v158, v73, v82
    v_dot2_f32_bf16 v83, v159, v73, v83
    s_waitcnt lgkmcnt(0)
    ds_read_b128 v[48:51], v6 offset:8192
    ds_read_b128 v[52:55], v6 offset:9216
    ds_read_b128 v[56:59], v6 offset:12288
    ds_read_b128 v[60:63], v6 offset:13312
    v_mfma_f32_32x32x16_bf16 v[16:31], v[128:131], v[32:35], 0
    ds_read_b64_tr_b16 v[160:161], v71 offset:0
    ds_read_b64_tr_b16 v[162:163], v71 offset:512
    v_mfma_f32_32x32x16_bf16 v[16:31], v[132:135], v[36:39], v[16:31]
    ds_read_b64_tr_b16 v[164:165], v71 offset:1024
    ds_read_b64_tr_b16 v[166:167], v71 offset:1536
    v_mfma_f32_32x32x16_bf16 v[16:31], v[136:139], v[40:43], v[16:31]
    ds_read_b64_tr_b16 v[168:169], v71 offset:2048
    ds_read_b64_tr_b16 v[170:171], v71 offset:2560
    v_mfma_f32_32x32x16_bf16 v[16:31], v[140:143], v[44:47], v[16:31]
    ds_read_b64_tr_b16 v[172:173], v71 offset:3072
    ds_read_b64_tr_b16 v[174:175], v71 offset:3584
    s_waitcnt lgkmcnt(8)
    v_mfma_f32_32x32x16_bf16 v[16:31], v[144:147], v[48:51], v[16:31]
    s_waitcnt lgkmcnt(9)
    ds_read_b64_tr_b16 v[176:177], v71 offset:4096
    ds_read_b64_tr_b16 v[178:179], v71 offset:4608
    ds_read_b128 v[32:35], v6 offset:2048
    v_mfma_f32_32x32x16_bf16 v[16:31], v[148:151], v[52:55], v[16:31]
    s_waitcnt lgkmcnt(9)
    ds_read_b64_tr_b16 v[180:181], v71 offset:5120
    ds_read_b64_tr_b16 v[182:183], v71 offset:5632
    ds_read_b128 v[36:39], v6 offset:3072
    v_mfma_f32_32x32x16_bf16 v[16:31], v[152:155], v[56:59], v[16:31]
    s_waitcnt lgkmcnt(9)
    ds_read_b64_tr_b16 v[184:185], v71 offset:6144
    ds_read_b64_tr_b16 v[186:187], v71 offset:6656
    ds_read_b128 v[40:43], v6 offset:6144
    v_mfma_f32_32x32x16_bf16 v[16:31], v[156:159], v[60:63], v[16:31]
    s_waitcnt lgkmcnt(9)
    ds_read_b64_tr_b16 v[188:189], v71 offset:7168
    ds_read_b64_tr_b16 v[190:191], v71 offset:7680
    ds_read_b128 v[44:47], v6 offset:7168
    s_waitcnt lgkmcnt(9)
    v_mfma_f32_32x32x16_bf16 v[16:31], v[160:163], v[32:35], v[16:31]
    ds_read_b128 v[48:51], v6 offset:10240
    s_waitcnt lgkmcnt(7)
    v_mfma_f32_32x32x16_bf16 v[16:31], v[164:167], v[36:39], v[16:31]
    ds_read_b128 v[52:55], v6 offset:11264
    s_waitcnt lgkmcnt(5)
    v_mfma_f32_32x32x16_bf16 v[16:31], v[168:171], v[40:43], v[16:31]
    ds_read_b128 v[56:59], v6 offset:14336
    s_waitcnt lgkmcnt(3)
    v_mfma_f32_32x32x16_bf16 v[16:31], v[172:175], v[44:47], v[16:31]
    ds_read_b128 v[60:63], v6 offset:15360
    s_waitcnt lgkmcnt(3)
    v_mfma_f32_32x32x16_bf16 v[16:31], v[176:179], v[48:51], v[16:31]
    s_waitcnt lgkmcnt(2)
    v_mfma_f32_32x32x16_bf16 v[16:31], v[180:183], v[52:55], v[16:31]
    s_waitcnt lgkmcnt(1)
    v_mfma_f32_32x32x16_bf16 v[16:31], v[184:187], v[56:59], v[16:31]
    s_waitcnt lgkmcnt(0)
    v_mfma_f32_32x32x16_bf16 v[16:31], v[188:191], v[60:63], v[16:31]
    s_mul_i32 s37, s20, 2128
    s_lshl_b32 s38, s20, 11
    s_add_u32 s38, s38, 6610944
    s_lshr_b32 s30, s21, 1
    s_lshl_b32 s39, s30, 14
    v_add_u32 v0, s30, v1
    v_and_b32 v0, 7, v0
    v_lshlrev_b32 v0, 10, v0
    s_lshl_b32 s33, s20, 7
    s_add_u32 s33, s33, 26615808
    s_mov_b64 exec, 0xff
    buffer_load_dword v2, v0, s[8:11], s33 offen sc1
    s_mov_b64 exec, -1
    v_mul_f32 v110, 0x3eb8aa3b, v109
    v_dot2_f32_bf16 v80, v160, v73, v80
    v_dot2_f32_bf16 v81, v161, v73, v81
    v_dot2_f32_bf16 v82, v162, v73, v82
    v_dot2_f32_bf16 v83, v163, v73, v83
    v_dot2_f32_bf16 v80, v164, v73, v80
    v_dot2_f32_bf16 v81, v165, v73, v81
    v_dot2_f32_bf16 v82, v166, v73, v82
    v_dot2_f32_bf16 v83, v167, v73, v83
    v_dot2_f32_bf16 v80, v168, v73, v80
    v_dot2_f32_bf16 v81, v169, v73, v81
    v_dot2_f32_bf16 v82, v170, v73, v82
    v_dot2_f32_bf16 v83, v171, v73, v83
    v_dot2_f32_bf16 v80, v172, v73, v80
    v_dot2_f32_bf16 v81, v173, v73, v81
    v_dot2_f32_bf16 v82, v174, v73, v82
    v_dot2_f32_bf16 v83, v175, v73, v83
    v_dot2_f32_bf16 v80, v176, v73, v80
    v_dot2_f32_bf16 v81, v177, v73, v81
    v_dot2_f32_bf16 v82, v178, v73, v82
    v_dot2_f32_bf16 v83, v179, v73, v83
    v_dot2_f32_bf16 v80, v180, v73, v80
    v_dot2_f32_bf16 v81, v181, v73, v81
    v_dot2_f32_bf16 v82, v182, v73, v82
    v_dot2_f32_bf16 v83, v183, v73, v83
    v_dot2_f32_bf16 v80, v184, v73, v80
    v_dot2_f32_bf16 v81, v185, v73, v81
    v_dot2_f32_bf16 v82, v186, v73, v82
    v_dot2_f32_bf16 v83, v187, v73, v83
    v_dot2_f32_bf16 v80, v188, v73, v80
    v_dot2_f32_bf16 v81, v189, v73, v81
    v_dot2_f32_bf16 v82, v190, v73, v82
    v_dot2_f32_bf16 v83, v191, v73, v83
    s_nop 2
    v_add_f32 v80, v80, v81
    v_add_f32 v82, v82, v83
    v_add_f32 v80, v80, v82
    v_mov_b32 v81, v80
    s_nop 1
    v_permlane32_swap_b32 v80, v81
    v_add_f32 v80, v80, v81
    ds_write_b32 v74, v80
    ds_write_b128 v7, v[24:27] offset:0
    ds_write_b128 v7, v[28:31] offset:1024
    s_waitcnt lgkmcnt(0)
    s_barrier
    ds_read_b128 v[24:27], v8 offset:0
    ds_read_b128 v[28:31], v8 offset:1024
    s_mov_b32 s31, 0
    s_mov_b64 exec, 0xff
pr_kp11:
    s_add_u32 s31, s31, 1
    s_waitcnt vmcnt(0)
    v_cmp_ne_u32 vcc, 0, v2
    s_and_b32 s30, vcc_lo, 1
    s_cmp_eq_u32 s30, 1
    s_cbranch_scc1 pr_kpd12
    s_sleep 2
    buffer_load_dword v2, v0, s[8:11], s33 offen sc1
    s_cmp_lt_u32 s31, 2097152
    s_cbranch_scc1 pr_kp11
    s_branch k_end
pr_kpd12:
    s_mov_b64 exec, -1
    s_add_u32 s30, s39, 0
    s_and_b32 s30, s30, 0x1ffff
    s_add_u32 m0, s37, 0
    s_add_u32 s30, s30, s38
    buffer_load_dwordx4 v3, s[8:11], s30 offen lds
    buffer_load_dwordx4 v3, s[8:11], s30 offen offset:1024 lds
    s_mov_b64 exec, 0xff
    buffer_load_dword v2, v0, s[8:11], s33 offen sc1
    s_mov_b64 exec, -1
    ds_read_b128 v[96:99], v77 offset:0
    ds_read_b128 v[32:35], v78 offset:0
    ds_read_b128 v[100:103], v77 offset:32
    ds_read_b128 v[36:39], v78 offset:32
    s_waitcnt lgkmcnt(0)
    v_add_f32 v96, v96, v32
    v_add_f32 v97, v97, v33
    v_add_f32 v98, v98, v34
    v_add_f32 v99, v99, v35
    v_add_f32 v100, v100, v36
    v_add_f32 v101, v101, v37
    v_add_f32 v102, v102, v38
    v_add_f32 v103, v103, v39
    v_mov_b32 v208, v96
    v_mov_b32 v209, v97
    v_mov_b32 v210, v98
    v_mov_b32 v211, v99
    v_mov_b32 v212, v100
    v_mov_b32 v213, v101
    v_mov_b32 v214, v102
    v_mov_b32 v215, v103
    v_mov_b32 v216, v104
    v_mov_b32 v217, v105
    v_mov_b32 v218, v106
    v_mov_b32 v219, v107
    v_fma_f32 v16, -v108, v96, v16
    v_fma_f32 v17, -v108, v97, v17
    v_fma_f32 v18, -v108, v98, v18
    v_fma_f32 v19, -v108, v99, v19
    v_fma_f32 v20, -v108, v100, v20
    v_fma_f32 v21, -v108, v101, v21
    v_fma_f32 v22, -v108, v102, v22
    v_fma_f32 v23, -v108, v103, v23
    s_waitcnt lgkmcnt(0)
    v_add_f32 v16, v16, v24
    v_add_f32 v17, v17, v25
    v_add_f32 v18, v18, v26
    v_add_f32 v19, v19, v27
    v_add_f32 v20, v20, v28
    v_add_f32 v21, v21, v29
    v_add_f32 v22, v22, v30
    v_add_f32 v23, v23, v31
    v_mul_f32 v16, v110, v16
    v_mul_f32 v17, v110, v17
    v_mul_f32 v18, v110, v18
    v_mul_f32 v19, v110, v19
    v_mul_f32 v20, v110, v20
    v_mul_f32 v21, v110, v21
    v_mul_f32 v22, v110, v22
    v_mul_f32 v23, v110, v23
    v_cvt_pk_bf16_f32 v124, v16, v17
    v_cvt_pk_bf16_f32 v125, v18, v19
    v_cvt_pk_bf16_f32 v126, v20, v21
    v_cvt_pk_bf16_f32 v127, v22, v23
    s_barrier
    s_add_u32 s36, s19, 13049856
    s_load_dwordx2 s[4:5], s[0:1], 32
    s_load_dwordx4 s[52:55], s[0:1], 48
    s_load_dwordx2 s[16:17], s[0:1], 64
    v_mov_b32 v104, v3
    v_and_b32 v106, 15, v1
    v_lshrrev_b32 v107, 5, v1
    v_lshl_add_u32 v106, v107, 4, v106
    v_lshlrev_b32 v106, 4, v106
    v_add_u32 v105, 1024, v106
    v_add_u32 v111, 1536, v106
    v_and_b32 v107, 31, v1
    v_cmp_eq_u32 vcc, 16, v107
    v_mov_b32 v108, 2048
    s_nop 0
    v_cndmask_b32 v105, v105, v108, vcc
    v_cndmask_b32 v111, v111, v108, vcc
    v_cmp_lt_u32 vcc, 16, v107
    v_mov_b32 v108, 2064
    s_nop 0
    v_cndmask_b32 v105, v105, v108, vcc
    v_cndmask_b32 v111, v111, v108, vcc
    v_subrev_u32 v107, 20, v107
    v_cmp_gt_u32 vcc, 8, v107
    v_mov_b32 v108, 2112
    s_nop 0
    v_cndmask_b32 v105, v105, v108, vcc
    v_cndmask_b32 v111, v111, v108, vcc
    v_mov_b32 v56, 0
    v_mov_b32 v57, 0
    v_mov_b32 v58, 0
    v_mov_b32 v59, 0
    v_mov_b32 v60, 0
    v_mov_b32 v61, 0
    v_mov_b32 v62, 0
    v_mov_b32 v63, 0
    v_mov_b32 v64, 0
    v_mov_b32 v65, 0
    v_mov_b32 v66, 0
    v_mov_b32 v67, 0
    v_mov_b32 v68, 0
    v_mov_b32 v69, 0
    v_mov_b32 v70, 0
    v_mov_b32 v71, 0
    v_mov_b32 v76, 0
    v_mov_b32 v77, 0
    v_mov_b32 v78, 0
    v_mov_b32 v79, 0
    v_mov_b32 v100, 0
    v_mov_b32 v72, 0x3f803f80
    v_mov_b32 v101, 0
    v_mov_b32 v73, 0x3f803f80
    v_mov_b32 v102, 0
    v_mov_b32 v74, 0x3f803f80
    v_mov_b32 v103, 0
    v_mov_b32 v75, 0x3f803f80
    v_mul_u32_u24 v106, 2128, v1
    s_cmp_lg_u32 s20, 7
    s_cbranch_scc1 l0_cw13
    ds_write_b128 v106, v[72:75] offset:2048
    ds_write_b128 v106, v[76:79] offset:2064
    ds_write_b128 v106, v[76:79] offset:2112
l0_cw13:
    s_waitcnt vmcnt(0) lgkmcnt(0)
    v_cmp_ne_u32 vcc, 0, v2
    s_barrier
    s_and_b32 s32, vcc_lo, 0xff
    s_cmp_lg_u32 s32, 0xff
    s_cbranch_scc1 l0_nd14
    s_add_u32 s30, s39, 16384
    s_and_b32 s30, s30, 0x1ffff
    s_add_u32 m0, s37, 17024
    s_add_u32 s30, s30, s38
    buffer_load_dwordx4 v3, s[8:11], s30 offen lds
    buffer_load_dwordx4 v3, s[8:11], s30 offen offset:1024 lds
    s_add_u32 s30, s39, 32768
    s_and_b32 s30, s30, 0x1ffff
    s_add_u32 m0, s37, 34048
    s_add_u32 s30, s30, s38
    buffer_load_dwordx4 v3, s[8:11], s30 offen lds
    buffer_load_dwordx4 v3, s[8:11], s30 offen offset:1024 lds
    s_add_u32 s30, s39, 49152
    s_and_b32 s30, s30, 0x1ffff
    s_add_u32 m0, s37, 51072
    s_add_u32 s30, s30, s38
    buffer_load_dwordx4 v3, s[8:11], s30 offen lds
    buffer_load_dwordx4 v3, s[8:11], s30 offen offset:1024 lds
l0_nd14:
    ds_read_b128 v[80:83], v104 offset:0
    ds_read_b128 v[84:87], v104 offset:2128
    ds_read_b128 v[88:91], v105 offset:0
    ds_read_b128 v[92:95], v111 offset:0
    s_waitcnt lgkmcnt(3)
    v_mfma_f32_32x32x16_bf16 v[24:39], v[80:83], v[124:127], 0
    s_nop 11
    v_max3_f32 v106, v24, v25, v26
    v_max3_f32 v106, v106, v27, v28
    v_max3_f32 v106, v106, v29, v30
    v_max3_f32 v106, v106, v31, v32
    v_max3_f32 v106, v106, v33, v34
    v_max3_f32 v106, v106, v35, v36
    v_max3_f32 v106, v106, v37, v38
    v_max_f32 v106, v106, v39
    v_mov_b32 v107, v106
    s_nop 1
    v_permlane32_swap_b32 v106, v107
    v_max_f32 v106, v106, v107
    v_sub_f32 v8, 0, v106
    v_sub_f32 v9, 0, v106
    v_sub_f32 v10, 0, v106
    v_sub_f32 v11, 0, v106
    v_sub_f32 v12, 0, v106
    v_sub_f32 v13, 0, v106
    v_sub_f32 v14, 0, v106
    v_sub_f32 v15, 0, v106
    v_sub_f32 v16, 0, v106
    v_sub_f32 v17, 0, v106
    v_sub_f32 v18, 0, v106
    v_sub_f32 v19, 0, v106
    v_sub_f32 v20, 0, v106
    v_sub_f32 v21, 0, v106
    v_sub_f32 v22, 0, v106
    v_sub_f32 v23, 0, v106
    v_sub_f32 v24, v24, v106
    v_sub_f32 v25, v25, v106
    v_sub_f32 v26, v26, v106
    v_sub_f32 v27, v27, v106
    v_sub_f32 v28, v28, v106
    v_sub_f32 v29, v29, v106
    v_sub_f32 v30, v30, v106
    v_sub_f32 v31, v31, v106
    v_sub_f32 v32, v32, v106
    v_sub_f32 v33, v33, v106
    v_sub_f32 v34, v34, v106
    v_sub_f32 v35, v35, v106
    v_sub_f32 v36, v36, v106
    v_sub_f32 v37, v37, v106
    v_sub_f32 v38, v38, v106
    v_sub_f32 v39, v39, v106
    s_setprio 3
    s_waitcnt lgkmcnt(0)
    v_mfma_f32_32x32x16_bf16 v[40:55], v[84:87], v[124:127], v[8:23]
    ds_read_b128 v[80:83], v104 offset:4256
    v_exp_f32 v24, v24
    v_exp_f32 v25, v25
    v_exp_f32 v26, v26
    v_exp_f32 v27, v27
    v_exp_f32 v28, v28
    v_exp_f32 v29, v29
    v_mfma_f32_32x32x16_bf16 v[56:71], v[100:103], v[76:79], v[56:71]
    v_exp_f32 v30, v30
    v_exp_f32 v31, v31
    v_cvt_pk_bf16_f32 v72, v24, v25
    v_cvt_pk_bf16_f32 v73, v26, v27
    v_cvt_pk_bf16_f32 v74, v28, v29
    v_cvt_pk_bf16_f32 v75, v30, v31
    v_exp_f32 v32, v32
    v_exp_f32 v33, v33
    s_waitcnt lgkmcnt(0)
    v_mfma_f32_32x32x16_bf16 v[56:71], v[88:91], v[72:75], v[56:71]
    ds_read_b128 v[96:99], v105 offset:2128
    ds_read_b128 v[100:103], v111 offset:2128
    v_exp_f32 v34, v34
    v_exp_f32 v35, v35
    v_exp_f32 v36, v36
    v_exp_f32 v37, v37
    v_exp_f32 v38, v38
    v_exp_f32 v39, v39
    v_cvt_pk_bf16_f32 v76, v32, v33
    v_cvt_pk_bf16_f32 v77, v34, v35
    v_cvt_pk_bf16_f32 v78, v36, v37
    v_cvt_pk_bf16_f32 v79, v38, v39
    v_mfma_f32_32x32x16_bf16 v[24:39], v[80:83], v[124:127], v[8:23]
    ds_read_b128 v[84:87], v104 offset:6384
    v_exp_f32 v40, v40
    v_exp_f32 v41, v41
    v_exp_f32 v42, v42
    v_exp_f32 v43, v43
    v_exp_f32 v44, v44
    v_exp_f32 v45, v45
    v_mfma_f32_32x32x16_bf16 v[56:71], v[92:95], v[76:79], v[56:71]
    v_exp_f32 v46, v46
    v_exp_f32 v47, v47
    v_cvt_pk_bf16_f32 v72, v40, v41
    v_cvt_pk_bf16_f32 v73, v42, v43
    v_cvt_pk_bf16_f32 v74, v44, v45
    v_cvt_pk_bf16_f32 v75, v46, v47
    v_exp_f32 v48, v48
    v_exp_f32 v49, v49
    s_waitcnt lgkmcnt(0)
    v_mfma_f32_32x32x16_bf16 v[56:71], v[96:99], v[72:75], v[56:71]
    ds_read_b128 v[88:91], v105 offset:4256
    ds_read_b128 v[92:95], v111 offset:4256
    v_exp_f32 v50, v50
    v_exp_f32 v51, v51
    v_exp_f32 v52, v52
    v_exp_f32 v53, v53
    v_exp_f32 v54, v54
    v_exp_f32 v55, v55
    v_cvt_pk_bf16_f32 v76, v48, v49
    v_cvt_pk_bf16_f32 v77, v50, v51
    v_cvt_pk_bf16_f32 v78, v52, v53
    v_cvt_pk_bf16_f32 v79, v54, v55
    s_cmp_eq_u32 s32, 0xff
    s_cbranch_scc1 l0_dn15
    s_mov_b64 exec, 0xff
    buffer_load_dword v2, v0, s[8:11], s33 offen sc1
    s_mov_b64 exec, -1
    s_mov_b32 s31, 0
    s_mov_b64 exec, 0xff
l0_kp16:
    s_add_u32 s31, s31, 1
    s_waitcnt vmcnt(0)
    v_cmp_ne_u32 vcc, 0, v2
    s_and_b32 s30, vcc_lo, 255
    s_cmp_eq_u32 s30, 255
    s_cbranch_scc1 l0_kpd17
    s_sleep 2
    buffer_load_dword v2, v0, s[8:11], s33 offen sc1
    s_cmp_lt_u32 s31, 2097152
    s_cbranch_scc1 l0_kp16
    s_branch k_end
l0_kpd17:
    s_mov_b64 exec, -1
    s_add_u32 s30, s39, 16384
    s_and_b32 s30, s30, 0x1ffff
    s_add_u32 m0, s37, 17024
    s_add_u32 s30, s30, s38
    buffer_load_dwordx4 v3, s[8:11], s30 offen lds
    buffer_load_dwordx4 v3, s[8:11], s30 offen offset:1024 lds
    s_add_u32 s30, s39, 32768
    s_and_b32 s30, s30, 0x1ffff
    s_add_u32 m0, s37, 34048
    s_add_u32 s30, s30, s38
    buffer_load_dwordx4 v3, s[8:11], s30 offen lds
    buffer_load_dwordx4 v3, s[8:11], s30 offen offset:1024 lds
    s_add_u32 s30, s39, 49152
    s_and_b32 s30, s30, 0x1ffff
    s_add_u32 m0, s37, 51072
    s_add_u32 s30, s30, s38
    buffer_load_dwordx4 v3, s[8:11], s30 offen lds
    buffer_load_dwordx4 v3, s[8:11], s30 offen offset:1024 lds
l0_dn15:
    v_mfma_f32_32x32x16_bf16 v[40:55], v[84:87], v[124:127], v[8:23]
    ds_read_b128 v[80:83], v104 offset:8512
    v_exp_f32 v24, v24
    v_exp_f32 v25, v25
    v_exp_f32 v26, v26
    v_exp_f32 v27, v27
    v_exp_f32 v28, v28
    v_exp_f32 v29, v29
    v_mfma_f32_32x32x16_bf16 v[56:71], v[100:103], v[76:79], v[56:71]
    s_add_u32 s30, s39, 65536
    s_and_b32 s30, s30, 0x1ffff
    s_add_u32 m0, s37, 68096
    s_add_u32 s30, s30, s38
    buffer_load_dwordx4 v3, s[8:11], s30 offen lds
    buffer_load_dwordx4 v3, s[8:11], s30 offen offset:1024 lds
    s_add_u32 s30, s39, 81920
    s_and_b32 s30, s30, 0x1ffff
    s_add_u32 m0, s37, 85120
    s_add_u32 s30, s30, s38
    buffer_load_dwordx4 v3, s[8:11], s30 offen lds
    buffer_load_dwordx4 v3, s[8:11], s30 offen offset:1024 lds
    s_add_u32 s30, s39, 98304
    s_and_b32 s30, s30, 0x1ffff
    s_add_u32 m0, s37, 102144
    s_add_u32 s30, s30, s38
    buffer_load_dwordx4 v3, s[8:11], s30 offen lds
    buffer_load_dwordx4 v3, s[8:11], s30 offen offset:1024 lds
    s_add_u32 s30, s39, 114688
    s_and_b32 s30, s30, 0x1ffff
    s_add_u32 m0, s37, 119168
    s_add_u32 s30, s30, s38
    buffer_load_dwordx4 v3, s[8:11], s30 offen lds
    buffer_load_dwordx4 v3, s[8:11], s30 offen offset:1024 lds
    v_exp_f32 v30, v30
    v_exp_f32 v31, v31
    v_cvt_pk_bf16_f32 v72, v24, v25
    v_cvt_pk_bf16_f32 v73, v26, v27
    v_cvt_pk_bf16_f32 v74, v28, v29
    v_cvt_pk_bf16_f32 v75, v30, v31
    v_exp_f32 v32, v32
    v_exp_f32 v33, v33
    s_waitcnt lgkmcnt(0)
    v_mfma_f32_32x32x16_bf16 v[56:71], v[88:91], v[72:75], v[56:71]
    ds_read_b128 v[96:99], v105 offset:6384
    ds_read_b128 v[100:103], v111 offset:6384
    v_exp_f32 v34, v34
    v_exp_f32 v35, v35
    v_exp_f32 v36, v36
    v_exp_f32 v37, v37
    v_exp_f32 v38, v38
    v_exp_f32 v39, v39
    v_cvt_pk_bf16_f32 v76, v32, v33
    v_cvt_pk_bf16_f32 v77, v34, v35
    v_cvt_pk_bf16_f32 v78, v36, v37
    v_cvt_pk_bf16_f32 v79, v38, v39
    v_mfma_f32_32x32x16_bf16 v[24:39], v[80:83], v[124:127], v[8:23]
    ds_read_b128 v[84:87], v104 offset:10640
    v_exp_f32 v40, v40
    v_exp_f32 v41, v41
    v_exp_f32 v42, v42
    v_exp_f32 v43, v43
    v_exp_f32 v44, v44
    v_exp_f32 v45, v45
    v_mfma_f32_32x32x16_bf16 v[56:71], v[92:95], v[76:79], v[56:71]
    v_exp_f32 v46, v46
    v_exp_f32 v47, v47
    v_cvt_pk_bf16_f32 v72, v40, v41
    v_cvt_pk_bf16_f32 v73, v42, v43
    v_cvt_pk_bf16_f32 v74, v44, v45
    v_cvt_pk_bf16_f32 v75, v46, v47
    v_exp_f32 v48, v48
    v_exp_f32 v49, v49
    s_waitcnt lgkmcnt(0)
    v_mfma_f32_32x32x16_bf16 v[56:71], v[96:99], v[72:75], v[56:71]
    ds_read_b128 v[88:91], v105 offset:8512
    ds_read_b128 v[92:95], v111 offset:8512
    v_exp_f32 v50, v50
    v_exp_f32 v51, v51
    v_exp_f32 v52, v52
    v_exp_f32 v53, v53
    v_exp_f32 v54, v54
    v_exp_f32 v55, v55
    v_cvt_pk_bf16_f32 v76, v48, v49
    v_cvt_pk_bf16_f32 v77, v50, v51
    v_cvt_pk_bf16_f32 v78, v52, v53
    v_cvt_pk_bf16_f32 v79, v54, v55
    v_mfma_f32_32x32x16_bf16 v[40:55], v[84:87], v[124:127], v[8:23]
    ds_read_b128 v[80:83], v104 offset:12768
    v_exp_f32 v24, v24
    v_exp_f32 v25, v25
    v_exp_f32 v26, v26
    v_exp_f32 v27, v27
    v_exp_f32 v28, v28
    v_exp_f32 v29, v29
    v_mfma_f32_32x32x16_bf16 v[56:71], v[100:103], v[76:79], v[56:71]
    v_exp_f32 v30, v30
    v_exp_f32 v31, v31
    v_cvt_pk_bf16_f32 v72, v24, v25
    v_cvt_pk_bf16_f32 v73, v26, v27
    v_cvt_pk_bf16_f32 v74, v28, v29
    v_cvt_pk_bf16_f32 v75, v30, v31
    v_exp_f32 v32, v32
    v_exp_f32 v33, v33
    s_waitcnt lgkmcnt(0)
    v_mfma_f32_32x32x16_bf16 v[56:71], v[88:91], v[72:75], v[56:71]
    ds_read_b128 v[96:99], v105 offset:10640
    ds_read_b128 v[100:103], v111 offset:10640
    v_exp_f32 v34, v34
    v_exp_f32 v35, v35
    v_exp_f32 v36, v36
    v_exp_f32 v37, v37
    v_exp_f32 v38, v38
    v_exp_f32 v39, v39
    v_cvt_pk_bf16_f32 v76, v32, v33
    v_cvt_pk_bf16_f32 v77, v34, v35
    v_cvt_pk_bf16_f32 v78, v36, v37
    v_cvt_pk_bf16_f32 v79, v38, v39
    v_mfma_f32_32x32x16_bf16 v[24:39], v[80:83], v[124:127], v[8:23]
    ds_read_b128 v[84:87], v104 offset:14896
    v_exp_f32 v40, v40
    v_exp_f32 v41, v41
    v_exp_f32 v42, v42
    v_exp_f32 v43, v43
    v_exp_f32 v44, v44
    v_exp_f32 v45, v45
    v_mfma_f32_32x32x16_bf16 v[56:71], v[92:95], v[76:79], v[56:71]
    v_exp_f32 v46, v46
    v_exp_f32 v47, v47
    v_cvt_pk_bf16_f32 v72, v40, v41
    v_cvt_pk_bf16_f32 v73, v42, v43
    v_cvt_pk_bf16_f32 v74, v44, v45
    v_cvt_pk_bf16_f32 v75, v46, v47
    v_exp_f32 v48, v48
    v_exp_f32 v49, v49
    s_waitcnt lgkmcnt(0)
    v_mfma_f32_32x32x16_bf16 v[56:71], v[96:99], v[72:75], v[56:71]
    ds_read_b128 v[88:91], v105 offset:12768
    ds_read_b128 v[92:95], v111 offset:12768
    v_exp_f32 v50, v50
    v_exp_f32 v51, v51
    v_exp_f32 v52, v52
    v_exp_f32 v53, v53
    v_exp_f32 v54, v54
    v_exp_f32 v55, v55
    v_cvt_pk_bf16_f32 v76, v48, v49
    v_cvt_pk_bf16_f32 v77, v50, v51
    v_cvt_pk_bf16_f32 v78, v52, v53
    v_cvt_pk_bf16_f32 v79, v54, v55
    s_waitcnt vmcnt(0)
    s_barrier
    s_and_b32 s30, s18, 0x33
    s_cmp_lg_u32 s30, 0
    s_cbranch_scc1 pr_w0
    s_lshl_b32 s30, s26, 8
    v_xor_b32 v112, s30, v3
    s_and_b32 s30, s19, 0x7fff
    s_lshl_b32 s30, s30, 4
    s_add_u32 s30, s30, 0
    v_add_u32 v112, s30, v112
    s_cmp_lg_u32 s21, 3
    s_cbranch_scc1 pr_ws3
    buffer_store_dwordx4 v[176:179], v112, s[8:11], s42 offen offset:2048 sc0 sc1
    buffer_store_dwordx4 v[180:183], v112, s[8:11], s42 offen offset:3072 sc0 sc1
    buffer_store_dwordx4 v[184:187], v112, s[8:11], s43 offen offset:2048 sc0 sc1
    buffer_store_dwordx4 v[188:191], v112, s[8:11], s43 offen offset:3072 sc0 sc1
    s_branch pr_w0
pr_ws3:
    s_cmp_lg_u32 s21, 2
    s_cbranch_scc1 pr_ws2
    buffer_store_dwordx4 v[160:163], v112, s[8:11], 0 offen offset:2048 sc0 sc1
    buffer_store_dwordx4 v[164:167], v112, s[8:11], 0 offen offset:3072 sc0 sc1
    buffer_store_dwordx4 v[168:171], v112, s[8:11], s41 offen offset:2048 sc0 sc1
    buffer_store_dwordx4 v[172:175], v112, s[8:11], s41 offen offset:3072 sc0 sc1
    s_branch pr_w0
pr_ws2:
    s_cmp_lg_u32 s21, 1
    s_cbranch_scc1 pr_ws1
    buffer_store_dwordx4 v[144:147], v112, s[8:11], s42 offen offset:0 sc0 sc1
    buffer_store_dwordx4 v[148:151], v112, s[8:11], s42 offen offset:1024 sc0 sc1
    buffer_store_dwordx4 v[152:155], v112, s[8:11], s43 offen offset:0 sc0 sc1
    buffer_store_dwordx4 v[156:159], v112, s[8:11], s43 offen offset:1024 sc0 sc1
    s_branch pr_w0
pr_ws1:
    buffer_store_dwordx4 v[128:131], v112, s[8:11], 0 offen offset:0 sc0 sc1
    buffer_store_dwordx4 v[132:135], v112, s[8:11], 0 offen offset:1024 sc0 sc1
    buffer_store_dwordx4 v[136:139], v112, s[8:11], s41 offen offset:0 sc0 sc1
    buffer_store_dwordx4 v[140:143], v112, s[8:11], s41 offen offset:1024 sc0 sc1
    v_lshrrev_b32 v113, 5, v1
    v_lshlrev_b32 v113, 4, v113
    s_lshr_b32 s31, s19, 4
    s_add_u32 s31, s31, 6586368
    s_mov_b32 exec_lo, 1
    s_mov_b32 exec_hi, 1
    buffer_store_dwordx4 v[208:211], v113, s[8:11], s31 offen sc0 sc1
    buffer_store_dwordx4 v[212:215], v113, s[8:11], s31 offen offset:32 sc0 sc1
    s_mov_b64 exec, -1
    s_cmp_lg_u32 s22, 0
    s_cbranch_scc1 pr_w0
    s_lshl_b32 s30, s20, 12
    s_add_u32 s30, s30, 524288
    buffer_store_dwordx4 v[192:195], v3, s[8:11], s30 offen offset:0 sc0 sc1
    buffer_store_dwordx4 v[196:199], v3, s[8:11], s30 offen offset:1024 sc0 sc1
    buffer_store_dwordx4 v[200:203], v3, s[8:11], s30 offen offset:2048 sc0 sc1
    buffer_store_dwordx4 v[204:207], v3, s[8:11], s30 offen offset:3072 sc0 sc1
    s_cmp_ge_u32 s20, 4
    s_cbranch_scc1 pr_w0
    s_lshl_b32 s31, s20, 5
    s_add_u32 s31, s31, 6588416
    s_mov_b32 exec_lo, 1
    s_mov_b32 exec_hi, 1
    buffer_store_dwordx4 v[216:219], v113, s[8:11], s31 offen sc0 sc1
    s_mov_b64 exec, -1
pr_w0:
    s_mul_i32 s30, s2, 3
    s_add_u32 s30, s30, s20
    s_mov_b32 s58, s30
    s_cmp_lt_u32 s20, 3
    s_cselect_b32 s57, 1, 0
    s_cmp_lt_u32 s30, 736
    s_cselect_b32 s57, s57, 0
    s_cmp_eq_u32 s57, 0
    s_cselect_b32 s30, 0, s30
    s_cmp_lt_u32 s30, 64
    s_cbranch_scc1 pk_jwo
    s_cmp_lt_u32 s30, 512
    s_cbranch_scc1 pk_jgu
    s_sub_u32 s30, s30, 512
    s_mov_b64 s[4:5], s[16:17]
    s_mov_b32 s6, 1835008
    s_mov_b32 s50, 1024
    s_and_b32 s31, s30, 7
    s_lshr_b32 s30, s30, 3
    s_lshl_b32 s51, s30, 16
    s_lshl_b32 s56, s31, 7
    s_add_u32 s51, s51, s56
    s_mul_i32 s56, s31, 229376
    s_lshl_b32 s30, s30, 12
    s_add_u32 s56, s56, s30
    s_add_u32 s56, s56, 4751360
    s_mov_b32 s52, 114688
    s_mov_b32 s53, 256
    s_mov_b32 s54, 6606848
    s_branch pk_jgo
pk_jwo:
    s_mov_b32 s6, 524288
    s_mov_b32 s50, 1024
    s_lshr_b32 s31, s30, 3
    s_and_b32 s30, s30, 7
    s_lshl_b32 s51, s30, 16
    s_lshl_b32 s56, s31, 7
    s_add_u32 s51, s51, s56
    s_lshl_b32 s56, s31, 16
    s_lshl_b32 s30, s30, 12
    s_add_u32 s56, s56, s30
    s_add_u32 s56, s56, 557056
    s_mov_b32 s52, 32768
    s_mov_b32 s53, 256
    s_mov_b32 s54, 6606848
    s_branch pk_jgo
pk_jgu:
    s_sub_u32 s30, s30, 64
    s_cmp_ge_u32 s30, 224
    s_cselect_b32 s4, s54, s52
    s_cselect_b32 s5, s55, s53
    s_cselect_b32 s16, 1, 0
    s_cselect_b32 s31, 224, 0
    s_sub_u32 s30, s30, s31
    s_mov_b32 s6, 1835008
    s_mov_b32 s50, 3584
    s_lshr_b32 s31, s30, 3
    s_and_b32 s30, s30, 7
    s_mul_i32 s51, s30, 229376
    s_lshl_b32 s56, s31, 7
    s_add_u32 s51, s51, s56
    s_lshl_b32 s56, s31, 17
    s_lshl_b32 s17, s30, 12
    s_add_u32 s56, s56, s17
    s_lshl_b32 s17, s16, 8
    s_add_u32 s56, s56, s17
    s_add_u32 s56, s56, 1081344
    s_mov_b32 s52, 65536
    s_mov_b32 s53, 32768
    s_mul_i32 s54, s30, 14336
    s_lshl_b32 s17, s31, 9
    s_add_u32 s54, s54, s17
    s_lshl_b32 s17, s16, 6
    s_add_u32 s54, s54, s17
    s_add_u32 s54, s54, 26370048
pk_jgo:
    v_lshrrev_b32 v112, 3, v1
    v_and_b32 v113, 7, v1
    v_mul_lo_u32 v112, v112, s50
    v_lshl_add_u32 v112, v113, 4, v112
    s_lshl_b32 s50, s50, 3
    s_min_u32 s59, s20, 2
    s_lshl_b32 s59, s59, 13
    s_add_u32 s59, s59, 139264
    s_cmp_eq_u32 s57, 0
    s_cbranch_scc1 pk_i_end
    s_add_u32 m0, s59, 0
    s_nop 0
    buffer_load_dwordx4 v112, s[4:7], s51 offen lds
    s_add_u32 s51, s51, s50
    s_add_u32 m0, s59, 1024
    s_nop 0
    buffer_load_dwordx4 v112, s[4:7], s51 offen lds
    s_add_u32 s51, s51, s50
    s_add_u32 m0, s59, 2048
    s_nop 0
    buffer_load_dwordx4 v112, s[4:7], s51 offen lds
    s_add_u32 s51, s51, s50
    s_add_u32 m0, s59, 3072
    s_nop 0
    buffer_load_dwordx4 v112, s[4:7], s51 offen lds
    s_add_u32 s51, s51, s50
    s_add_u32 m0, s59, 4096
    s_nop 0
    buffer_load_dwordx4 v112, s[4:7], s51 offen lds
    s_add_u32 s51, s51, s50
    s_add_u32 m0, s59, 5120
    s_nop 0
    buffer_load_dwordx4 v112, s[4:7], s51 offen lds
    s_add_u32 s51, s51, s50
    s_add_u32 m0, s59, 6144
    s_nop 0
    buffer_load_dwordx4 v112, s[4:7], s51 offen lds
    s_add_u32 s51, s51, s50
    s_add_u32 m0, s59, 7168
    s_nop 0
    buffer_load_dwordx4 v112, s[4:7], s51 offen lds
    s_add_u32 s51, s51, s50
pk_i_end:
    v_mfma_f32_32x32x16_bf16 v[40:55], v[84:87], v[124:127], v[8:23]
    ds_read_b128 v[80:83], v104 offset:17024
    v_exp_f32 v24, v24
    v_exp_f32 v25, v25
    v_exp_f32 v26, v26
    v_exp_f32 v27, v27
    v_exp_f32 v28, v28
    v_exp_f32 v29, v29
    v_mfma_f32_32x32x16_bf16 v[56:71], v[100:103], v[76:79], v[56:71]
    v_exp_f32 v30, v30
    v_exp_f32 v31, v31
    v_cvt_pk_bf16_f32 v72, v24, v25
    v_cvt_pk_bf16_f32 v73, v26, v27
    v_cvt_pk_bf16_f32 v74, v28, v29
    v_cvt_pk_bf16_f32 v75, v30, v31
    v_exp_f32 v32, v32
    v_exp_f32 v33, v33
    s_waitcnt lgkmcnt(0)
    v_mfma_f32_32x32x16_bf16 v[56:71], v[88:91], v[72:75], v[56:71]
    ds_read_b128 v[96:99], v105 offset:14896
    ds_read_b128 v[100:103], v111 offset:14896
    v_exp_f32 v34, v34
    v_exp_f32 v35, v35
    v_exp_f32 v36, v36
    v_exp_f32 v37, v37
    v_exp_f32 v38, v38
    v_exp_f32 v39, v39
    v_cvt_pk_bf16_f32 v76, v32, v33
    v_cvt_pk_bf16_f32 v77, v34, v35
    v_cvt_pk_bf16_f32 v78, v36, v37
    v_cvt_pk_bf16_f32 v79, v38, v39
    v_mfma_f32_32x32x16_bf16 v[24:39], v[80:83], v[124:127], v[8:23]
    ds_read_b128 v[84:87], v104 offset:19152
    v_exp_f32 v40, v40
    v_exp_f32 v41, v41
    v_exp_f32 v42, v42
    v_exp_f32 v43, v43
    v_exp_f32 v44, v44
    v_exp_f32 v45, v45
    v_mfma_f32_32x32x16_bf16 v[56:71], v[92:95], v[76:79], v[56:71]
    v_exp_f32 v46, v46
    v_exp_f32 v47, v47
    v_cvt_pk_bf16_f32 v72, v40, v41
    v_cvt_pk_bf16_f32 v73, v42, v43
    v_cvt_pk_bf16_f32 v74, v44, v45
    v_cvt_pk_bf16_f32 v75, v46, v47
    v_exp_f32 v48, v48
    v_exp_f32 v49, v49
    s_waitcnt lgkmcnt(0)
    v_mfma_f32_32x32x16_bf16 v[56:71], v[96:99], v[72:75], v[56:71]
    ds_read_b128 v[88:91], v105 offset:17024
    ds_read_b128 v[92:95], v111 offset:17024
    v_exp_f32 v50, v50
    v_exp_f32 v51, v51
    v_exp_f32 v52, v52
    v_exp_f32 v53, v53
    v_exp_f32 v54, v54
    v_exp_f32 v55, v55
    v_cvt_pk_bf16_f32 v76, v48, v49
    v_cvt_pk_bf16_f32 v77, v50, v51
    v_cvt_pk_bf16_f32 v78, v52, v53
    v_cvt_pk_bf16_f32 v79, v54, v55
    v_mfma_f32_32x32x16_bf16 v[40:55], v[84:87], v[124:127], v[8:23]
    ds_read_b128 v[80:83], v104 offset:21280
    v_exp_f32 v24, v24
    v_exp_f32 v25, v25
    v_exp_f32 v26, v26
    v_exp_f32 v27, v27
    v_exp_f32 v28, v28
    v_exp_f32 v29, v29
    v_mfma_f32_32x32x16_bf16 v[56:71], v[100:103], v[76:79], v[56:71]
    v_exp_f32 v30, v30
    v_exp_f32 v31, v31
    v_cvt_pk_bf16_f32 v72, v24, v25
    v_cvt_pk_bf16_f32 v73, v26, v27
    v_cvt_pk_bf16_f32 v74, v28, v29
    v_cvt_pk_bf16_f32 v75, v30, v31
    v_exp_f32 v32, v32
    v_exp_f32 v33, v33
    s_waitcnt lgkmcnt(0)
    v_mfma_f32_32x32x16_bf16 v[56:71], v[88:91], v[72:75], v[56:71]
    ds_read_b128 v[96:99], v105 offset:19152
    ds_read_b128 v[100:103], v111 offset:19152
    v_exp_f32 v34, v34
    v_exp_f32 v35, v35
    v_exp_f32 v36, v36
    v_exp_f32 v37, v37
    v_exp_f32 v38, v38
    v_exp_f32 v39, v39
    v_cvt_pk_bf16_f32 v76, v32, v33
    v_cvt_pk_bf16_f32 v77, v34, v35
    v_cvt_pk_bf16_f32 v78, v36, v37
    v_cvt_pk_bf16_f32 v79, v38, v39
    v_mfma_f32_32x32x16_bf16 v[24:39], v[80:83], v[124:127], v[8:23]
    ds_read_b128 v[84:87], v104 offset:23408
    v_exp_f32 v40, v40
    v_exp_f32 v41, v41
    v_exp_f32 v42, v42
    v_exp_f32 v43, v43
    v_exp_f32 v44, v44
    v_exp_f32 v45, v45
    v_mfma_f32_32x32x16_bf16 v[56:71], v[92:95], v[76:79], v[56:71]
    v_exp_f32 v46, v46
    v_exp_f32 v47, v47
    v_cvt_pk_bf16_f32 v72, v40, v41
    v_cvt_pk_bf16_f32 v73, v42, v43
    v_cvt_pk_bf16_f32 v74, v44, v45
    v_cvt_pk_bf16_f32 v75, v46, v47
    v_exp_f32 v48, v48
    v_exp_f32 v49, v49
    s_waitcnt lgkmcnt(0)
    v_mfma_f32_32x32x16_bf16 v[56:71], v[96:99], v[72:75], v[56:71]
    ds_read_b128 v[88:91], v105 offset:21280
    ds_read_b128 v[92:95], v111 offset:21280
    v_exp_f32 v50, v50
    v_exp_f32 v51, v51
    v_exp_f32 v52, v52
    v_exp_f32 v53, v53
    v_exp_f32 v54, v54
    v_exp_f32 v55, v55
    v_cvt_pk_bf16_f32 v76, v48, v49
    v_cvt_pk_bf16_f32 v77, v50, v51
    v_cvt_pk_bf16_f32 v78, v52, v53
    v_cvt_pk_bf16_f32 v79, v54, v55
    v_mfma_f32_32x32x16_bf16 v[40:55], v[84:87], v[124:127], v[8:23]
    ds_read_b128 v[80:83], v104 offset:25536
    v_exp_f32 v24, v24
    v_exp_f32 v25, v25
    v_exp_f32 v26, v26
    v_exp_f32 v27, v27
    v_exp_f32 v28, v28
    v_exp_f32 v29, v29
    v_mfma_f32_32x32x16_bf16 v[56:71], v[100:103], v[76:79], v[56:71]
    v_exp_f32 v30, v30
    v_exp_f32 v31, v31
    v_cvt_pk_bf16_f32 v72, v24, v25
    v_cvt_pk_bf16_f32 v73, v26, v27
    v_cvt_pk_bf16_f32 v74, v28, v29
    v_cvt_pk_bf16_f32 v75, v30, v31
    v_exp_f32 v32, v32
    v_exp_f32 v33, v33
    s_waitcnt lgkmcnt(0)
    v_mfma_f32_32x32x16_bf16 v[56:71], v[88:91], v[72:75], v[56:71]
    ds_read_b128 v[96:99], v105 offset:23408
    ds_read_b128 v[100:103], v111 offset:23408
    v_exp_f32 v34, v34
    v_exp_f32 v35, v35
    v_exp_f32 v36, v36
    v_exp_f32 v37, v37
    v_exp_f32 v38, v38
    v_exp_f32 v39, v39
    v_cvt_pk_bf16_f32 v76, v32, v33
    v_cvt_pk_bf16_f32 v77, v34, v35
    v_cvt_pk_bf16_f32 v78, v36, v37
    v_cvt_pk_bf16_f32 v79, v38, v39
    v_mfma_f32_32x32x16_bf16 v[24:39], v[80:83], v[124:127], v[8:23]
    ds_read_b128 v[84:87], v104 offset:27664
    v_exp_f32 v40, v40
    v_exp_f32 v41, v41
    v_exp_f32 v42, v42
    v_exp_f32 v43, v43
    v_exp_f32 v44, v44
    v_exp_f32 v45, v45
    v_mfma_f32_32x32x16_bf16 v[56:71], v[92:95], v[76:79], v[56:71]
    v_exp_f32 v46, v46
    v_exp_f32 v47, v47
    v_cvt_pk_bf16_f32 v72, v40, v41
    v_cvt_pk_bf16_f32 v73, v42, v43
    v_cvt_pk_bf16_f32 v74, v44, v45
    v_cvt_pk_bf16_f32 v75, v46, v47
    v_exp_f32 v48, v48
    v_exp_f32 v49, v49
    s_waitcnt lgkmcnt(0)
    v_mfma_f32_32x32x16_bf16 v[56:71], v[96:99], v[72:75], v[56:71]
    ds_read_b128 v[88:91], v105 offset:25536
    ds_read_b128 v[92:95], v111 offset:25536
    v_exp_f32 v50, v50
    v_exp_f32 v51, v51
    v_exp_f32 v52, v52
    v_exp_f32 v53, v53
    v_exp_f32 v54, v54
    v_exp_f32 v55, v55
    v_cvt_pk_bf16_f32 v76, v48, v49
    v_cvt_pk_bf16_f32 v77, v50, v51
    v_cvt_pk_bf16_f32 v78, v52, v53
    v_cvt_pk_bf16_f32 v79, v54, v55
    v_mfma_f32_32x32x16_bf16 v[40:55], v[84:87], v[124:127], v[8:23]
    ds_read_b128 v[80:83], v104 offset:29792
    v_exp_f32 v24, v24
    v_exp_f32 v25, v25
    v_exp_f32 v26, v26
    v_exp_f32 v27, v27
    v_exp_f32 v28, v28
    v_exp_f32 v29, v29
    v_mfma_f32_32x32x16_bf16 v[56:71], v[100:103], v[76:79], v[56:71]
    v_exp_f32 v30, v30
    v_exp_f32 v31, v31
    v_cvt_pk_bf16_f32 v72, v24, v25
    v_cvt_pk_bf16_f32 v73, v26, v27
    v_cvt_pk_bf16_f32 v74, v28, v29
    v_cvt_pk_bf16_f32 v75, v30, v31
    v_exp_f32 v32, v32
    v_exp_f32 v33, v33
    s_waitcnt lgkmcnt(0)
    v_mfma_f32_32x32x16_bf16 v[56:71], v[88:91], v[72:75], v[56:71]
    ds_read_b128 v[96:99], v105 offset:27664
    ds_read_b128 v[100:103], v111 offset:27664
    v_exp_f32 v34, v34
    v_exp_f32 v35, v35
    v_exp_f32 v36, v36
    v_exp_f32 v37, v37
    v_exp_f32 v38, v38
    v_exp_f32 v39, v39
    v_cvt_pk_bf16_f32 v76, v32, v33
    v_cvt_pk_bf16_f32 v77, v34, v35
    v_cvt_pk_bf16_f32 v78, v36, v37
    v_cvt_pk_bf16_f32 v79, v38, v39
    v_mfma_f32_32x32x16_bf16 v[24:39], v[80:83], v[124:127], v[8:23]
    ds_read_b128 v[84:87], v104 offset:31920
    v_exp_f32 v40, v40
    v_exp_f32 v41, v41
    v_exp_f32 v42, v42
    v_exp_f32 v43, v43
    v_exp_f32 v44, v44
    v_exp_f32 v45, v45
    v_mfma_f32_32x32x16_bf16 v[56:71], v[92:95], v[76:79], v[56:71]
    v_exp_f32 v46, v46
    v_exp_f32 v47, v47
    v_cvt_pk_bf16_f32 v72, v40, v41
    v_cvt_pk_bf16_f32 v73, v42, v43
    v_cvt_pk_bf16_f32 v74, v44, v45
    v_cvt_pk_bf16_f32 v75, v46, v47
    v_exp_f32 v48, v48
    v_exp_f32 v49, v49
    s_waitcnt lgkmcnt(0)
    v_mfma_f32_32x32x16_bf16 v[56:71], v[96:99], v[72:75], v[56:71]
    ds_read_b128 v[88:91], v105 offset:29792
    ds_read_b128 v[92:95], v111 offset:29792
    v_exp_f32 v50, v50
    v_exp_f32 v51, v51
    v_exp_f32 v52, v52
    v_exp_f32 v53, v53
    v_exp_f32 v54, v54
    v_exp_f32 v55, v55
    v_cvt_pk_bf16_f32 v76, v48, v49
    v_cvt_pk_bf16_f32 v77, v50, v51
    v_cvt_pk_bf16_f32 v78, v52, v53
    v_cvt_pk_bf16_f32 v79, v54, v55
    v_mfma_f32_32x32x16_bf16 v[40:55], v[84:87], v[124:127], v[8:23]
    ds_read_b128 v[80:83], v104 offset:34048
    v_exp_f32 v24, v24
    v_exp_f32 v25, v25
    v_exp_f32 v26, v26
    v_exp_f32 v27, v27
    v_exp_f32 v28, v28
    v_exp_f32 v29, v29
    v_mfma_f32_32x32x16_bf16 v[56:71], v[100:103], v[76:79], v[56:71]
    v_exp_f32 v30, v30
    v_exp_f32 v31, v31
    v_cvt_pk_bf16_f32 v72, v24, v25
    v_cvt_pk_bf16_f32 v73, v26, v27
    v_cvt_pk_bf16_f32 v74, v28, v29
    v_cvt_pk_bf16_f32 v75, v30, v31
    v_exp_f32 v32, v32
    v_exp_f32 v33, v33
    s_waitcnt lgkmcnt(0)
    v_mfma_f32_32x32x16_bf16 v[56:71], v[88:91], v[72:75], v[56:71]
    ds_read_b128 v[96:99], v105 offset:31920
    ds_read_b128 v[100:103], v111 offset:31920
    v_exp_f32 v34, v34
    v_exp_f32 v35, v35
    v_exp_f32 v36, v36
    v_exp_f32 v37, v37
    v_exp_f32 v38, v38
    v_exp_f32 v39, v39
    v_cvt_pk_bf16_f32 v76, v32, v33
    v_cvt_pk_bf16_f32 v77, v34, v35
    v_cvt_pk_bf16_f32 v78, v36, v37
    v_cvt_pk_bf16_f32 v79, v38, v39
    v_mfma_f32_32x32x16_bf16 v[24:39], v[80:83], v[124:127], v[8:23]
    ds_read_b128 v[84:87], v104 offset:36176
    v_exp_f32 v40, v40
    v_exp_f32 v41, v41
    v_exp_f32 v42, v42
    v_exp_f32 v43, v43
    v_exp_f32 v44, v44
    v_exp_f32 v45, v45
    v_mfma_f32_32x32x16_bf16 v[56:71], v[92:95], v[76:79], v[56:71]
    v_exp_f32 v46, v46
    v_exp_f32 v47, v47
    v_cvt_pk_bf16_f32 v72, v40, v41
    v_cvt_pk_bf16_f32 v73, v42, v43
    v_cvt_pk_bf16_f32 v74, v44, v45
    v_cvt_pk_bf16_f32 v75, v46, v47
    v_exp_f32 v48, v48
    v_exp_f32 v49, v49
    s_waitcnt lgkmcnt(0)
    v_mfma_f32_32x32x16_bf16 v[56:71], v[96:99], v[72:75], v[56:71]
    ds_read_b128 v[88:91], v105 offset:34048
    ds_read_b128 v[92:95], v111 offset:34048
    v_exp_f32 v50, v50
    v_exp_f32 v51, v51
    v_exp_f32 v52, v52
    v_exp_f32 v53, v53
    v_exp_f32 v54, v54
    v_exp_f32 v55, v55
    v_cvt_pk_bf16_f32 v76, v48, v49
    v_cvt_pk_bf16_f32 v77, v50, v51
    v_cvt_pk_bf16_f32 v78, v52, v53
    v_cvt_pk_bf16_f32 v79, v54, v55
    v_mfma_f32_32x32x16_bf16 v[40:55], v[84:87], v[124:127], v[8:23]
    ds_read_b128 v[80:83], v104 offset:38304
    v_exp_f32 v24, v24
    v_exp_f32 v25, v25
    v_exp_f32 v26, v26
    v_exp_f32 v27, v27
    v_exp_f32 v28, v28
    v_exp_f32 v29, v29
    v_mfma_f32_32x32x16_bf16 v[56:71], v[100:103], v[76:79], v[56:71]
    v_exp_f32 v30, v30
    v_exp_f32 v31, v31
    v_cvt_pk_bf16_f32 v72, v24, v25
    v_cvt_pk_bf16_f32 v73, v26, v27
    v_cvt_pk_bf16_f32 v74, v28, v29
    v_cvt_pk_bf16_f32 v75, v30, v31
    v_exp_f32 v32, v32
    v_exp_f32 v33, v33
    s_waitcnt lgkmcnt(0)
    v_mfma_f32_32x32x16_bf16 v[56:71], v[88:91], v[72:75], v[56:71]
    ds_read_b128 v[96:99], v105 offset:36176
    ds_read_b128 v[100:103], v111 offset:36176
    v_exp_f32 v34, v34
    v_exp_f32 v35, v35
    v_exp_f32 v36, v36
    v_exp_f32 v37, v37
    v_exp_f32 v38, v38
    v_exp_f32 v39, v39
    v_cvt_pk_bf16_f32 v76, v32, v33
    v_cvt_pk_bf16_f32 v77, v34, v35
    v_cvt_pk_bf16_f32 v78, v36, v37
    v_cvt_pk_bf16_f32 v79, v38, v39
    v_mfma_f32_32x32x16_bf16 v[24:39], v[80:83], v[124:127], v[8:23]
    ds_read_b128 v[84:87], v104 offset:40432
    v_exp_f32 v40, v40
    v_exp_f32 v41, v41
    v_exp_f32 v42, v42
    v_exp_f32 v43, v43
    v_exp_f32 v44, v44
    v_exp_f32 v45, v45
    v_mfma_f32_32x32x16_bf16 v[56:71], v[92:95], v[76:79], v[56:71]
    v_exp_f32 v46, v46
    v_exp_f32 v47, v47
    v_cvt_pk_bf16_f32 v72, v40, v41
    v_cvt_pk_bf16_f32 v73, v42, v43
    v_cvt_pk_bf16_f32 v74, v44, v45
    v_cvt_pk_bf16_f32 v75, v46, v47
    v_exp_f32 v48, v48
    v_exp_f32 v49, v49
    s_waitcnt lgkmcnt(0)
    v_mfma_f32_32x32x16_bf16 v[56:71], v[96:99], v[72:75], v[56:71]
    ds_read_b128 v[88:91], v105 offset:38304
    ds_read_b128 v[92:95], v111 offset:38304
    v_exp_f32 v50, v50
    v_exp_f32 v51, v51
    v_exp_f32 v52, v52
    v_exp_f32 v53, v53
    v_exp_f32 v54, v54
    v_exp_f32 v55, v55
    v_cvt_pk_bf16_f32 v76, v48, v49
    v_cvt_pk_bf16_f32 v77, v50, v51
    v_cvt_pk_bf16_f32 v78, v52, v53
    v_cvt_pk_bf16_f32 v79, v54, v55
    s_cmp_eq_u32 s57, 0
    s_cbranch_scc1 pk_c_end
    v_lshrrev_b32 v112, 5, v1
    v_bfe_u32 v113, v1, 2, 2
    v_lshl_add_u32 v113, v112, 2, v113
    v_and_b32 v114, 3, v1
    v_lshlrev_b32 v114, 3, v114
    v_lshl_add_u32 v113, v113, 7, v114
    v_bfe_u32 v114, v1, 4, 1
    v_lshl_add_u32 v113, v114, 5, v113
    v_add_u32 v113, s59, v113
    v_mul_lo_u32 v114, v114, s53
    v_and_b32 v115, 15, v1
    v_lshl_add_u32 v114, v115, 4, v114
    v_lshl_add_u32 v114, v112, 9, v114
    v_lshrrev_b32 v112, 4, v1
    v_lshlrev_b32 v112, 7, v112
    v_lshl_add_u32 v112, v115, 2, v112
    v_mov_b32 v115, 0x3f803f80
    s_add_u32 s52, s52, s56
    s_waitcnt vmcnt(0)
    ds_read_b64_tr_b16 v[128:129], v113 offset:0
    ds_read_b64_tr_b16 v[130:131], v113 offset:1024
    ds_read_b64_tr_b16 v[132:133], v113 offset:2048
    ds_read_b64_tr_b16 v[134:135], v113 offset:3072
    ds_read_b64_tr_b16 v[136:137], v113 offset:4096
    ds_read_b64_tr_b16 v[138:139], v113 offset:5120
    ds_read_b64_tr_b16 v[140:141], v113 offset:6144
    ds_read_b64_tr_b16 v[142:143], v113 offset:7168
    s_waitcnt lgkmcnt(0)
    buffer_store_dwordx4 v[128:131], v114, s[8:11], s56 offen offset:0 sc0 sc1
    buffer_store_dwordx4 v[132:135], v114, s[8:11], s56 offen offset:1024 sc0 sc1
    buffer_store_dwordx4 v[136:139], v114, s[8:11], s56 offen offset:2048 sc0 sc1
    buffer_store_dwordx4 v[140:143], v114, s[8:11], s56 offen offset:3072 sc0 sc1
    ds_read_b64_tr_b16 v[144:145], v113 offset:64
    ds_read_b64_tr_b16 v[146:147], v113 offset:1088
    ds_read_b64_tr_b16 v[148:149], v113 offset:2112
    ds_read_b64_tr_b16 v[150:151], v113 offset:3136
    ds_read_b64_tr_b16 v[152:153], v113 offset:4160
    ds_read_b64_tr_b16 v[154:155], v113 offset:5184
    ds_read_b64_tr_b16 v[156:157], v113 offset:6208
    ds_read_b64_tr_b16 v[158:159], v113 offset:7232
    s_waitcnt lgkmcnt(0)
    buffer_store_dwordx4 v[144:147], v114, s[8:11], s52 offen offset:0 sc0 sc1
    buffer_store_dwordx4 v[148:151], v114, s[8:11], s52 offen offset:1024 sc0 sc1
    buffer_store_dwordx4 v[152:155], v114, s[8:11], s52 offen offset:2048 sc0 sc1
    buffer_store_dwordx4 v[156:159], v114, s[8:11], s52 offen offset:3072 sc0 sc1
    s_cmp_eq_u32 s53, 256
    s_cbranch_scc1 pk_c_end
    v_dot2_f32_bf16 v116, v128, v115, 0
    v_dot2_f32_bf16 v117, v144, v115, 0
    v_dot2_f32_bf16 v116, v129, v115, v116
    v_dot2_f32_bf16 v117, v145, v115, v117
    v_dot2_f32_bf16 v116, v130, v115, v116
    v_dot2_f32_bf16 v117, v146, v115, v117
    v_dot2_f32_bf16 v116, v131, v115, v116
    v_dot2_f32_bf16 v117, v147, v115, v117
    v_dot2_f32_bf16 v116, v132, v115, v116
    v_dot2_f32_bf16 v117, v148, v115, v117
    v_dot2_f32_bf16 v116, v133, v115, v116
    v_dot2_f32_bf16 v117, v149, v115, v117
    v_dot2_f32_bf16 v116, v134, v115, v116
    v_dot2_f32_bf16 v117, v150, v115, v117
    v_dot2_f32_bf16 v116, v135, v115, v116
    v_dot2_f32_bf16 v117, v151, v115, v117
    v_dot2_f32_bf16 v116, v136, v115, v116
    v_dot2_f32_bf16 v117, v152, v115, v117
    v_dot2_f32_bf16 v116, v137, v115, v116
    v_dot2_f32_bf16 v117, v153, v115, v117
    v_dot2_f32_bf16 v116, v138, v115, v116
    v_dot2_f32_bf16 v117, v154, v115, v117
    v_dot2_f32_bf16 v116, v139, v115, v116
    v_dot2_f32_bf16 v117, v155, v115, v117
    v_dot2_f32_bf16 v116, v140, v115, v116
    v_dot2_f32_bf16 v117, v156, v115, v117
    v_dot2_f32_bf16 v116, v141, v115, v116
    v_dot2_f32_bf16 v117, v157, v115, v117
    v_dot2_f32_bf16 v116, v142, v115, v116
    v_dot2_f32_bf16 v117, v158, v115, v117
    v_dot2_f32_bf16 v116, v143, v115, v116
    v_dot2_f32_bf16 v117, v159, v115, v117
    s_nop 2
    v_permlane32_swap_b32 v116, v117
    v_add_f32 v116, v116, v117
    buffer_store_dword v116, v112, s[8:11], s54 offen sc0 sc1
pk_c_end:
    v_mfma_f32_32x32x16_bf16 v[40:55], v[84:87], v[124:127], v[8:23]
    ds_read_b128 v[80:83], v104 offset:42560
    v_exp_f32 v24, v24
    v_exp_f32 v25, v25
    v_exp_f32 v26, v26
    v_exp_f32 v27, v27
    v_exp_f32 v28, v28
    v_exp_f32 v29, v29
    v_mfma_f32_32x32x16_bf16 v[56:71], v[100:103], v[76:79], v[56:71]
    v_exp_f32 v30, v30
    v_exp_f32 v31, v31
    v_cvt_pk_bf16_f32 v72, v24, v25
    v_cvt_pk_bf16_f32 v73, v26, v27
    v_cvt_pk_bf16_f32 v74, v28, v29
    v_cvt_pk_bf16_f32 v75, v30, v31
    v_exp_f32 v32, v32
    v_exp_f32 v33, v33
    s_waitcnt lgkmcnt(0)
    v_mfma_f32_32x32x16_bf16 v[56:71], v[88:91], v[72:75], v[56:71]
    ds_read_b128 v[96:99], v105 offset:40432
    ds_read_b128 v[100:103], v111 offset:40432
    v_exp_f32 v34, v34
    v_exp_f32 v35, v35
    v_exp_f32 v36, v36
    v_exp_f32 v37, v37
    v_exp_f32 v38, v38
    v_exp_f32 v39, v39
    v_cvt_pk_bf16_f32 v76, v32, v33
    v_cvt_pk_bf16_f32 v77, v34, v35
    v_cvt_pk_bf16_f32 v78, v36, v37
    v_cvt_pk_bf16_f32 v79, v38, v39
    v_mfma_f32_32x32x16_bf16 v[24:39], v[80:83], v[124:127], v[8:23]
    ds_read_b128 v[84:87], v104 offset:44688
    v_exp_f32 v40, v40
    v_exp_f32 v41, v41
    v_exp_f32 v42, v42
    v_exp_f32 v43, v43
    v_exp_f32 v44, v44
    v_exp_f32 v45, v45
    v_mfma_f32_32x32x16_bf16 v[56:71], v[92:95], v[76:79], v[56:71]
    v_exp_f32 v46, v46
    v_exp_f32 v47, v47
    v_cvt_pk_bf16_f32 v72, v40, v41
    v_cvt_pk_bf16_f32 v73, v42, v43
    v_cvt_pk_bf16_f32 v74, v44, v45
    v_cvt_pk_bf16_f32 v75, v46, v47
    v_exp_f32 v48, v48
    v_exp_f32 v49, v49
    s_waitcnt lgkmcnt(0)
    v_mfma_f32_32x32x16_bf16 v[56:71], v[96:99], v[72:75], v[56:71]
    ds_read_b128 v[88:91], v105 offset:42560
    ds_read_b128 v[92:95], v111 offset:42560
    v_exp_f32 v50, v50
    v_exp_f32 v51, v51
    v_exp_f32 v52, v52
    v_exp_f32 v53, v53
    v_exp_f32 v54, v54
    v_exp_f32 v55, v55
    v_cvt_pk_bf16_f32 v76, v48, v49
    v_cvt_pk_bf16_f32 v77, v50, v51
    v_cvt_pk_bf16_f32 v78, v52, v53
    v_cvt_pk_bf16_f32 v79, v54, v55
    v_mfma_f32_32x32x16_bf16 v[40:55], v[84:87], v[124:127], v[8:23]
    ds_read_b128 v[80:83], v104 offset:46816
    v_exp_f32 v24, v24
    v_exp_f32 v25, v25
    v_exp_f32 v26, v26
    v_exp_f32 v27, v27
    v_exp_f32 v28, v28
    v_exp_f32 v29, v29
    v_mfma_f32_32x32x16_bf16 v[56:71], v[100:103], v[76:79], v[56:71]
    v_exp_f32 v30, v30
    v_exp_f32 v31, v31
    v_cvt_pk_bf16_f32 v72, v24, v25
    v_cvt_pk_bf16_f32 v73, v26, v27
    v_cvt_pk_bf16_f32 v74, v28, v29
    v_cvt_pk_bf16_f32 v75, v30, v31
    v_exp_f32 v32, v32
    v_exp_f32 v33, v33
    s_waitcnt lgkmcnt(0)
    v_mfma_f32_32x32x16_bf16 v[56:71], v[88:91], v[72:75], v[56:71]
    ds_read_b128 v[96:99], v105 offset:44688
    ds_read_b128 v[100:103], v111 offset:44688
    v_exp_f32 v34, v34
    v_exp_f32 v35, v35
    v_exp_f32 v36, v36
    v_exp_f32 v37, v37
    v_exp_f32 v38, v38
    v_exp_f32 v39, v39
    v_cvt_pk_bf16_f32 v76, v32, v33
    v_cvt_pk_bf16_f32 v77, v34, v35
    v_cvt_pk_bf16_f32 v78, v36, v37
    v_cvt_pk_bf16_f32 v79, v38, v39
    v_mfma_f32_32x32x16_bf16 v[24:39], v[80:83], v[124:127], v[8:23]
    ds_read_b128 v[84:87], v104 offset:48944
    v_exp_f32 v40, v40
    v_exp_f32 v41, v41
    v_exp_f32 v42, v42
    v_exp_f32 v43, v43
    v_exp_f32 v44, v44
    v_exp_f32 v45, v45
    v_mfma_f32_32x32x16_bf16 v[56:71], v[92:95], v[76:79], v[56:71]
    v_exp_f32 v46, v46
    v_exp_f32 v47, v47
    v_cvt_pk_bf16_f32 v72, v40, v41
    v_cvt_pk_bf16_f32 v73, v42, v43
    v_cvt_pk_bf16_f32 v74, v44, v45
    v_cvt_pk_bf16_f32 v75, v46, v47
    v_exp_f32 v48, v48
    v_exp_f32 v49, v49
    s_waitcnt lgkmcnt(0)
    v_mfma_f32_32x32x16_bf16 v[56:71], v[96:99], v[72:75], v[56:71]
    ds_read_b128 v[88:91], v105 offset:46816
    ds_read_b128 v[92:95], v111 offset:46816
    v_exp_f32 v50, v50
    v_exp_f32 v51, v51
    v_exp_f32 v52, v52
    v_exp_f32 v53, v53
    v_exp_f32 v54, v54
    v_exp_f32 v55, v55
    v_cvt_pk_bf16_f32 v76, v48, v49
    v_cvt_pk_bf16_f32 v77, v50, v51
    v_cvt_pk_bf16_f32 v78, v52, v53
    v_cvt_pk_bf16_f32 v79, v54, v55
    v_mov_b32 v112, 0
    v_mov_b32 v113, 1
    s_cmp_eq_u32 s57, 0
    s_cbranch_scc1 pk_f_1
    s_lshl_b32 s30, s58, 7
    s_add_u32 s30, s30, 26501120
    s_waitcnt vmcnt(0)
    s_mov_b64 exec, 1
    buffer_store_dword v113, v112, s[8:11], s30 offen sc0 sc1
    s_mov_b64 exec, -1
pk_f_1:
    s_and_b32 s30, s18, 0x33
    s_cmp_lg_u32 s30, 0
    s_cbranch_scc1 pk_f_end
    s_lshl_b32 s30, s22, 1
    s_add_u32 s30, s30, s20
    s_lshl_b32 s31, s21, 5
    s_add_u32 s30, s30, s31
    s_lshl_b32 s30, s30, 7
    s_add_u32 s30, s30, 26599424
    s_waitcnt vmcnt(0)
    s_mov_b64 exec, 1
    buffer_store_dword v113, v112, s[8:11], s30 offen sc0 sc1
    s_mov_b64 exec, -1
pk_f_end:
    v_mfma_f32_32x32x16_bf16 v[40:55], v[84:87], v[124:127], v[8:23]
    ds_read_b128 v[80:83], v104 offset:51072
    v_exp_f32 v24, v24
    v_exp_f32 v25, v25
    v_exp_f32 v26, v26
    v_exp_f32 v27, v27
    v_exp_f32 v28, v28
    v_exp_f32 v29, v29
    v_mfma_f32_32x32x16_bf16 v[56:71], v[100:103], v[76:79], v[56:71]
    v_exp_f32 v30, v30
    v_exp_f32 v31, v31
    v_cvt_pk_bf16_f32 v72, v24, v25
    v_cvt_pk_bf16_f32 v73, v26, v27
    v_cvt_pk_bf16_f32 v74, v28, v29
    v_cvt_pk_bf16_f32 v75, v30, v31
    v_exp_f32 v32, v32
    v_exp_f32 v33, v33
    s_waitcnt lgkmcnt(0)
    v_mfma_f32_32x32x16_bf16 v[56:71], v[88:91], v[72:75], v[56:71]
    ds_read_b128 v[96:99], v105 offset:48944
    ds_read_b128 v[100:103], v111 offset:48944
    v_exp_f32 v34, v34
    v_exp_f32 v35, v35
    v_exp_f32 v36, v36
    v_exp_f32 v37, v37
    v_exp_f32 v38, v38
    v_exp_f32 v39, v39
    v_cvt_pk_bf16_f32 v76, v32, v33
    v_cvt_pk_bf16_f32 v77, v34, v35
    v_cvt_pk_bf16_f32 v78, v36, v37
    v_cvt_pk_bf16_f32 v79, v38, v39
    v_mfma_f32_32x32x16_bf16 v[24:39], v[80:83], v[124:127], v[8:23]
    ds_read_b128 v[84:87], v104 offset:53200
    v_exp_f32 v40, v40
    v_exp_f32 v41, v41
    v_exp_f32 v42, v42
    v_exp_f32 v43, v43
    v_exp_f32 v44, v44
    v_exp_f32 v45, v45
    v_mfma_f32_32x32x16_bf16 v[56:71], v[92:95], v[76:79], v[56:71]
    v_exp_f32 v46, v46
    v_exp_f32 v47, v47
    v_cvt_pk_bf16_f32 v72, v40, v41
    v_cvt_pk_bf16_f32 v73, v42, v43
    v_cvt_pk_bf16_f32 v74, v44, v45
    v_cvt_pk_bf16_f32 v75, v46, v47
    v_exp_f32 v48, v48
    v_exp_f32 v49, v49
    s_waitcnt lgkmcnt(0)
    v_mfma_f32_32x32x16_bf16 v[56:71], v[96:99], v[72:75], v[56:71]
    ds_read_b128 v[88:91], v105 offset:51072
    ds_read_b128 v[92:95], v111 offset:51072
    v_exp_f32 v50, v50
    v_exp_f32 v51, v51
    v_exp_f32 v52, v52
    v_exp_f32 v53, v53
    v_exp_f32 v54, v54
    v_exp_f32 v55, v55
    v_cvt_pk_bf16_f32 v76, v48, v49
    v_cvt_pk_bf16_f32 v77, v50, v51
    v_cvt_pk_bf16_f32 v78, v52, v53
    v_cvt_pk_bf16_f32 v79, v54, v55
    v_add_u32 v104, 51072, v104
    v_add_u32 v105, 51072, v105
    v_add_u32 v111, 51072, v111
    v_mfma_f32_32x32x16_bf16 v[40:55], v[84:87], v[124:127], v[8:23]
    ds_read_b128 v[80:83], v104 offset:4256
    v_exp_f32 v24, v24
    v_exp_f32 v25, v25
    v_exp_f32 v26, v26
    v_exp_f32 v27, v27
    v_exp_f32 v28, v28
    v_exp_f32 v29, v29
    v_mfma_f32_32x32x16_bf16 v[56:71], v[100:103], v[76:79], v[56:71]
    v_exp_f32 v30, v30
    v_exp_f32 v31, v31
    v_cvt_pk_bf16_f32 v72, v24, v25
    v_cvt_pk_bf16_f32 v73, v26, v27
    v_cvt_pk_bf16_f32 v74, v28, v29
    v_cvt_pk_bf16_f32 v75, v30, v31
    v_exp_f32 v32, v32
    v_exp_f32 v33, v33
    s_waitcnt lgkmcnt(0)
    v_mfma_f32_32x32x16_bf16 v[56:71], v[88:91], v[72:75], v[56:71]
    ds_read_b128 v[96:99], v105 offset:2128
    ds_read_b128 v[100:103], v111 offset:2128
    v_exp_f32 v34, v34
    v_exp_f32 v35, v35
    v_exp_f32 v36, v36
    v_exp_f32 v37, v37
    v_exp_f32 v38, v38
    v_exp_f32 v39, v39
    v_cvt_pk_bf16_f32 v76, v32, v33
    v_cvt_pk_bf16_f32 v77, v34, v35
    v_cvt_pk_bf16_f32 v78, v36, v37
    v_cvt_pk_bf16_f32 v79, v38, v39
    v_mfma_f32_32x32x16_bf16 v[24:39], v[80:83], v[124:127], v[8:23]
    ds_read_b128 v[84:87], v104 offset:6384
    v_exp_f32 v40, v40
    v_exp_f32 v41, v41
    v_exp_f32 v42, v42
    v_exp_f32 v43, v43
    v_exp_f32 v44, v44
    v_exp_f32 v45, v45
    v_mfma_f32_32x32x16_bf16 v[56:71], v[92:95], v[76:79], v[56:71]
    v_exp_f32 v46, v46
    v_exp_f32 v47, v47
    v_cvt_pk_bf16_f32 v72, v40, v41
    v_cvt_pk_bf16_f32 v73, v42, v43
    v_cvt_pk_bf16_f32 v74, v44, v45
    v_cvt_pk_bf16_f32 v75, v46, v47
    v_exp_f32 v48, v48
    v_exp_f32 v49, v49
    s_waitcnt lgkmcnt(0)
    v_mfma_f32_32x32x16_bf16 v[56:71], v[96:99], v[72:75], v[56:71]
    ds_read_b128 v[88:91], v105 offset:4256
    ds_read_b128 v[92:95], v111 offset:4256
    v_exp_f32 v50, v50
    v_exp_f32 v51, v51
    v_exp_f32 v52, v52
    v_exp_f32 v53, v53
    v_exp_f32 v54, v54
    v_exp_f32 v55, v55
    v_cvt_pk_bf16_f32 v76, v48, v49
    v_cvt_pk_bf16_f32 v77, v50, v51
    v_cvt_pk_bf16_f32 v78, v52, v53
    v_cvt_pk_bf16_f32 v79, v54, v55
    v_mfma_f32_32x32x16_bf16 v[40:55], v[84:87], v[124:127], v[8:23]
    ds_read_b128 v[80:83], v104 offset:8512
    v_exp_f32 v24, v24
    v_exp_f32 v25, v25
    v_exp_f32 v26, v26
    v_exp_f32 v27, v27
    v_exp_f32 v28, v28
    v_exp_f32 v29, v29
    v_mfma_f32_32x32x16_bf16 v[56:71], v[100:103], v[76:79], v[56:71]
    v_exp_f32 v30, v30
    v_exp_f32 v31, v31
    v_cvt_pk_bf16_f32 v72, v24, v25
    v_cvt_pk_bf16_f32 v73, v26, v27
    v_cvt_pk_bf16_f32 v74, v28, v29
    v_cvt_pk_bf16_f32 v75, v30, v31
    v_exp_f32 v32, v32
    v_exp_f32 v33, v33
    s_waitcnt lgkmcnt(0)
    v_mfma_f32_32x32x16_bf16 v[56:71], v[88:91], v[72:75], v[56:71]
    ds_read_b128 v[96:99], v105 offset:6384
    ds_read_b128 v[100:103], v111 offset:6384
    v_exp_f32 v34, v34
    v_exp_f32 v35, v35
    v_exp_f32 v36, v36
    v_exp_f32 v37, v37
    v_exp_f32 v38, v38
    v_exp_f32 v39, v39
    v_cvt_pk_bf16_f32 v76, v32, v33
    v_cvt_pk_bf16_f32 v77, v34, v35
    v_cvt_pk_bf16_f32 v78, v36, v37
    v_cvt_pk_bf16_f32 v79, v38, v39
    v_mfma_f32_32x32x16_bf16 v[24:39], v[80:83], v[124:127], v[8:23]
    ds_read_b128 v[84:87], v104 offset:10640
    v_exp_f32 v40, v40
    v_exp_f32 v41, v41
    v_exp_f32 v42, v42
    v_exp_f32 v43, v43
    v_exp_f32 v44, v44
    v_exp_f32 v45, v45
    v_mfma_f32_32x32x16_bf16 v[56:71], v[92:95], v[76:79], v[56:71]
    v_exp_f32 v46, v46
    v_exp_f32 v47, v47
    v_cvt_pk_bf16_f32 v72, v40, v41
    v_cvt_pk_bf16_f32 v73, v42, v43
    v_cvt_pk_bf16_f32 v74, v44, v45
    v_cvt_pk_bf16_f32 v75, v46, v47
    v_exp_f32 v48, v48
    v_exp_f32 v49, v49
    s_waitcnt lgkmcnt(0)
    v_mfma_f32_32x32x16_bf16 v[56:71], v[96:99], v[72:75], v[56:71]
    ds_read_b128 v[88:91], v105 offset:8512
    ds_read_b128 v[92:95], v111 offset:8512
    v_exp_f32 v50, v50
    v_exp_f32 v51, v51
    v_exp_f32 v52, v52
    v_exp_f32 v53, v53
    v_exp_f32 v54, v54
    v_exp_f32 v55, v55
    v_cvt_pk_bf16_f32 v76, v48, v49
    v_cvt_pk_bf16_f32 v77, v50, v51
    v_cvt_pk_bf16_f32 v78, v52, v53
    v_cvt_pk_bf16_f32 v79, v54, v55
    s_setprio 2
    v_mfma_f32_32x32x16_bf16 v[40:55], v[84:87], v[124:127], v[8:23]
    ds_read_b128 v[80:83], v104 offset:12768
    v_exp_f32 v24, v24
    v_exp_f32 v25, v25
    v_exp_f32 v26, v26
    v_exp_f32 v27, v27
    v_exp_f32 v28, v28
    v_exp_f32 v29, v29
    v_mfma_f32_32x32x16_bf16 v[56:71], v[100:103], v[76:79], v[56:71]
    v_exp_f32 v30, v30
    v_exp_f32 v31, v31
    v_cvt_pk_bf16_f32 v72, v24, v25
    v_cvt_pk_bf16_f32 v73, v26, v27
    v_cvt_pk_bf16_f32 v74, v28, v29
    v_cvt_pk_bf16_f32 v75, v30, v31
    v_exp_f32 v32, v32
    v_exp_f32 v33, v33
    s_waitcnt lgkmcnt(0)
    v_mfma_f32_32x32x16_bf16 v[56:71], v[88:91], v[72:75], v[56:71]
    ds_read_b128 v[96:99], v105 offset:10640
    ds_read_b128 v[100:103], v111 offset:10640
    v_exp_f32 v34, v34
    v_exp_f32 v35, v35
    v_exp_f32 v36, v36
    v_exp_f32 v37, v37
    v_exp_f32 v38, v38
    v_exp_f32 v39, v39
    v_cvt_pk_bf16_f32 v76, v32, v33
    v_cvt_pk_bf16_f32 v77, v34, v35
    v_cvt_pk_bf16_f32 v78, v36, v37
    v_cvt_pk_bf16_f32 v79, v38, v39
    v_mfma_f32_32x32x16_bf16 v[24:39], v[80:83], v[124:127], v[8:23]
    ds_read_b128 v[84:87], v104 offset:14896
    v_exp_f32 v40, v40
    v_exp_f32 v41, v41
    v_exp_f32 v42, v42
    v_exp_f32 v43, v43
    v_exp_f32 v44, v44
    v_exp_f32 v45, v45
    v_mfma_f32_32x32x16_bf16 v[56:71], v[92:95], v[76:79], v[56:71]
    v_exp_f32 v46, v46
    v_exp_f32 v47, v47
    v_cvt_pk_bf16_f32 v72, v40, v41
    v_cvt_pk_bf16_f32 v73, v42, v43
    v_cvt_pk_bf16_f32 v74, v44, v45
    v_cvt_pk_bf16_f32 v75, v46, v47
    v_exp_f32 v48, v48
    v_exp_f32 v49, v49
    s_waitcnt lgkmcnt(0)
    v_mfma_f32_32x32x16_bf16 v[56:71], v[96:99], v[72:75], v[56:71]
    ds_read_b128 v[88:91], v105 offset:12768
    ds_read_b128 v[92:95], v111 offset:12768
    v_exp_f32 v50, v50
    v_exp_f32 v51, v51
    v_exp_f32 v52, v52
    v_exp_f32 v53, v53
    v_exp_f32 v54, v54
    v_exp_f32 v55, v55
    v_cvt_pk_bf16_f32 v76, v48, v49
    v_cvt_pk_bf16_f32 v77, v50, v51
    v_cvt_pk_bf16_f32 v78, v52, v53
    v_cvt_pk_bf16_f32 v79, v54, v55
    v_mfma_f32_32x32x16_bf16 v[40:55], v[84:87], v[124:127], v[8:23]
    ds_read_b128 v[80:83], v104 offset:17024
    v_exp_f32 v24, v24
    v_exp_f32 v25, v25
    v_exp_f32 v26, v26
    v_exp_f32 v27, v27
    v_exp_f32 v28, v28
    v_exp_f32 v29, v29
    v_mfma_f32_32x32x16_bf16 v[56:71], v[100:103], v[76:79], v[56:71]
    v_exp_f32 v30, v30
    v_exp_f32 v31, v31
    v_cvt_pk_bf16_f32 v72, v24, v25
    v_cvt_pk_bf16_f32 v73, v26, v27
    v_cvt_pk_bf16_f32 v74, v28, v29
    v_cvt_pk_bf16_f32 v75, v30, v31
    v_exp_f32 v32, v32
    v_exp_f32 v33, v33
    s_waitcnt lgkmcnt(0)
    v_mfma_f32_32x32x16_bf16 v[56:71], v[88:91], v[72:75], v[56:71]
    ds_read_b128 v[96:99], v105 offset:14896
    ds_read_b128 v[100:103], v111 offset:14896
    v_exp_f32 v34, v34
    v_exp_f32 v35, v35
    v_exp_f32 v36, v36
    v_exp_f32 v37, v37
    v_exp_f32 v38, v38
    v_exp_f32 v39, v39
    v_cvt_pk_bf16_f32 v76, v32, v33
    v_cvt_pk_bf16_f32 v77, v34, v35
    v_cvt_pk_bf16_f32 v78, v36, v37
    v_cvt_pk_bf16_f32 v79, v38, v39
    v_mfma_f32_32x32x16_bf16 v[24:39], v[80:83], v[124:127], v[8:23]
    ds_read_b128 v[84:87], v104 offset:19152
    v_exp_f32 v40, v40
    v_exp_f32 v41, v41
    v_exp_f32 v42, v42
    v_exp_f32 v43, v43
    v_exp_f32 v44, v44
    v_exp_f32 v45, v45
    v_mfma_f32_32x32x16_bf16 v[56:71], v[92:95], v[76:79], v[56:71]
    v_exp_f32 v46, v46
    v_exp_f32 v47, v47
    v_cvt_pk_bf16_f32 v72, v40, v41
    v_cvt_pk_bf16_f32 v73, v42, v43
    v_cvt_pk_bf16_f32 v74, v44, v45
    v_cvt_pk_bf16_f32 v75, v46, v47
    v_exp_f32 v48, v48
    v_exp_f32 v49, v49
    s_waitcnt lgkmcnt(0)
    v_mfma_f32_32x32x16_bf16 v[56:71], v[96:99], v[72:75], v[56:71]
    ds_read_b128 v[88:91], v105 offset:17024
    ds_read_b128 v[92:95], v111 offset:17024
    v_exp_f32 v50, v50
    v_exp_f32 v51, v51
    v_exp_f32 v52, v52
    v_exp_f32 v53, v53
    v_exp_f32 v54, v54
    v_exp_f32 v55, v55
    v_cvt_pk_bf16_f32 v76, v48, v49
    v_cvt_pk_bf16_f32 v77, v50, v51
    v_cvt_pk_bf16_f32 v78, v52, v53
    v_cvt_pk_bf16_f32 v79, v54, v55
    v_mfma_f32_32x32x16_bf16 v[40:55], v[84:87], v[124:127], v[8:23]
    ds_read_b128 v[80:83], v104 offset:21280
    v_exp_f32 v24, v24
    v_exp_f32 v25, v25
    v_exp_f32 v26, v26
    v_exp_f32 v27, v27
    v_exp_f32 v28, v28
    v_exp_f32 v29, v29
    v_mfma_f32_32x32x16_bf16 v[56:71], v[100:103], v[76:79], v[56:71]
    v_exp_f32 v30, v30
    v_exp_f32 v31, v31
    v_cvt_pk_bf16_f32 v72, v24, v25
    v_cvt_pk_bf16_f32 v73, v26, v27
    v_cvt_pk_bf16_f32 v74, v28, v29
    v_cvt_pk_bf16_f32 v75, v30, v31
    v_exp_f32 v32, v32
    v_exp_f32 v33, v33
    s_waitcnt lgkmcnt(0)
    v_mfma_f32_32x32x16_bf16 v[56:71], v[88:91], v[72:75], v[56:71]
    ds_read_b128 v[96:99], v105 offset:19152
    ds_read_b128 v[100:103], v111 offset:19152
    v_exp_f32 v34, v34
    v_exp_f32 v35, v35
    v_exp_f32 v36, v36
    v_exp_f32 v37, v37
    v_exp_f32 v38, v38
    v_exp_f32 v39, v39
    v_cvt_pk_bf16_f32 v76, v32, v33
    v_cvt_pk_bf16_f32 v77, v34, v35
    v_cvt_pk_bf16_f32 v78, v36, v37
    v_cvt_pk_bf16_f32 v79, v38, v39
    s_mul_i32 s30, s22, 7
    s_lshr_b32 s30, s30, 2
    v_lshrrev_b32 v112, 4, v1
    v_add_u32 v112, s30, v112
    v_min_u32 v112, 27, v112
    v_and_b32 v113, 7, v1
    v_lshl_add_u32 v112, v112, 3, v113
    v_bfe_u32 v114, v1, 3, 1
    v_mul_u32_u24 v114, 224, v114
    v_add3_u32 v112, v112, v114, 64
    s_mul_i32 s30, s20, 7
    s_lshr_b32 s30, s30, 1
    v_min_u32 v114, 4, v113
    v_add_u32 v114, s30, v114
    v_min_u32 v114, 27, v114
    s_add_u32 s30, s24, 512
    v_lshl_add_u32 v114, v114, 3, s30
    v_cmp_le_u32 vcc, 48, v1
    s_lshl_b32 s30, s24, 3
    s_add_u32 s30, s30, s20
    v_cndmask_b32 v112, v112, v114, vcc
    v_mov_b32 v114, s30
    v_cmp_le_u32 vcc, 56, v1
    s_add_u32 s31, s20, 768
    s_and_b32 s30, s22, 12
    s_lshl_b32 s30, s30, 1
    s_add_u32 s30, s30, s31
    v_cndmask_b32 v112, v112, v114, vcc
    v_writelane_b32 v112, s30, 59
    s_add_u32 s30, s30, 32
    v_writelane_b32 v112, s30, 60
    s_add_u32 s30, s30, 32
    v_writelane_b32 v112, s30, 61
    s_add_u32 s30, s30, 32
    v_writelane_b32 v112, s30, 62
    s_add_u32 s30, s30, 32
    v_writelane_b32 v112, s31, 63
    s_mov_b32 s30, 26501120
    s_mov_b32 s31, 0
    v_lshlrev_b32 v112, 7, v112
    s_bfe_u32 s32, s19, 0x3000c
    s_lshl_b32 s32, s32, 3
    s_lshl_b32 s33, s26, 2
    s_add_u32 s32, s32, s33
    v_and_b32 v114, 3, v1
    v_add_u32 v114, s32, v114
    v_lshlrev_b32 v114, 7, v114
    buffer_load_dword v113, v112, s[8:11], s30 offen sc1
    buffer_load_dword v115, v114, s[8:11], s30 offen sc1
    v_mfma_f32_32x32x16_bf16 v[24:39], v[80:83], v[124:127], v[8:23]
    ds_read_b128 v[84:87], v104 offset:23408
    v_exp_f32 v40, v40
    v_exp_f32 v41, v41
    v_exp_f32 v42, v42
    v_exp_f32 v43, v43
    v_exp_f32 v44, v44
    v_exp_f32 v45, v45
    v_mfma_f32_32x32x16_bf16 v[56:71], v[92:95], v[76:79], v[56:71]
    v_exp_f32 v46, v46
    v_exp_f32 v47, v47
    v_cvt_pk_bf16_f32 v72, v40, v41
    v_cvt_pk_bf16_f32 v73, v42, v43
    v_cvt_pk_bf16_f32 v74, v44, v45
    v_cvt_pk_bf16_f32 v75, v46, v47
    v_exp_f32 v48, v48
    v_exp_f32 v49, v49
    s_waitcnt lgkmcnt(0)
    v_mfma_f32_32x32x16_bf16 v[56:71], v[96:99], v[72:75], v[56:71]
    ds_read_b128 v[88:91], v105 offset:21280
    ds_read_b128 v[92:95], v111 offset:21280
    v_exp_f32 v50, v50
    v_exp_f32 v51, v51
    v_exp_f32 v52, v52
    v_exp_f32 v53, v53
    v_exp_f32 v54, v54
    v_exp_f32 v55, v55
    v_cvt_pk_bf16_f32 v76, v48, v49
    v_cvt_pk_bf16_f32 v77, v50, v51
    v_cvt_pk_bf16_f32 v78, v52, v53
    v_cvt_pk_bf16_f32 v79, v54, v55
    v_mfma_f32_32x32x16_bf16 v[40:55], v[84:87], v[124:127], v[8:23]
    ds_read_b128 v[80:83], v104 offset:25536
    v_exp_f32 v24, v24
    v_exp_f32 v25, v25
    v_exp_f32 v26, v26
    v_exp_f32 v27, v27
    v_exp_f32 v28, v28
    v_exp_f32 v29, v29
    v_mfma_f32_32x32x16_bf16 v[56:71], v[100:103], v[76:79], v[56:71]
    v_exp_f32 v30, v30
    v_exp_f32 v31, v31
    v_cvt_pk_bf16_f32 v72, v24, v25
    v_cvt_pk_bf16_f32 v73, v26, v27
    v_cvt_pk_bf16_f32 v74, v28, v29
    v_cvt_pk_bf16_f32 v75, v30, v31
    v_exp_f32 v32, v32
    v_exp_f32 v33, v33
    s_waitcnt lgkmcnt(0)
    v_mfma_f32_32x32x16_bf16 v[56:71], v[88:91], v[72:75], v[56:71]
    ds_read_b128 v[96:99], v105 offset:23408
    ds_read_b128 v[100:103], v111 offset:23408
    v_exp_f32 v34, v34
    v_exp_f32 v35, v35
    v_exp_f32 v36, v36
    v_exp_f32 v37, v37
    v_exp_f32 v38, v38
    v_exp_f32 v39, v39
    v_cvt_pk_bf16_f32 v76, v32, v33
    v_cvt_pk_bf16_f32 v77, v34, v35
    v_cvt_pk_bf16_f32 v78, v36, v37
    v_cvt_pk_bf16_f32 v79, v38, v39
    v_mfma_f32_32x32x16_bf16 v[24:39], v[80:83], v[124:127], v[8:23]
    ds_read_b128 v[84:87], v104 offset:27664
    v_exp_f32 v40, v40
    v_exp_f32 v41, v41
    v_exp_f32 v42, v42
    v_exp_f32 v43, v43
    v_exp_f32 v44, v44
    v_exp_f32 v45, v45
    v_mfma_f32_32x32x16_bf16 v[56:71], v[92:95], v[76:79], v[56:71]
    v_exp_f32 v46, v46
    v_exp_f32 v47, v47
    v_cvt_pk_bf16_f32 v72, v40, v41
    v_cvt_pk_bf16_f32 v73, v42, v43
    v_cvt_pk_bf16_f32 v74, v44, v45
    v_cvt_pk_bf16_f32 v75, v46, v47
    v_exp_f32 v48, v48
    v_exp_f32 v49, v49
    s_waitcnt lgkmcnt(0)
    v_mfma_f32_32x32x16_bf16 v[56:71], v[96:99], v[72:75], v[56:71]
    ds_read_b128 v[88:91], v105 offset:25536
    ds_read_b128 v[92:95], v111 offset:25536
    v_exp_f32 v50, v50
    v_exp_f32 v51, v51
    v_exp_f32 v52, v52
    v_exp_f32 v53, v53
    v_exp_f32 v54, v54
    v_exp_f32 v55, v55
    v_cvt_pk_bf16_f32 v76, v48, v49
    v_cvt_pk_bf16_f32 v77, v50, v51
    v_cvt_pk_bf16_f32 v78, v52, v53
    v_cvt_pk_bf16_f32 v79, v54, v55
    s_mov_b32 s30, 26501120
    s_mov_b32 s31, 0
pk_p:
    s_waitcnt vmcnt(0)
    v_and_b32 v113, v113, v115
    v_cmp_eq_u32 vcc, 1, v113
    s_add_u32 s31, s31, 1
    s_cmp_eq_u64 vcc, -1
    s_cbranch_scc1 pk_pd
    s_sleep 16
    buffer_load_dword v113, v112, s[8:11], s30 offen sc1
    buffer_load_dword v115, v114, s[8:11], s30 offen sc1
    s_cmp_lt_u32 s31, 524288
    s_cbranch_scc1 pk_p
    s_branch k_end
pk_pd:
    v_mfma_f32_32x32x16_bf16 v[40:55], v[84:87], v[124:127], v[8:23]
    ds_read_b128 v[80:83], v104 offset:29792
    v_exp_f32 v24, v24
    v_exp_f32 v25, v25
    v_exp_f32 v26, v26
    v_exp_f32 v27, v27
    v_exp_f32 v28, v28
    v_exp_f32 v29, v29
    v_mfma_f32_32x32x16_bf16 v[56:71], v[100:103], v[76:79], v[56:71]
    s_mul_i32 s30, s22, 7
    s_min_u32 s31, s20, 6
    s_add_u32 s40, s30, s31
    s_lshl_b32 s30, s40, 15
    s_add_u32 s30, s30, 1081344
    s_cmp_eq_u32 s20, 7
    s_cselect_b32 s30, 0x70000000, s30
    v_add_u32 v112, s30, v3
    s_lshl_b32 s30, s26, 8
    v_xor_b32 v113, s30, v3
    s_mul_i32 s31, s20, 14336
    s_add_u32 s31, s31, 4751360
    s_xor_b32 s30, s28, 1
    s_mul_i32 s30, s30, 114688
    s_add_u32 s30, s30, s31
    v_add_u32 v114, s30, v113
    s_mul_i32 s30, s28, 114688
    s_add_u32 s30, s30, s31
    v_add_u32 v113, s30, v113
    s_lshl_b32 s30, s26, 8
    v_xor_b32 v116, s30, v3
    s_and_b32 s30, s19, 0x7fff
    s_lshl_b32 s30, s30, 4
    s_add_u32 s30, s30, 557056
    v_add_u32 v116, s30, v116
    buffer_load_dwordx4 v[128:131], v112, s[8:11], 0 offen offset:0
    v_exp_f32 v30, v30
    v_exp_f32 v31, v31
    v_cvt_pk_bf16_f32 v72, v24, v25
    v_cvt_pk_bf16_f32 v73, v26, v27
    v_cvt_pk_bf16_f32 v74, v28, v29
    v_cvt_pk_bf16_f32 v75, v30, v31
    v_exp_f32 v32, v32
    v_exp_f32 v33, v33
    s_waitcnt lgkmcnt(0)
    v_mfma_f32_32x32x16_bf16 v[56:71], v[88:91], v[72:75], v[56:71]
    ds_read_b128 v[96:99], v105 offset:27664
    ds_read_b128 v[100:103], v111 offset:27664
    v_exp_f32 v34, v34
    v_exp_f32 v35, v35
    v_exp_f32 v36, v36
    v_exp_f32 v37, v37
    v_exp_f32 v38, v38
    v_exp_f32 v39, v39
    v_cvt_pk_bf16_f32 v76, v32, v33
    v_cvt_pk_bf16_f32 v77, v34, v35
    v_cvt_pk_bf16_f32 v78, v36, v37
    v_cvt_pk_bf16_f32 v79, v38, v39
    v_mfma_f32_32x32x16_bf16 v[24:39], v[80:83], v[124:127], v[8:23]
    ds_read_b128 v[84:87], v104 offset:31920
    v_exp_f32 v40, v40
    v_exp_f32 v41, v41
    v_exp_f32 v42, v42
    v_exp_f32 v43, v43
    v_exp_f32 v44, v44
    v_exp_f32 v45, v45
    v_mfma_f32_32x32x16_bf16 v[56:71], v[92:95], v[76:79], v[56:71]
    buffer_load_dwordx4 v[132:135], v112, s[8:11], 0 offen offset:1024
    buffer_load_dwordx4 v[136:139], v112, s[8:11], 0 offen offset:2048
    v_exp_f32 v46, v46
    v_exp_f32 v47, v47
    v_cvt_pk_bf16_f32 v72, v40, v41
    v_cvt_pk_bf16_f32 v73, v42, v43
    v_cvt_pk_bf16_f32 v74, v44, v45
    v_cvt_pk_bf16_f32 v75, v46, v47
    v_exp_f32 v48, v48
    v_exp_f32 v49, v49
    s_waitcnt lgkmcnt(0)
    v_mfma_f32_32x32x16_bf16 v[56:71], v[96:99], v[72:75], v[56:71]
    ds_read_b128 v[88:91], v105 offset:29792
    ds_read_b128 v[92:95], v111 offset:29792
    v_exp_f32 v50, v50
    v_exp_f32 v51, v51
    v_exp_f32 v52, v52
    v_exp_f32 v53, v53
    v_exp_f32 v54, v54
    v_exp_f32 v55, v55
    v_cvt_pk_bf16_f32 v76, v48, v49
    v_cvt_pk_bf16_f32 v77, v50, v51
    v_cvt_pk_bf16_f32 v78, v52, v53
    v_cvt_pk_bf16_f32 v79, v54, v55
    v_mfma_f32_32x32x16_bf16 v[40:55], v[84:87], v[124:127], v[8:23]
    ds_read_b128 v[80:83], v104 offset:34048
    v_exp_f32 v24, v24
    v_exp_f32 v25, v25
    v_exp_f32 v26, v26
    v_exp_f32 v27, v27
    v_exp_f32 v28, v28
    v_exp_f32 v29, v29
    v_mfma_f32_32x32x16_bf16 v[56:71], v[100:103], v[76:79], v[56:71]
    buffer_load_dwordx4 v[140:143], v112, s[8:11], 0 offen offset:3072
    v_exp_f32 v30, v30
    v_exp_f32 v31, v31
    v_cvt_pk_bf16_f32 v72, v24, v25
    v_cvt_pk_bf16_f32 v73, v26, v27
    v_cvt_pk_bf16_f32 v74, v28, v29
    v_cvt_pk_bf16_f32 v75, v30, v31
    v_exp_f32 v32, v32
    v_exp_f32 v33, v33
    s_waitcnt lgkmcnt(0)
    v_mfma_f32_32x32x16_bf16 v[56:71], v[88:91], v[72:75], v[56:71]
    ds_read_b128 v[96:99], v105 offset:31920
    ds_read_b128 v[100:103], v111 offset:31920
    v_exp_f32 v34, v34
    v_exp_f32 v35, v35
    v_exp_f32 v36, v36
    v_exp_f32 v37, v37
    v_exp_f32 v38, v38
    v_exp_f32 v39, v39
    v_cvt_pk_bf16_f32 v76, v32, v33
    v_cvt_pk_bf16_f32 v77, v34, v35
    v_cvt_pk_bf16_f32 v78, v36, v37
    v_cvt_pk_bf16_f32 v79, v38, v39
    v_mfma_f32_32x32x16_bf16 v[24:39], v[80:83], v[124:127], v[8:23]
    ds_read_b128 v[84:87], v104 offset:36176
    v_exp_f32 v40, v40
    v_exp_f32 v41, v41
    v_exp_f32 v42, v42
    v_exp_f32 v43, v43
    v_exp_f32 v44, v44
    v_exp_f32 v45, v45
    v_mfma_f32_32x32x16_bf16 v[56:71], v[92:95], v[76:79], v[56:71]
    buffer_load_dwordx4 v[144:147], v112, s[8:11], s41 offen offset:0
    buffer_load_dwordx4 v[148:151], v112, s[8:11], s41 offen offset:1024
    v_exp_f32 v46, v46
    v_exp_f32 v47, v47
    v_cvt_pk_bf16_f32 v72, v40, v41
    v_cvt_pk_bf16_f32 v73, v42, v43
    v_cvt_pk_bf16_f32 v74, v44, v45
    v_cvt_pk_bf16_f32 v75, v46, v47
    v_exp_f32 v48, v48
    v_exp_f32 v49, v49
    s_waitcnt lgkmcnt(0)
    v_mfma_f32_32x32x16_bf16 v[56:71], v[96:99], v[72:75], v[56:71]
    ds_read_b128 v[88:91], v105 offset:34048
    ds_read_b128 v[92:95], v111 offset:34048
    v_exp_f32 v50, v50
    v_exp_f32 v51, v51
    v_exp_f32 v52, v52
    v_exp_f32 v53, v53
    v_exp_f32 v54, v54
    v_exp_f32 v55, v55
    v_cvt_pk_bf16_f32 v76, v48, v49
    v_cvt_pk_bf16_f32 v77, v50, v51
    v_cvt_pk_bf16_f32 v78, v52, v53
    v_cvt_pk_bf16_f32 v79, v54, v55
    v_mfma_f32_32x32x16_bf16 v[40:55], v[84:87], v[124:127], v[8:23]
    ds_read_b128 v[80:83], v104 offset:38304
    v_exp_f32 v24, v24
    v_exp_f32 v25, v25
    v_exp_f32 v26, v26
    v_exp_f32 v27, v27
    v_exp_f32 v28, v28
    v_exp_f32 v29, v29
    v_mfma_f32_32x32x16_bf16 v[56:71], v[100:103], v[76:79], v[56:71]
    buffer_load_dwordx4 v[152:155], v112, s[8:11], s41 offen offset:2048
    buffer_load_dwordx4 v[156:159], v112, s[8:11], s41 offen offset:3072
    v_exp_f32 v30, v30
    v_exp_f32 v31, v31
    v_cvt_pk_bf16_f32 v72, v24, v25
    v_cvt_pk_bf16_f32 v73, v26, v27
    v_cvt_pk_bf16_f32 v74, v28, v29
    v_cvt_pk_bf16_f32 v75, v30, v31
    v_exp_f32 v32, v32
    v_exp_f32 v33, v33
    s_waitcnt lgkmcnt(0)
    v_mfma_f32_32x32x16_bf16 v[56:71], v[88:91], v[72:75], v[56:71]
    ds_read_b128 v[96:99], v105 offset:36176
    ds_read_b128 v[100:103], v111 offset:36176
    v_exp_f32 v34, v34
    v_exp_f32 v35, v35
    v_exp_f32 v36, v36
    v_exp_f32 v37, v37
    v_exp_f32 v38, v38
    v_exp_f32 v39, v39
    v_cvt_pk_bf16_f32 v76, v32, v33
    v_cvt_pk_bf16_f32 v77, v34, v35
    v_cvt_pk_bf16_f32 v78, v36, v37
    v_cvt_pk_bf16_f32 v79, v38, v39
    v_mfma_f32_32x32x16_bf16 v[24:39], v[80:83], v[124:127], v[8:23]
    ds_read_b128 v[84:87], v104 offset:40432
    v_exp_f32 v40, v40
    v_exp_f32 v41, v41
    v_exp_f32 v42, v42
    v_exp_f32 v43, v43
    v_exp_f32 v44, v44
    v_exp_f32 v45, v45
    v_mfma_f32_32x32x16_bf16 v[56:71], v[92:95], v[76:79], v[56:71]
    buffer_load_dwordx4 v[160:163], v112, s[8:11], s42 offen offset:0
    v_exp_f32 v46, v46
    v_exp_f32 v47, v47
    v_cvt_pk_bf16_f32 v72, v40, v41
    v_cvt_pk_bf16_f32 v73, v42, v43
    v_cvt_pk_bf16_f32 v74, v44, v45
    v_cvt_pk_bf16_f32 v75, v46, v47
    v_exp_f32 v48, v48
    v_exp_f32 v49, v49
    s_waitcnt lgkmcnt(0)
    v_mfma_f32_32x32x16_bf16 v[56:71], v[96:99], v[72:75], v[56:71]
    ds_read_b128 v[88:91], v105 offset:38304
    ds_read_b128 v[92:95], v111 offset:38304
    v_exp_f32 v50, v50
    v_exp_f32 v51, v51
    v_exp_f32 v52, v52
    v_exp_f32 v53, v53
    v_exp_f32 v54, v54
    v_exp_f32 v55, v55
    v_cvt_pk_bf16_f32 v76, v48, v49
    v_cvt_pk_bf16_f32 v77, v50, v51
    v_cvt_pk_bf16_f32 v78, v52, v53
    v_cvt_pk_bf16_f32 v79, v54, v55
    v_mfma_f32_32x32x16_bf16 v[40:55], v[84:87], v[124:127], v[8:23]
    ds_read_b128 v[80:83], v104 offset:42560
    v_exp_f32 v24, v24
    v_exp_f32 v25, v25
    v_exp_f32 v26, v26
    v_exp_f32 v27, v27
    v_exp_f32 v28, v28
    v_exp_f32 v29, v29
    v_mfma_f32_32x32x16_bf16 v[56:71], v[100:103], v[76:79], v[56:71]
    buffer_load_dwordx4 v[164:167], v112, s[8:11], s42 offen offset:1024
    buffer_load_dwordx4 v[168:171], v112, s[8:11], s42 offen offset:2048
    v_exp_f32 v30, v30
    v_exp_f32 v31, v31
    v_cvt_pk_bf16_f32 v72, v24, v25
    v_cvt_pk_bf16_f32 v73, v26, v27
    v_cvt_pk_bf16_f32 v74, v28, v29
    v_cvt_pk_bf16_f32 v75, v30, v31
    v_exp_f32 v32, v32
    v_exp_f32 v33, v33
    s_waitcnt lgkmcnt(0)
    v_mfma_f32_32x32x16_bf16 v[56:71], v[88:91], v[72:75], v[56:71]
    ds_read_b128 v[96:99], v105 offset:40432
    ds_read_b128 v[100:103], v111 offset:40432
    v_exp_f32 v34, v34
    v_exp_f32 v35, v35
    v_exp_f32 v36, v36
    v_exp_f32 v37, v37
    v_exp_f32 v38, v38
    v_exp_f32 v39, v39
    v_cvt_pk_bf16_f32 v76, v32, v33
    v_cvt_pk_bf16_f32 v77, v34, v35
    v_cvt_pk_bf16_f32 v78, v36, v37
    v_cvt_pk_bf16_f32 v79, v38, v39
    v_mfma_f32_32x32x16_bf16 v[24:39], v[80:83], v[124:127], v[8:23]
    ds_read_b128 v[84:87], v104 offset:44688
    v_exp_f32 v40, v40
    v_exp_f32 v41, v41
    v_exp_f32 v42, v42
    v_exp_f32 v43, v43
    v_exp_f32 v44, v44
    v_exp_f32 v45, v45
    v_mfma_f32_32x32x16_bf16 v[56:71], v[92:95], v[76:79], v[56:71]
    buffer_load_dwordx4 v[172:175], v112, s[8:11], s42 offen offset:3072
    buffer_load_dwordx4 v[176:179], v112, s[8:11], s43 offen offset:0
    v_exp_f32 v46, v46
    v_exp_f32 v47, v47
    v_cvt_pk_bf16_f32 v72, v40, v41
    v_cvt_pk_bf16_f32 v73, v42, v43
    v_cvt_pk_bf16_f32 v74, v44, v45
    v_cvt_pk_bf16_f32 v75, v46, v47
    v_exp_f32 v48, v48
    v_exp_f32 v49, v49
    s_waitcnt lgkmcnt(0)
    v_mfma_f32_32x32x16_bf16 v[56:71], v[96:99], v[72:75], v[56:71]
    ds_read_b128 v[88:91], v105 offset:42560
    ds_read_b128 v[92:95], v111 offset:42560
    v_exp_f32 v50, v50
    v_exp_f32 v51, v51
    v_exp_f32 v52, v52
    v_exp_f32 v53, v53
    v_exp_f32 v54, v54
    v_exp_f32 v55, v55
    v_cvt_pk_bf16_f32 v76, v48, v49
    v_cvt_pk_bf16_f32 v77, v50, v51
    v_cvt_pk_bf16_f32 v78, v52, v53
    v_cvt_pk_bf16_f32 v79, v54, v55
    v_mfma_f32_32x32x16_bf16 v[40:55], v[84:87], v[124:127], v[8:23]
    ds_read_b128 v[80:83], v104 offset:46816
    v_exp_f32 v24, v24
    v_exp_f32 v25, v25
    v_exp_f32 v26, v26
    v_exp_f32 v27, v27
    v_exp_f32 v28, v28
    v_exp_f32 v29, v29
    v_mfma_f32_32x32x16_bf16 v[56:71], v[100:103], v[76:79], v[56:71]
    buffer_load_dwordx4 v[180:183], v112, s[8:11], s43 offen offset:1024
    v_exp_f32 v30, v30
    v_exp_f32 v31, v31
    v_cvt_pk_bf16_f32 v72, v24, v25
    v_cvt_pk_bf16_f32 v73, v26, v27
    v_cvt_pk_bf16_f32 v74, v28, v29
    v_cvt_pk_bf16_f32 v75, v30, v31
    v_exp_f32 v32, v32
    v_exp_f32 v33, v33
    s_waitcnt lgkmcnt(0)
    v_mfma_f32_32x32x16_bf16 v[56:71], v[88:91], v[72:75], v[56:71]
    ds_read_b128 v[96:99], v105 offset:44688
    ds_read_b128 v[100:103], v111 offset:44688
    v_exp_f32 v34, v34
    v_exp_f32 v35, v35
    v_exp_f32 v36, v36
    v_exp_f32 v37, v37
    v_exp_f32 v38, v38
    v_exp_f32 v39, v39
    v_cvt_pk_bf16_f32 v76, v32, v33
    v_cvt_pk_bf16_f32 v77, v34, v35
    v_cvt_pk_bf16_f32 v78, v36, v37
    v_cvt_pk_bf16_f32 v79, v38, v39
    v_mfma_f32_32x32x16_bf16 v[24:39], v[80:83], v[124:127], v[8:23]
    ds_read_b128 v[84:87], v104 offset:48944
    v_exp_f32 v40, v40
    v_exp_f32 v41, v41
    v_exp_f32 v42, v42
    v_exp_f32 v43, v43
    v_exp_f32 v44, v44
    v_exp_f32 v45, v45
    v_mfma_f32_32x32x16_bf16 v[56:71], v[92:95], v[76:79], v[56:71]
    buffer_load_dwordx4 v[184:187], v112, s[8:11], s43 offen offset:2048
    buffer_load_dwordx4 v[188:191], v112, s[8:11], s43 offen offset:3072
    v_exp_f32 v46, v46
    v_exp_f32 v47, v47
    v_cvt_pk_bf16_f32 v72, v40, v41
    v_cvt_pk_bf16_f32 v73, v42, v43
    v_cvt_pk_bf16_f32 v74, v44, v45
    v_cvt_pk_bf16_f32 v75, v46, v47
    v_exp_f32 v48, v48
    v_exp_f32 v49, v49
    s_waitcnt lgkmcnt(0)
    v_mfma_f32_32x32x16_bf16 v[56:71], v[96:99], v[72:75], v[56:71]
    ds_read_b128 v[88:91], v105 offset:46816
    ds_read_b128 v[92:95], v111 offset:46816
    v_exp_f32 v50, v50
    v_exp_f32 v51, v51
    v_exp_f32 v52, v52
    v_exp_f32 v53, v53
    v_exp_f32 v54, v54
    v_exp_f32 v55, v55
    v_cvt_pk_bf16_f32 v76, v48, v49
    v_cvt_pk_bf16_f32 v77, v50, v51
    v_cvt_pk_bf16_f32 v78, v52, v53
    v_cvt_pk_bf16_f32 v79, v54, v55
    s_setprio 1
    v_mfma_f32_32x32x16_bf16 v[40:55], v[84:87], v[124:127], v[8:23]
    ds_read_b128 v[80:83], v104 offset:51072
    v_exp_f32 v24, v24
    v_exp_f32 v25, v25
    v_exp_f32 v26, v26
    v_exp_f32 v27, v27
    v_exp_f32 v28, v28
    v_exp_f32 v29, v29
    v_mfma_f32_32x32x16_bf16 v[56:71], v[100:103], v[76:79], v[56:71]
    buffer_load_dwordx4 v[192:195], v112, s[8:11], s44 offen offset:0
    buffer_load_dwordx4 v[196:199], v112, s[8:11], s44 offen offset:1024
    v_exp_f32 v30, v30
    v_exp_f32 v31, v31
    v_cvt_pk_bf16_f32 v72, v24, v25
    v_cvt_pk_bf16_f32 v73, v26, v27
    v_cvt_pk_bf16_f32 v74, v28, v29
    v_cvt_pk_bf16_f32 v75, v30, v31
    v_exp_f32 v32, v32
    v_exp_f32 v33, v33
    s_waitcnt lgkmcnt(0)
    v_mfma_f32_32x32x16_bf16 v[56:71], v[88:91], v[72:75], v[56:71]
    ds_read_b128 v[96:99], v105 offset:48944
    ds_read_b128 v[100:103], v111 offset:48944
    v_exp_f32 v34, v34
    v_exp_f32 v35, v35
    v_exp_f32 v36, v36
    v_exp_f32 v37, v37
    v_exp_f32 v38, v38
    v_exp_f32 v39, v39
    v_cvt_pk_bf16_f32 v76, v32, v33
    v_cvt_pk_bf16_f32 v77, v34, v35
    v_cvt_pk_bf16_f32 v78, v36, v37
    v_cvt_pk_bf16_f32 v79, v38, v39
    v_mfma_f32_32x32x16_bf16 v[24:39], v[80:83], v[124:127], v[8:23]
    ds_read_b128 v[84:87], v104 offset:53200
    v_exp_f32 v40, v40
    v_exp_f32 v41, v41
    v_exp_f32 v42, v42
    v_exp_f32 v43, v43
    v_exp_f32 v44, v44
    v_exp_f32 v45, v45
    v_mfma_f32_32x32x16_bf16 v[56:71], v[92:95], v[76:79], v[56:71]
    buffer_load_dwordx4 v[200:203], v112, s[8:11], s44 offen offset:2048
    v_exp_f32 v46, v46
    v_exp_f32 v47, v47
    v_cvt_pk_bf16_f32 v72, v40, v41
    v_cvt_pk_bf16_f32 v73, v42, v43
    v_cvt_pk_bf16_f32 v74, v44, v45
    v_cvt_pk_bf16_f32 v75, v46, v47
    v_exp_f32 v48, v48
    v_exp_f32 v49, v49
    s_waitcnt lgkmcnt(0)
    v_mfma_f32_32x32x16_bf16 v[56:71], v[96:99], v[72:75], v[56:71]
    ds_read_b128 v[88:91], v105 offset:51072
    ds_read_b128 v[92:95], v111 offset:51072
    v_exp_f32 v50, v50
    v_exp_f32 v51, v51
    v_exp_f32 v52, v52
    v_exp_f32 v53, v53
    v_exp_f32 v54, v54
    v_exp_f32 v55, v55
    v_cvt_pk_bf16_f32 v76, v48, v49
    v_cvt_pk_bf16_f32 v77, v50, v51
    v_cvt_pk_bf16_f32 v78, v52, v53
    v_cvt_pk_bf16_f32 v79, v54, v55
    v_add_u32 v104, 51072, v104
    v_add_u32 v105, 51072, v105
    v_add_u32 v111, 51072, v111
    v_mfma_f32_32x32x16_bf16 v[40:55], v[84:87], v[124:127], v[8:23]
    ds_read_b128 v[80:83], v104 offset:4256
    v_exp_f32 v24, v24
    v_exp_f32 v25, v25
    v_exp_f32 v26, v26
    v_exp_f32 v27, v27
    v_exp_f32 v28, v28
    v_exp_f32 v29, v29
    v_mfma_f32_32x32x16_bf16 v[56:71], v[100:103], v[76:79], v[56:71]
    buffer_load_dwordx4 v[204:207], v112, s[8:11], s44 offen offset:3072
    buffer_load_dwordx4 v[208:211], v112, s[8:11], s45 offen offset:0
    v_exp_f32 v30, v30
    v_exp_f32 v31, v31
    v_cvt_pk_bf16_f32 v72, v24, v25
    v_cvt_pk_bf16_f32 v73, v26, v27
    v_cvt_pk_bf16_f32 v74, v28, v29
    v_cvt_pk_bf16_f32 v75, v30, v31
    v_exp_f32 v32, v32
    v_exp_f32 v33, v33
    s_waitcnt lgkmcnt(0)
    v_mfma_f32_32x32x16_bf16 v[56:71], v[88:91], v[72:75], v[56:71]
    ds_read_b128 v[96:99], v105 offset:2128
    ds_read_b128 v[100:103], v111 offset:2128
    v_exp_f32 v34, v34
    v_exp_f32 v35, v35
    v_exp_f32 v36, v36
    v_exp_f32 v37, v37
    v_exp_f32 v38, v38
    v_exp_f32 v39, v39
    v_cvt_pk_bf16_f32 v76, v32, v33
    v_cvt_pk_bf16_f32 v77, v34, v35
    v_cvt_pk_bf16_f32 v78, v36, v37
    v_cvt_pk_bf16_f32 v79, v38, v39
    v_mfma_f32_32x32x16_bf16 v[24:39], v[80:83], v[124:127], v[8:23]
    ds_read_b128 v[84:87], v104 offset:6384
    v_exp_f32 v40, v40
    v_exp_f32 v41, v41
    v_exp_f32 v42, v42
    v_exp_f32 v43, v43
    v_exp_f32 v44, v44
    v_exp_f32 v45, v45
    v_mfma_f32_32x32x16_bf16 v[56:71], v[92:95], v[76:79], v[56:71]
    buffer_load_dwordx4 v[212:215], v112, s[8:11], s45 offen offset:1024
    buffer_load_dwordx4 v[216:219], v112, s[8:11], s45 offen offset:2048
    v_exp_f32 v46, v46
    v_exp_f32 v47, v47
    v_cvt_pk_bf16_f32 v72, v40, v41
    v_cvt_pk_bf16_f32 v73, v42, v43
    v_cvt_pk_bf16_f32 v74, v44, v45
    v_cvt_pk_bf16_f32 v75, v46, v47
    v_exp_f32 v48, v48
    v_exp_f32 v49, v49
    s_waitcnt lgkmcnt(0)
    v_mfma_f32_32x32x16_bf16 v[56:71], v[96:99], v[72:75], v[56:71]
    ds_read_b128 v[88:91], v105 offset:4256
    ds_read_b128 v[92:95], v111 offset:4256
    v_exp_f32 v50, v50
    v_exp_f32 v51, v51
    v_exp_f32 v52, v52
    v_exp_f32 v53, v53
    v_exp_f32 v54, v54
    v_exp_f32 v55, v55
    v_cvt_pk_bf16_f32 v76, v48, v49
    v_cvt_pk_bf16_f32 v77, v50, v51
    v_cvt_pk_bf16_f32 v78, v52, v53
    v_cvt_pk_bf16_f32 v79, v54, v55
    v_mfma_f32_32x32x16_bf16 v[40:55], v[84:87], v[124:127], v[8:23]
    ds_read_b128 v[80:83], v104 offset:8512
    v_exp_f32 v24, v24
    v_exp_f32 v25, v25
    v_exp_f32 v26, v26
    v_exp_f32 v27, v27
    v_exp_f32 v28, v28
    v_exp_f32 v29, v29
    v_mfma_f32_32x32x16_bf16 v[56:71], v[100:103], v[76:79], v[56:71]
    buffer_load_dwordx4 v[220:223], v112, s[8:11], s45 offen offset:3072
    v_exp_f32 v30, v30
    v_exp_f32 v31, v31
    v_cvt_pk_bf16_f32 v72, v24, v25
    v_cvt_pk_bf16_f32 v73, v26, v27
    v_cvt_pk_bf16_f32 v74, v28, v29
    v_cvt_pk_bf16_f32 v75, v30, v31
    v_exp_f32 v32, v32
    v_exp_f32 v33, v33
    s_waitcnt lgkmcnt(0)
    v_mfma_f32_32x32x16_bf16 v[56:71], v[88:91], v[72:75], v[56:71]
    ds_read_b128 v[96:99], v105 offset:6384
    ds_read_b128 v[100:103], v111 offset:6384
    v_exp_f32 v34, v34
    v_exp_f32 v35, v35
    v_exp_f32 v36, v36
    v_exp_f32 v37, v37
    v_exp_f32 v38, v38
    v_exp_f32 v39, v39
    v_cvt_pk_bf16_f32 v76, v32, v33
    v_cvt_pk_bf16_f32 v77, v34, v35
    v_cvt_pk_bf16_f32 v78, v36, v37
    v_cvt_pk_bf16_f32 v79, v38, v39
    v_mfma_f32_32x32x16_bf16 v[24:39], v[80:83], v[124:127], v[8:23]
    ds_read_b128 v[84:87], v104 offset:10640
    v_exp_f32 v40, v40
    v_exp_f32 v41, v41
    v_exp_f32 v42, v42
    v_exp_f32 v43, v43
    v_exp_f32 v44, v44
    v_exp_f32 v45, v45
    v_mfma_f32_32x32x16_bf16 v[56:71], v[92:95], v[76:79], v[56:71]
    buffer_load_dwordx4 v[224:227], v116, s[8:11], 0 offen offset:0
    buffer_load_dwordx4 v[228:231], v116, s[8:11], 0 offen offset:1024
    v_exp_f32 v46, v46
    v_exp_f32 v47, v47
    v_cvt_pk_bf16_f32 v72, v40, v41
    v_cvt_pk_bf16_f32 v73, v42, v43
    v_cvt_pk_bf16_f32 v74, v44, v45
    v_cvt_pk_bf16_f32 v75, v46, v47
    v_exp_f32 v48, v48
    v_exp_f32 v49, v49
    s_waitcnt lgkmcnt(0)
    v_mfma_f32_32x32x16_bf16 v[56:71], v[96:99], v[72:75], v[56:71]
    ds_read_b128 v[88:91], v105 offset:8512
    ds_read_b128 v[92:95], v111 offset:8512
    v_exp_f32 v50, v50
    v_exp_f32 v51, v51
    v_exp_f32 v52, v52
    v_exp_f32 v53, v53
    v_exp_f32 v54, v54
    v_exp_f32 v55, v55
    v_cvt_pk_bf16_f32 v76, v48, v49
    v_cvt_pk_bf16_f32 v77, v50, v51
    v_cvt_pk_bf16_f32 v78, v52, v53
    v_cvt_pk_bf16_f32 v79, v54, v55
    v_mfma_f32_32x32x16_bf16 v[40:55], v[84:87], v[124:127], v[8:23]
    ds_read_b128 v[80:83], v104 offset:12768
    v_exp_f32 v24, v24
    v_exp_f32 v25, v25
    v_exp_f32 v26, v26
    v_exp_f32 v27, v27
    v_exp_f32 v28, v28
    v_exp_f32 v29, v29
    v_mfma_f32_32x32x16_bf16 v[56:71], v[100:103], v[76:79], v[56:71]
    buffer_load_dwordx4 v[232:235], v116, s[8:11], s41 offen offset:0
    buffer_load_dwordx4 v[236:239], v116, s[8:11], s41 offen offset:1024
    v_exp_f32 v30, v30
    v_exp_f32 v31, v31
    v_cvt_pk_bf16_f32 v72, v24, v25
    v_cvt_pk_bf16_f32 v73, v26, v27
    v_cvt_pk_bf16_f32 v74, v28, v29
    v_cvt_pk_bf16_f32 v75, v30, v31
    v_exp_f32 v32, v32
    v_exp_f32 v33, v33
    s_waitcnt lgkmcnt(0)
    v_mfma_f32_32x32x16_bf16 v[56:71], v[88:91], v[72:75], v[56:71]
    ds_read_b128 v[96:99], v105 offset:10640
    ds_read_b128 v[100:103], v111 offset:10640
    v_exp_f32 v34, v34
    v_exp_f32 v35, v35
    v_exp_f32 v36, v36
    v_exp_f32 v37, v37
    v_exp_f32 v38, v38
    v_exp_f32 v39, v39
    v_cvt_pk_bf16_f32 v76, v32, v33
    v_cvt_pk_bf16_f32 v77, v34, v35
    v_cvt_pk_bf16_f32 v78, v36, v37
    v_cvt_pk_bf16_f32 v79, v38, v39
    v_mfma_f32_32x32x16_bf16 v[24:39], v[80:83], v[124:127], v[8:23]
    ds_read_b128 v[84:87], v104 offset:14896
    v_exp_f32 v40, v40
    v_exp_f32 v41, v41
    v_exp_f32 v42, v42
    v_exp_f32 v43, v43
    v_exp_f32 v44, v44
    v_exp_f32 v45, v45
    v_mfma_f32_32x32x16_bf16 v[56:71], v[92:95], v[76:79], v[56:71]
    buffer_load_dwordx4 v[240:243], v116, s[8:11], s42 offen offset:0
    v_exp_f32 v46, v46
    v_exp_f32 v47, v47
    v_cvt_pk_bf16_f32 v72, v40, v41
    v_cvt_pk_bf16_f32 v73, v42, v43
    v_cvt_pk_bf16_f32 v74, v44, v45
    v_cvt_pk_bf16_f32 v75, v46, v47
    v_exp_f32 v48, v48
    v_exp_f32 v49, v49
    s_waitcnt lgkmcnt(0)
    v_mfma_f32_32x32x16_bf16 v[56:71], v[96:99], v[72:75], v[56:71]
    ds_read_b128 v[88:91], v105 offset:12768
    ds_read_b128 v[92:95], v111 offset:12768
    v_exp_f32 v50, v50
    v_exp_f32 v51, v51
    v_exp_f32 v52, v52
    v_exp_f32 v53, v53
    v_exp_f32 v54, v54
    v_exp_f32 v55, v55
    v_cvt_pk_bf16_f32 v76, v48, v49
    v_cvt_pk_bf16_f32 v77, v50, v51
    v_cvt_pk_bf16_f32 v78, v52, v53
    v_cvt_pk_bf16_f32 v79, v54, v55
    v_mfma_f32_32x32x16_bf16 v[40:55], v[84:87], v[124:127], v[8:23]
    ds_read_b128 v[80:83], v104 offset:17024
    v_exp_f32 v24, v24
    v_exp_f32 v25, v25
    v_exp_f32 v26, v26
    v_exp_f32 v27, v27
    v_exp_f32 v28, v28
    v_exp_f32 v29, v29
    v_mfma_f32_32x32x16_bf16 v[56:71], v[100:103], v[76:79], v[56:71]
    buffer_load_dwordx4 v[244:247], v116, s[8:11], s42 offen offset:1024
    buffer_load_dwordx4 v[248:251], v116, s[8:11], s43 offen offset:0
    v_exp_f32 v30, v30
    v_exp_f32 v31, v31
    v_cvt_pk_bf16_f32 v72, v24, v25
    v_cvt_pk_bf16_f32 v73, v26, v27
    v_cvt_pk_bf16_f32 v74, v28, v29
    v_cvt_pk_bf16_f32 v75, v30, v31
    v_exp_f32 v32, v32
    v_exp_f32 v33, v33
    s_waitcnt lgkmcnt(0)
    v_mfma_f32_32x32x16_bf16 v[56:71], v[88:91], v[72:75], v[56:71]
    ds_read_b128 v[96:99], v105 offset:14896
    ds_read_b128 v[100:103], v111 offset:14896
    v_exp_f32 v34, v34
    v_exp_f32 v35, v35
    v_exp_f32 v36, v36
    v_exp_f32 v37, v37
    v_exp_f32 v38, v38
    v_exp_f32 v39, v39
    v_cvt_pk_bf16_f32 v76, v32, v33
    v_cvt_pk_bf16_f32 v77, v34, v35
    v_cvt_pk_bf16_f32 v78, v36, v37
    v_cvt_pk_bf16_f32 v79, v38, v39
    v_mfma_f32_32x32x16_bf16 v[24:39], v[80:83], v[124:127], v[8:23]
    ds_read_b128 v[84:87], v104 offset:19152
    v_exp_f32 v40, v40
    v_exp_f32 v41, v41
    v_exp_f32 v42, v42
    v_exp_f32 v43, v43
    v_exp_f32 v44, v44
    v_exp_f32 v45, v45
    v_mfma_f32_32x32x16_bf16 v[56:71], v[92:95], v[76:79], v[56:71]
    buffer_load_dwordx4 v[252:255], v116, s[8:11], s43 offen offset:1024
    s_and_b32 s30, s18, 7
    s_lshr_b32 s31, s30, 1
    s_lshl_b32 s31, s31, 2
    s_and_b32 s30, s30, 1
    s_add_u32 s30, s30, s31
    s_lshl_b32 s30, s30, 10
    buffer_load_dwordx4 v[120:123], v116, s[8:11], s30 offen offset:2048
    s_add_u32 s30, s30, 4294410240
    v_add_u32 v117, s30, v116
    buffer_load_dwordx4 v[120:123], v117, s[8:11], 0 offen
    buffer_load_dwordx4 v[120:123], v117, s[8:11], 0 offen offset:2048
    v_exp_f32 v46, v46
    v_exp_f32 v47, v47
    v_cvt_pk_bf16_f32 v72, v40, v41
    v_cvt_pk_bf16_f32 v73, v42, v43
    v_cvt_pk_bf16_f32 v74, v44, v45
    v_cvt_pk_bf16_f32 v75, v46, v47
    v_exp_f32 v48, v48
    v_exp_f32 v49, v49
    s_waitcnt lgkmcnt(0)
    v_mfma_f32_32x32x16_bf16 v[56:71], v[96:99], v[72:75], v[56:71]
    ds_read_b128 v[88:91], v105 offset:17024
    ds_read_b128 v[92:95], v111 offset:17024
    v_exp_f32 v50, v50
    v_exp_f32 v51, v51
    v_exp_f32 v52, v52
    v_exp_f32 v53, v53
    v_exp_f32 v54, v54
    v_exp_f32 v55, v55
    v_cvt_pk_bf16_f32 v76, v48, v49
    v_cvt_pk_bf16_f32 v77, v50, v51
    v_cvt_pk_bf16_f32 v78, v52, v53
    v_cvt_pk_bf16_f32 v79, v54, v55
    v_mfma_f32_32x32x16_bf16 v[40:55], v[84:87], v[124:127], v[8:23]
    ds_read_b128 v[80:83], v104 offset:21280
    v_exp_f32 v24, v24
    v_exp_f32 v25, v25
    v_exp_f32 v26, v26
    v_exp_f32 v27, v27
    v_exp_f32 v28, v28
    v_exp_f32 v29, v29
    v_mfma_f32_32x32x16_bf16 v[56:71], v[100:103], v[76:79], v[56:71]
    v_exp_f32 v30, v30
    v_exp_f32 v31, v31
    v_cvt_pk_bf16_f32 v72, v24, v25
    v_cvt_pk_bf16_f32 v73, v26, v27
    v_cvt_pk_bf16_f32 v74, v28, v29
    v_cvt_pk_bf16_f32 v75, v30, v31
    v_exp_f32 v32, v32
    v_exp_f32 v33, v33
    s_waitcnt lgkmcnt(0)
    v_mfma_f32_32x32x16_bf16 v[56:71], v[88:91], v[72:75], v[56:71]
    ds_read_b128 v[96:99], v105 offset:19152
    ds_read_b128 v[100:103], v111 offset:19152
    v_exp_f32 v34, v34
    v_exp_f32 v35, v35
    v_exp_f32 v36, v36
    v_exp_f32 v37, v37
    v_exp_f32 v38, v38
    v_exp_f32 v39, v39
    v_cvt_pk_bf16_f32 v76, v32, v33
    v_cvt_pk_bf16_f32 v77, v34, v35
    v_cvt_pk_bf16_f32 v78, v36, v37
    v_cvt_pk_bf16_f32 v79, v38, v39
    v_mfma_f32_32x32x16_bf16 v[24:39], v[80:83], v[124:127], v[8:23]
    ds_read_b128 v[84:87], v104 offset:23408
    v_exp_f32 v40, v40
    v_exp_f32 v41, v41
    v_exp_f32 v42, v42
    v_exp_f32 v43, v43
    v_exp_f32 v44, v44
    v_exp_f32 v45, v45
    v_mfma_f32_32x32x16_bf16 v[56:71], v[92:95], v[76:79], v[56:71]
    v_exp_f32 v46, v46
    v_exp_f32 v47, v47
    v_cvt_pk_bf16_f32 v72, v40, v41
    v_cvt_pk_bf16_f32 v73, v42, v43
    v_cvt_pk_bf16_f32 v74, v44, v45
    v_cvt_pk_bf16_f32 v75, v46, v47
    v_exp_f32 v48, v48
    v_exp_f32 v49, v49
    s_waitcnt lgkmcnt(0)
    v_mfma_f32_32x32x16_bf16 v[56:71], v[96:99], v[72:75], v[56:71]
    ds_read_b128 v[88:91], v105 offset:21280
    ds_read_b128 v[92:95], v111 offset:21280
    v_exp_f32 v50, v50
    v_exp_f32 v51, v51
    v_exp_f32 v52, v52
    v_exp_f32 v53, v53
    v_exp_f32 v54, v54
    v_exp_f32 v55, v55
    v_cvt_pk_bf16_f32 v76, v48, v49
    v_cvt_pk_bf16_f32 v77, v50, v51
    v_cvt_pk_bf16_f32 v78, v52, v53
    v_cvt_pk_bf16_f32 v79, v54, v55
    s_setprio 0
    v_mfma_f32_32x32x16_bf16 v[40:55], v[84:87], v[124:127], v[8:23]
    ds_read_b128 v[80:83], v104 offset:25536
    v_exp_f32 v24, v24
    v_exp_f32 v25, v25
    v_exp_f32 v26, v26
    v_exp_f32 v27, v27
    v_exp_f32 v28, v28
    v_exp_f32 v29, v29
    v_mfma_f32_32x32x16_bf16 v[56:71], v[100:103], v[76:79], v[56:71]
    v_exp_f32 v30, v30
    v_exp_f32 v31, v31
    v_cvt_pk_bf16_f32 v72, v24, v25
    v_cvt_pk_bf16_f32 v73, v26, v27
    v_cvt_pk_bf16_f32 v74, v28, v29
    v_cvt_pk_bf16_f32 v75, v30, v31
    v_exp_f32 v32, v32
    v_exp_f32 v33, v33
    s_waitcnt lgkmcnt(0)
    v_mfma_f32_32x32x16_bf16 v[56:71], v[88:91], v[72:75], v[56:71]
    ds_read_b128 v[96:99], v105 offset:23408
    ds_read_b128 v[100:103], v111 offset:23408
    v_exp_f32 v34, v34
    v_exp_f32 v35, v35
    v_exp_f32 v36, v36
    v_exp_f32 v37, v37
    v_exp_f32 v38, v38
    v_exp_f32 v39, v39
    v_cvt_pk_bf16_f32 v76, v32, v33
    v_cvt_pk_bf16_f32 v77, v34, v35
    v_cvt_pk_bf16_f32 v78, v36, v37
    v_cvt_pk_bf16_f32 v79, v38, v39
    v_mfma_f32_32x32x16_bf16 v[24:39], v[80:83], v[124:127], v[8:23]
    ds_read_b128 v[84:87], v104 offset:27664
    v_exp_f32 v40, v40
    v_exp_f32 v41, v41
    v_exp_f32 v42, v42
    v_exp_f32 v43, v43
    v_exp_f32 v44, v44
    v_exp_f32 v45, v45
    v_mfma_f32_32x32x16_bf16 v[56:71], v[92:95], v[76:79], v[56:71]
    v_exp_f32 v46, v46
    v_exp_f32 v47, v47
    v_cvt_pk_bf16_f32 v72, v40, v41
    v_cvt_pk_bf16_f32 v73, v42, v43
    v_cvt_pk_bf16_f32 v74, v44, v45
    v_cvt_pk_bf16_f32 v75, v46, v47
    v_exp_f32 v48, v48
    v_exp_f32 v49, v49
    s_waitcnt lgkmcnt(0)
    v_mfma_f32_32x32x16_bf16 v[56:71], v[96:99], v[72:75], v[56:71]
    ds_read_b128 v[88:91], v105 offset:25536
    ds_read_b128 v[92:95], v111 offset:25536
    v_exp_f32 v50, v50
    v_exp_f32 v51, v51
    v_exp_f32 v52, v52
    v_exp_f32 v53, v53
    v_exp_f32 v54, v54
    v_exp_f32 v55, v55
    v_cvt_pk_bf16_f32 v76, v48, v49
    v_cvt_pk_bf16_f32 v77, v50, v51
    v_cvt_pk_bf16_f32 v78, v52, v53
    v_cvt_pk_bf16_f32 v79, v54, v55
    v_mfma_f32_32x32x16_bf16 v[40:55], v[84:87], v[124:127], v[8:23]
    ds_read_b128 v[80:83], v104 offset:29792
    v_exp_f32 v24, v24
    v_exp_f32 v25, v25
    v_exp_f32 v26, v26
    v_exp_f32 v27, v27
    v_exp_f32 v28, v28
    v_exp_f32 v29, v29
    v_mfma_f32_32x32x16_bf16 v[56:71], v[100:103], v[76:79], v[56:71]
    v_exp_f32 v30, v30
    v_exp_f32 v31, v31
    v_cvt_pk_bf16_f32 v72, v24, v25
    v_cvt_pk_bf16_f32 v73, v26, v27
    v_cvt_pk_bf16_f32 v74, v28, v29
    v_cvt_pk_bf16_f32 v75, v30, v31
    v_exp_f32 v32, v32
    v_exp_f32 v33, v33
    s_waitcnt lgkmcnt(0)
    v_mfma_f32_32x32x16_bf16 v[56:71], v[88:91], v[72:75], v[56:71]
    ds_read_b128 v[96:99], v105 offset:27664
    ds_read_b128 v[100:103], v111 offset:27664
    v_exp_f32 v34, v34
    v_exp_f32 v35, v35
    v_exp_f32 v36, v36
    v_exp_f32 v37, v37
    v_exp_f32 v38, v38
    v_exp_f32 v39, v39
    v_cvt_pk_bf16_f32 v76, v32, v33
    v_cvt_pk_bf16_f32 v77, v34, v35
    v_cvt_pk_bf16_f32 v78, v36, v37
    v_cvt_pk_bf16_f32 v79, v38, v39
    v_mfma_f32_32x32x16_bf16 v[24:39], v[80:83], v[124:127], v[8:23]
    ds_read_b128 v[84:87], v104 offset:31920
    v_exp_f32 v40, v40
    v_exp_f32 v41, v41
    v_exp_f32 v42, v42
    v_exp_f32 v43, v43
    v_exp_f32 v44, v44
    v_exp_f32 v45, v45
    v_mfma_f32_32x32x16_bf16 v[56:71], v[92:95], v[76:79], v[56:71]
    v_exp_f32 v46, v46
    v_exp_f32 v47, v47
    v_cvt_pk_bf16_f32 v72, v40, v41
    v_cvt_pk_bf16_f32 v73, v42, v43
    v_cvt_pk_bf16_f32 v74, v44, v45
    v_cvt_pk_bf16_f32 v75, v46, v47
    v_exp_f32 v48, v48
    v_exp_f32 v49, v49
    s_waitcnt lgkmcnt(0)
    v_mfma_f32_32x32x16_bf16 v[56:71], v[96:99], v[72:75], v[56:71]
    ds_read_b128 v[88:91], v105 offset:29792
    ds_read_b128 v[92:95], v111 offset:29792
    v_exp_f32 v50, v50
    v_exp_f32 v51, v51
    v_exp_f32 v52, v52
    v_exp_f32 v53, v53
    v_exp_f32 v54, v54
    v_exp_f32 v55, v55
    v_cvt_pk_bf16_f32 v76, v48, v49
    v_cvt_pk_bf16_f32 v77, v50, v51
    v_cvt_pk_bf16_f32 v78, v52, v53
    v_cvt_pk_bf16_f32 v79, v54, v55
    v_mfma_f32_32x32x16_bf16 v[40:55], v[84:87], v[124:127], v[8:23]
    ds_read_b128 v[80:83], v104 offset:34048
    v_exp_f32 v24, v24
    v_exp_f32 v25, v25
    v_exp_f32 v26, v26
    v_exp_f32 v27, v27
    v_exp_f32 v28, v28
    v_exp_f32 v29, v29
    v_mfma_f32_32x32x16_bf16 v[56:71], v[100:103], v[76:79], v[56:71]
    v_exp_f32 v30, v30
    v_exp_f32 v31, v31
    v_cvt_pk_bf16_f32 v72, v24, v25
    v_cvt_pk_bf16_f32 v73, v26, v27
    v_cvt_pk_bf16_f32 v74, v28, v29
    v_cvt_pk_bf16_f32 v75, v30, v31
    v_exp_f32 v32, v32
    v_exp_f32 v33, v33
    s_waitcnt lgkmcnt(0)
    v_mfma_f32_32x32x16_bf16 v[56:71], v[88:91], v[72:75], v[56:71]
    ds_read_b128 v[96:99], v105 offset:31920
    ds_read_b128 v[100:103], v111 offset:31920
    v_exp_f32 v34, v34
    v_exp_f32 v35, v35
    v_exp_f32 v36, v36
    v_exp_f32 v37, v37
    v_exp_f32 v38, v38
    v_exp_f32 v39, v39
    v_cvt_pk_bf16_f32 v76, v32, v33
    v_cvt_pk_bf16_f32 v77, v34, v35
    v_cvt_pk_bf16_f32 v78, v36, v37
    v_cvt_pk_bf16_f32 v79, v38, v39
    v_mfma_f32_32x32x16_bf16 v[24:39], v[80:83], v[124:127], v[8:23]
    ds_read_b128 v[84:87], v104 offset:36176
    v_exp_f32 v40, v40
    v_exp_f32 v41, v41
    v_exp_f32 v42, v42
    v_exp_f32 v43, v43
    v_exp_f32 v44, v44
    v_exp_f32 v45, v45
    v_mfma_f32_32x32x16_bf16 v[56:71], v[92:95], v[76:79], v[56:71]
    v_exp_f32 v46, v46
    v_exp_f32 v47, v47
    v_cvt_pk_bf16_f32 v72, v40, v41
    v_cvt_pk_bf16_f32 v73, v42, v43
    v_cvt_pk_bf16_f32 v74, v44, v45
    v_cvt_pk_bf16_f32 v75, v46, v47
    v_exp_f32 v48, v48
    v_exp_f32 v49, v49
    s_waitcnt lgkmcnt(0)
    v_mfma_f32_32x32x16_bf16 v[56:71], v[96:99], v[72:75], v[56:71]
    ds_read_b128 v[88:91], v105 offset:34048
    ds_read_b128 v[92:95], v111 offset:34048
    v_exp_f32 v50, v50
    v_exp_f32 v51, v51
    v_exp_f32 v52, v52
    v_exp_f32 v53, v53
    v_exp_f32 v54, v54
    v_exp_f32 v55, v55
    v_cvt_pk_bf16_f32 v76, v48, v49
    v_cvt_pk_bf16_f32 v77, v50, v51
    v_cvt_pk_bf16_f32 v78, v52, v53
    v_cvt_pk_bf16_f32 v79, v54, v55
    v_add_u32 v104, 34048, v104
    v_add_u32 v105, 34048, v105
    v_add_u32 v111, 34048, v111
    v_mfma_f32_32x32x16_bf16 v[56:71], v[100:103], v[76:79], v[56:71]
    s_mov_b32 s39, 0
    s_waitcnt lgkmcnt(0)
    s_nop 10
l0_fin:
    v_mov_b32 v106, v64
    v_mov_b32 v107, v64
    v_mul_f32 v108, 0, v56
    v_fma_f32 v108, v57, 0, v108
    v_permlane32_swap_b32 v106, v107
    v_fma_f32 v108, v58, 0, v108
    v_fma_f32 v108, v59, 0, v108
    v_fma_f32 v108, v60, 0, v108
    v_fma_f32 v108, v61, 0, v108
    v_fma_f32 v108, v62, 0, v108
    v_fma_f32 v108, v63, 0, v108
    v_add_f32 v108, v108, v106
    v_mov_b32 v109, 0x4e800000
    v_cmp_nle_f32 vcc, v108, v109
    v_rcp_f32 v106, v106
    s_cmp_eq_u32 s39, 99
    s_cbranch_scc1 l0_store
    s_cbranch_vccnz l0_slow
l0_store:
    v_mul_f32 v56, v106, v56
    v_mul_f32 v57, v106, v57
    v_mul_f32 v58, v106, v58
    v_mul_f32 v59, v106, v59
    v_mul_f32 v60, v106, v60
    v_mul_f32 v61, v106, v61
    v_mul_f32 v62, v106, v62
    v_mul_f32 v63, v106, v63
    v_cvt_pk_bf16_f32 v72, v56, v57
    v_cvt_pk_bf16_f32 v73, v58, v59
    v_cvt_pk_bf16_f32 v74, v60, v61
    v_cvt_pk_bf16_f32 v75, v62, v63
    buffer_store_dwordx4 v[72:75], v3, s[8:11], s36 offen sc0 sc1
    s_nop 1
    buffer_load_dwordx4 v[64:67], v116, s[8:11], 0 offen offset:2048
    buffer_load_dwordx4 v[68:71], v116, s[8:11], 0 offen offset:3072
    buffer_load_dwordx4 v[72:75], v116, s[8:11], s41 offen offset:2048
    buffer_load_dwordx4 v[76:79], v116, s[8:11], s41 offen offset:3072
    buffer_load_dwordx4 v[80:83], v116, s[8:11], s42 offen offset:2048
    buffer_load_dwordx4 v[84:87], v116, s[8:11], s42 offen offset:3072
    buffer_load_dwordx4 v[88:91], v116, s[8:11], s43 offen offset:2048
    buffer_load_dwordx4 v[92:95], v116, s[8:11], s43 offen offset:3072
    s_lshl_b32 s30, s18, 15
    s_lshl_b32 s48, s20, 12
    s_add_u32 s30, s30, s48
    s_add_u32 s30, s30, 13049856
    v_add_u32 v5, s30, v3
    s_lshl_b32 s30, s26, 14
    s_add_u32 s30, s30, 36864
    v_add_u32 v6, s30, v3
    v_add_u32 v14, s48, v3
    s_add_u32 s48, s48, 36864
    s_lshl_b32 s30, s20, 11
    s_add_u32 s30, s30, 81920
    v_add_u32 v8, s30, v3
    v_xor_b32 v7, 0x2000, v8
    v_and_b32 v2, 31, v1
    v_lshlrev_b32 v2, 10, v2
    v_lshrrev_b32 v4, 5, v1
    v_lshl_add_u32 v2, v4, 3, v2
    s_lshl_b32 s30, s18, 15
    s_and_b32 s31, s19, 0x7fff
    s_lshr_b32 s31, s31, 5
    s_add_u32 s30, s30, s31
    buffer_load_dwordx2 v[96:97], v2, s[12:15], s30 offen
    buffer_load_dwordx2 v[98:99], v2, s[12:15], s30 offen offset:16
    s_lshr_b32 s30, s20, 1
    s_lshl_b32 s30, s30, 2
    s_and_b32 s31, s22, 3
    s_add_u32 s30, s30, s31
    s_lshl_b32 s32, 1, s30
    s_mov_b32 s33, 0
    v_lshlrev_b32 v0, 2, v1
    s_lshl_b32 s30, s21, 8
    s_add_u32 s30, s30, 24735744
    s_lshl_b32 s34, s22, 2
    s_add_u32 s34, s34, s30
    v_mov_b32 v4, 1
    s_waitcnt vmcnt(10) lgkmcnt(0)
    s_cmp_lg_u32 s20, 0
    s_barrier
    s_cbranch_scc1 l0_sig21
    s_mov_b64 exec, 1
    buffer_store_dword v4, v0, s[8:11], s34 offen
l0_sig21:
    s_mov_b32 s31, 0
    s_mov_b64 exec, s[32:33]
l0_pa18:
    buffer_load_dword v2, v0, s[8:11], s30 offen sc1
    s_add_u32 s31, s31, 1
    s_waitcnt vmcnt(0)
    v_cmp_ne_u32 vcc, 0, v2
    s_cmp_eq_u64 vcc, s[32:33]
    s_cbranch_scc1 l0_pd20
    s_cmp_lt_u32 s31, 64
    s_cbranch_scc1 l0_pa18
    s_mov_b64 exec, 1
    buffer_store_dword v4, v0, s[8:11], s34 offen offset:128 sc0 sc1
    s_mov_b64 exec, s[32:33]
l0_pb19:
    buffer_load_dword v2, v0, s[8:11], s30 offen sc1
    s_waitcnt vmcnt(0)
    v_cmp_ne_u32 s[36:37], 0, v2
    buffer_load_dword v2, v0, s[8:11], s30 offen offset:128 sc0 sc1
    s_waitcnt vmcnt(0)
    v_cmp_ne_u32 vcc, 0, v2
    s_add_u32 s31, s31, 1
    s_or_b64 vcc, vcc, s[36:37]
    s_cmp_eq_u64 vcc, s[32:33]
    s_cbranch_scc1 l0_pd20
    s_sleep 4
    s_cmp_lt_u32 s31, 1048576
    s_cbranch_scc1 l0_pb19
    s_branch k_end
l0_pd20:
    s_mov_b64 exec, -1
    s_mov_b32 m0, s48
    s_nop 0
    buffer_load_dwordx4 v5, s[8:11], 0 offen offset:0 lds
    buffer_load_dwordx4 v5, s[8:11], 0 offen offset:1024 lds
    buffer_load_dwordx4 v5, s[8:11], 0 offen offset:2048 lds
    buffer_load_dwordx4 v5, s[8:11], 0 offen offset:3072 lds
    s_waitcnt vmcnt(2)
    s_barrier
    ds_read_b128 v[32:35], v6 offset:0
    ds_read_b128 v[36:39], v6 offset:1024
    ds_read_b128 v[40:43], v6 offset:4096
    ds_read_b128 v[44:47], v6 offset:5120
    ds_read_b128 v[48:51], v6 offset:8192
    ds_read_b128 v[52:55], v6 offset:9216
    ds_read_b128 v[56:59], v6 offset:12288
    ds_read_b128 v[60:63], v6 offset:13312
    s_waitcnt lgkmcnt(7)
    v_mfma_f32_32x32x16_bf16 v[16:31], v[224:227], v[32:35], 0
    s_waitcnt lgkmcnt(6)
    v_mfma_f32_32x32x16_bf16 v[16:31], v[228:231], v[36:39], v[16:31]
    s_waitcnt lgkmcnt(5)
    v_mfma_f32_32x32x16_bf16 v[16:31], v[232:235], v[40:43], v[16:31]
    s_waitcnt lgkmcnt(4)
    v_mfma_f32_32x32x16_bf16 v[16:31], v[236:239], v[44:47], v[16:31]
    s_waitcnt vmcnt(0)
    s_barrier
    ds_read_b128 v[32:35], v6 offset:2048
    ds_read_b128 v[36:39], v6 offset:3072
    ds_read_b128 v[40:43], v6 offset:6144
    ds_read_b128 v[44:47], v6 offset:7168
    s_waitcnt lgkmcnt(7)
    v_mfma_f32_32x32x16_bf16 v[16:31], v[240:243], v[48:51], v[16:31]
    ds_read_b128 v[48:51], v6 offset:10240
    s_waitcnt lgkmcnt(7)
    v_mfma_f32_32x32x16_bf16 v[16:31], v[244:247], v[52:55], v[16:31]
    ds_read_b128 v[52:55], v6 offset:11264
    s_waitcnt lgkmcnt(7)
    v_mfma_f32_32x32x16_bf16 v[16:31], v[248:251], v[56:59], v[16:31]
    ds_read_b128 v[56:59], v6 offset:14336
    s_waitcnt lgkmcnt(7)
    v_mfma_f32_32x32x16_bf16 v[16:31], v[252:255], v[60:63], v[16:31]
    ds_read_b128 v[60:63], v6 offset:15360
    s_cmp_lg_u32 s20, 0
    s_cbranch_scc1 l0_fb24
    s_mov_b64 exec, 1
    buffer_store_dword v4, v0, s[8:11], s34 offen offset:128 sc0 sc1
    s_mov_b64 exec, -1
l0_fb24:
    s_waitcnt lgkmcnt(7)
    v_mfma_f32_32x32x16_bf16 v[16:31], v[64:67], v[32:35], v[16:31]
    buffer_load_dwordx4 v[224:227], v112, s[8:11], s46 offen offset:0
    s_waitcnt lgkmcnt(6)
    v_mfma_f32_32x32x16_bf16 v[16:31], v[68:71], v[36:39], v[16:31]
    buffer_load_dwordx4 v[228:231], v112, s[8:11], s46 offen offset:1024
    s_waitcnt lgkmcnt(5)
    v_mfma_f32_32x32x16_bf16 v[16:31], v[72:75], v[40:43], v[16:31]
    buffer_load_dwordx4 v[232:235], v112, s[8:11], s46 offen offset:2048
    s_waitcnt lgkmcnt(4)
    v_mfma_f32_32x32x16_bf16 v[16:31], v[76:79], v[44:47], v[16:31]
    buffer_load_dwordx4 v[236:239], v112, s[8:11], s46 offen offset:3072
    s_waitcnt lgkmcnt(3)
    v_mfma_f32_32x32x16_bf16 v[16:31], v[80:83], v[48:51], v[16:31]
    buffer_load_dwordx4 v[240:243], v112, s[8:11], s47 offen offset:0
    s_waitcnt lgkmcnt(2)
    v_mfma_f32_32x32x16_bf16 v[16:31], v[84:87], v[52:55], v[16:31]
    buffer_load_dwordx4 v[244:247], v112, s[8:11], s47 offen offset:1024
    s_waitcnt lgkmcnt(1)
    v_mfma_f32_32x32x16_bf16 v[16:31], v[88:91], v[56:59], v[16:31]
    buffer_load_dwordx4 v[248:251], v112, s[8:11], s47 offen offset:2048
    s_waitcnt lgkmcnt(0)
    v_mfma_f32_32x32x16_bf16 v[16:31], v[92:95], v[60:63], v[16:31]
    buffer_load_dwordx4 v[252:255], v112, s[8:11], s47 offen offset:3072
    v_lshlrev_b32 v32, 16, v96
    v_and_b32 v33, 0xffff0000, v96
    v_lshlrev_b32 v34, 16, v97
    v_and_b32 v35, 0xffff0000, v97
    v_lshlrev_b32 v36, 16, v98
    v_and_b32 v37, 0xffff0000, v98
    v_lshlrev_b32 v38, 16, v99
    v_and_b32 v39, 0xffff0000, v99
    s_nop 3
    ds_write_b128 v7, v[24:27] offset:0
    ds_write_b128 v7, v[28:31] offset:1024
    v_add_f32 v16, v16, v32
    v_add_f32 v17, v17, v33
    v_add_f32 v18, v18, v34
    v_add_f32 v19, v19, v35
    v_add_f32 v20, v20, v36
    v_add_f32 v21, v21, v37
    v_add_f32 v22, v22, v38
    v_add_f32 v23, v23, v39
    s_waitcnt lgkmcnt(0)
    s_barrier
    ds_read_b128 v[24:27], v8 offset:0
    ds_read_b128 v[28:31], v8 offset:1024
    s_waitcnt lgkmcnt(0)
    v_add_f32 v16, v16, v24
    v_add_f32 v17, v17, v25
    v_add_f32 v18, v18, v26
    v_add_f32 v19, v19, v27
    v_add_f32 v20, v20, v28
    v_add_f32 v21, v21, v29
    v_add_f32 v22, v22, v30
    v_add_f32 v23, v23, v31
    v_cvt_pk_bf16_f32 v24, v16, v17
    v_cvt_pk_bf16_f32 v25, v18, v19
    v_cvt_pk_bf16_f32 v26, v20, v21
    v_cvt_pk_bf16_f32 v27, v22, v23
    s_add_u32 s31, s19, 8855552
    buffer_store_dwordx4 v[24:27], v3, s[8:11], s31 offen sc0 sc1
    v_mov_b32 v36, 0x3f803f80
    v_dot2_f32_bf16 v33, v24, v24, 0
    v_dot2_f32_bf16 v32, v24, v36, 0
    v_dot2_f32_bf16 v33, v25, v25, v33
    v_dot2_f32_bf16 v32, v25, v36, v32
    v_dot2_f32_bf16 v33, v26, v26, v33
    v_dot2_f32_bf16 v32, v26, v36, v32
    v_dot2_f32_bf16 v33, v27, v27, v33
    v_dot2_f32_bf16 v32, v27, v36, v32
    s_nop 2
    v_mov_b32 v34, v32
    v_mov_b32 v35, v33
    s_nop 1
    v_permlane32_swap_b32 v32, v34
    v_permlane32_swap_b32 v33, v35
    v_add_f32 v32, v32, v34
    v_add_f32 v33, v33, v35
    s_lshr_b32 s31, s19, 2
    s_add_u32 s31, s31, 25321472
    v_lshlrev_b32 v4, 3, v1
    s_mov_b32 exec_hi, 0
    buffer_store_dwordx2 v[32:33], v4, s[8:11], s31 offen sc0 sc1
    s_mov_b64 exec, -1
    v_mov_b32 v15, v113
    v_mov_b32 v9, v114
    s_lshl_b32 s30, s21, 2
    s_add_u32 s30, s30, s29
    s_lshl_b32 s30, s30, 15
    s_lshr_b32 s31, s20, 1
    s_lshl_b32 s31, s31, 11
    s_add_u32 s30, s30, s31
    s_add_u32 s30, s30, 8855552
    v_add_u32 v13, s30, v3
    v_add_u32 v14, 0x10000, v13
    s_lshl_b32 s48, s29, 15
    s_add_u32 s48, s48, s31
    v_add_u32 v7, 0x10000, v3
    v_lshrrev_b32 v11, 5, v1
    v_lshlrev_b32 v11, 4, v11
    s_min_u32 s30, s20, 6
    s_lshl_b32 s30, s30, 7
    s_add_u32 s30, s30, 135168
    v_add_u32 v10, s30, v11
    v_and_b32 v12, 31, v1
    v_lshlrev_b32 v12, 3, v12
    v_lshl_add_u32 v12, v11, 8, v12
    s_lshl_b32 s30, s21, 15
    s_add_u32 s30, s30, 25321472
    v_add_u32 v12, s30, v12
    v_add_u32 v8, 131072, v3
    s_mul_i32 s31, s20, 14336
    s_mul_i32 s30, s27, 114688
    s_add_u32 s30, s30, s31
    s_add_u32 s30, s30, 15147008
    v_add_u32 v5, s30, v3
    v_add_u32 v6, 229376, v5
    s_lshl_b32 s32, 0x5555, s29
    s_cmp_eq_u32 s20, 7
    s_cselect_b32 s32, 0xffff, s32
    s_mov_b32 s33, 0
    v_lshlrev_b32 v0, 2, v1
    s_lshl_b32 s30, s21, 8
    s_add_u32 s30, s30, 24739840
    s_lshl_b32 s34, s22, 2
    s_add_u32 s34, s34, s30
    v_mov_b32 v4, 1
    s_waitcnt vmcnt(0) lgkmcnt(0)
    s_cmp_lg_u32 s20, 0
    s_barrier
    s_cbranch_scc1 l0_sig28
    s_mov_b64 exec, 1
    buffer_store_dword v4, v0, s[8:11], s34 offen
l0_sig28:
    s_mov_b32 s31, 0
    s_mov_b64 exec, s[32:33]
l0_pa25:
    buffer_load_dword v2, v0, s[8:11], s30 offen sc1
    s_add_u32 s31, s31, 1
    s_waitcnt vmcnt(0)
    v_cmp_ne_u32 vcc, 0, v2
    s_cmp_eq_u64 vcc, s[32:33]
    s_cbranch_scc1 l0_pd27
    s_cmp_lt_u32 s31, 64
    s_cbranch_scc1 l0_pa25
    s_mov_b64 exec, 1
    buffer_store_dword v4, v0, s[8:11], s34 offen offset:128 sc0 sc1
    s_mov_b64 exec, s[32:33]
l0_pb26:
    buffer_load_dword v2, v0, s[8:11], s30 offen sc1
    s_waitcnt vmcnt(0)
    v_cmp_ne_u32 s[36:37], 0, v2
    buffer_load_dword v2, v0, s[8:11], s30 offen offset:128 sc0 sc1
    s_waitcnt vmcnt(0)
    v_cmp_ne_u32 vcc, 0, v2
    s_add_u32 s31, s31, 1
    s_or_b64 vcc, vcc, s[36:37]
    s_cmp_eq_u64 vcc, s[32:33]
    s_cbranch_scc1 l0_pd27
    s_sleep 4
    s_cmp_lt_u32 s31, 1048576
    s_cbranch_scc1 l0_pb26
    s_branch k_end
l0_pd27:
    s_mov_b64 exec, -1
    s_add_u32 m0, s48, 0
    s_nop 0
    buffer_load_dwordx4 v13, s[8:11], 0 offen offset:0 lds
    buffer_load_dwordx4 v13, s[8:11], 0 offen offset:1024 lds
    s_add_u32 m0, s48, 8192
    s_nop 0
    buffer_load_dwordx4 v13, s[8:11], s42 offen offset:0 lds
    buffer_load_dwordx4 v13, s[8:11], s42 offen offset:1024 lds
    s_cmp_eq_u32 s20, 7
    s_cbranch_scc1 l0_gs31
    s_mul_i32 s39, s21, 448
    s_add_u32 s39, s39, s40
    s_lshl_b32 s39, s39, 10
    s_add_u32 s39, s39, 15147008
    s_waitcnt vmcnt(2)
    s_barrier
    ds_read_b128 v[80:83], v3 offset:0
    ds_read_b128 v[84:87], v3 offset:32768
    ds_read_b128 v[88:91], v3 offset:1024
    ds_read_b128 v[92:95], v3 offset:33792
    ds_read_b128 v[96:99], v3 offset:2048
    ds_read_b128 v[100:103], v3 offset:34816
    ds_read_b128 v[104:107], v3 offset:3072
    ds_read_b128 v[108:111], v3 offset:35840
    s_waitcnt lgkmcnt(4)
    v_mfma_f32_32x32x16_bf16 v[16:31], v[128:131], v[80:83], 0
    s_add_u32 m0, s48, 16384
    s_nop 0
    buffer_load_dwordx4 v13, s[8:11], s44 offen offset:0 lds
    buffer_load_dwordx4 v13, s[8:11], s44 offen offset:1024 lds
    v_mfma_f32_32x32x16_bf16 v[32:47], v[128:131], v[84:87], 0
    v_mfma_f32_32x32x16_bf16 v[16:31], v[132:135], v[88:91], v[16:31]
    v_mfma_f32_32x32x16_bf16 v[32:47], v[132:135], v[92:95], v[32:47]
    ds_read_b128 v[80:83], v3 offset:4096
    ds_read_b128 v[84:87], v3 offset:36864
    ds_read_b128 v[88:91], v3 offset:5120
    ds_read_b128 v[92:95], v3 offset:37888
    s_waitcnt lgkmcnt(4)
    v_mfma_f32_32x32x16_bf16 v[16:31], v[136:139], v[96:99], v[16:31]
    s_add_u32 m0, s48, 65536
    s_nop 0
    buffer_load_dwordx4 v14, s[8:11], 0 offen offset:0 lds
    buffer_load_dwordx4 v14, s[8:11], 0 offen offset:1024 lds
    v_mfma_f32_32x32x16_bf16 v[32:47], v[136:139], v[100:103], v[32:47]
    v_mfma_f32_32x32x16_bf16 v[16:31], v[140:143], v[104:107], v[16:31]
    v_mfma_f32_32x32x16_bf16 v[32:47], v[140:143], v[108:111], v[32:47]
    ds_read_b128 v[96:99], v3 offset:6144
    ds_read_b128 v[100:103], v3 offset:38912
    ds_read_b128 v[104:107], v3 offset:7168
    ds_read_b128 v[108:111], v3 offset:39936
    s_waitcnt lgkmcnt(4)
    v_mfma_f32_32x32x16_bf16 v[16:31], v[144:147], v[80:83], v[16:31]
    s_add_u32 m0, s48, 24576
    s_nop 0
    buffer_load_dwordx4 v13, s[8:11], s46 offen offset:0 lds
    buffer_load_dwordx4 v13, s[8:11], s46 offen offset:1024 lds
    v_mfma_f32_32x32x16_bf16 v[32:47], v[144:147], v[84:87], v[32:47]
    v_mfma_f32_32x32x16_bf16 v[16:31], v[148:151], v[88:91], v[16:31]
    v_mfma_f32_32x32x16_bf16 v[32:47], v[148:151], v[92:95], v[32:47]
    s_waitcnt vmcnt(6)
    s_barrier
    ds_read_b128 v[80:83], v3 offset:8192
    ds_read_b128 v[84:87], v3 offset:40960
    ds_read_b128 v[88:91], v3 offset:9216
    ds_read_b128 v[92:95], v3 offset:41984
    s_waitcnt lgkmcnt(4)
    v_mfma_f32_32x32x16_bf16 v[16:31], v[152:155], v[96:99], v[16:31]
    s_add_u32 m0, s48, 73728
    s_nop 0
    buffer_load_dwordx4 v14, s[8:11], s42 offen offset:0 lds
    buffer_load_dwordx4 v14, s[8:11], s42 offen offset:1024 lds
    v_mfma_f32_32x32x16_bf16 v[32:47], v[152:155], v[100:103], v[32:47]
    v_mfma_f32_32x32x16_bf16 v[16:31], v[156:159], v[104:107], v[16:31]
    v_mfma_f32_32x32x16_bf16 v[32:47], v[156:159], v[108:111], v[32:47]
    ds_read_b128 v[96:99], v3 offset:10240
    ds_read_b128 v[100:103], v3 offset:43008
    ds_read_b128 v[104:107], v3 offset:11264
    ds_read_b128 v[108:111], v3 offset:44032
    s_waitcnt lgkmcnt(4)
    v_mfma_f32_32x32x16_bf16 v[16:31], v[160:163], v[80:83], v[16:31]
    s_add_u32 m0, s48, 81920
    s_nop 0
    buffer_load_dwordx4 v14, s[8:11], s44 offen offset:0 lds
    buffer_load_dwordx4 v14, s[8:11], s44 offen offset:1024 lds
    v_mfma_f32_32x32x16_bf16 v[32:47], v[160:163], v[84:87], v[32:47]
    v_mfma_f32_32x32x16_bf16 v[16:31], v[164:167], v[88:91], v[16:31]
    v_mfma_f32_32x32x16_bf16 v[32:47], v[164:167], v[92:95], v[32:47]
    ds_read_b128 v[80:83], v3 offset:12288
    ds_read_b128 v[84:87], v3 offset:45056
    ds_read_b128 v[88:91], v3 offset:13312
    ds_read_b128 v[92:95], v3 offset:46080
    s_waitcnt lgkmcnt(4)
    v_mfma_f32_32x32x16_bf16 v[16:31], v[168:171], v[96:99], v[16:31]
    s_add_u32 m0, s48, 90112
    s_nop 0
    buffer_load_dwordx4 v14, s[8:11], s46 offen offset:0 lds
    buffer_load_dwordx4 v14, s[8:11], s46 offen offset:1024 lds
    v_mfma_f32_32x32x16_bf16 v[32:47], v[168:171], v[100:103], v[32:47]
    v_mfma_f32_32x32x16_bf16 v[16:31], v[172:175], v[104:107], v[16:31]
    v_mfma_f32_32x32x16_bf16 v[32:47], v[172:175], v[108:111], v[32:47]
    ds_read_b128 v[96:99], v3 offset:14336
    ds_read_b128 v[100:103], v3 offset:47104
    ds_read_b128 v[104:107], v3 offset:15360
    ds_read_b128 v[108:111], v3 offset:48128
    s_waitcnt lgkmcnt(4)
    v_mfma_f32_32x32x16_bf16 v[16:31], v[176:179], v[80:83], v[16:31]
    v_mfma_f32_32x32x16_bf16 v[32:47], v[176:179], v[84:87], v[32:47]
    v_mfma_f32_32x32x16_bf16 v[16:31], v[180:183], v[88:91], v[16:31]
    v_mfma_f32_32x32x16_bf16 v[32:47], v[180:183], v[92:95], v[32:47]
    s_waitcnt vmcnt(8)
    s_barrier
    ds_read_b128 v[80:83], v3 offset:16384
    ds_read_b128 v[84:87], v3 offset:49152
    ds_read_b128 v[88:91], v3 offset:17408
    ds_read_b128 v[92:95], v3 offset:50176
    s_waitcnt lgkmcnt(4)
    v_mfma_f32_32x32x16_bf16 v[16:31], v[184:187], v[96:99], v[16:31]
    v_mfma_f32_32x32x16_bf16 v[32:47], v[184:187], v[100:103], v[32:47]
    v_mfma_f32_32x32x16_bf16 v[16:31], v[188:191], v[104:107], v[16:31]
    v_mfma_f32_32x32x16_bf16 v[32:47], v[188:191], v[108:111], v[32:47]
    ds_read_b128 v[96:99], v3 offset:18432
    ds_read_b128 v[100:103], v3 offset:51200
    ds_read_b128 v[104:107], v3 offset:19456
    ds_read_b128 v[108:111], v3 offset:52224
    s_waitcnt lgkmcnt(4)
    v_mfma_f32_32x32x16_bf16 v[16:31], v[192:195], v[80:83], v[16:31]
    v_mfma_f32_32x32x16_bf16 v[32:47], v[192:195], v[84:87], v[32:47]
    v_mfma_f32_32x32x16_bf16 v[16:31], v[196:199], v[88:91], v[16:31]
    v_mfma_f32_32x32x16_bf16 v[32:47], v[196:199], v[92:95], v[32:47]
    ds_read_b128 v[80:83], v3 offset:20480
    ds_read_b128 v[84:87], v3 offset:53248
    ds_read_b128 v[88:91], v7 offset:0
    ds_read_b128 v[92:95], v7 offset:32768
    s_waitcnt lgkmcnt(4)
    v_mfma_f32_32x32x16_bf16 v[16:31], v[200:203], v[96:99], v[16:31]
    v_mfma_f32_32x32x16_bf16 v[32:47], v[200:203], v[100:103], v[32:47]
    v_mfma_f32_32x32x16_bf16 v[16:31], v[204:207], v[104:107], v[16:31]
    v_mfma_f32_32x32x16_bf16 v[32:47], v[204:207], v[108:111], v[32:47]
    ds_read_b128 v[96:99], v3 offset:21504
    ds_read_b128 v[100:103], v3 offset:54272
    ds_read_b128 v[104:107], v7 offset:1024
    ds_read_b128 v[108:111], v7 offset:33792
    s_waitcnt lgkmcnt(4)
    s_cmp_lg_u32 s20, 0
    s_cbranch_scc1 l0_fb33
    s_mov_b64 exec, 1
    buffer_store_dword v4, v0, s[8:11], s34 offen offset:128 sc0 sc1
    s_mov_b64 exec, -1
l0_fb33:
    v_mfma_f32_32x32x16_bf16 v[16:31], v[208:211], v[80:83], v[16:31]
    v_mfma_f32_32x32x16_bf16 v[32:47], v[208:211], v[84:87], v[32:47]
    v_mfma_f32_32x32x16_bf16 v[48:63], v[128:131], v[88:91], 0
    v_mfma_f32_32x32x16_bf16 v[64:79], v[128:131], v[92:95], 0
    s_waitcnt vmcnt(0)
    s_barrier
    ds_read_b128 v[80:83], v3 offset:22528
    ds_read_b128 v[84:87], v3 offset:55296
    ds_read_b128 v[88:91], v7 offset:2048
    ds_read_b128 v[92:95], v7 offset:34816
    s_waitcnt lgkmcnt(4)
    v_mfma_f32_32x32x16_bf16 v[16:31], v[212:215], v[96:99], v[16:31]
    buffer_load_dwordx4 v[128:131], v15, s[8:11], 0 offen offset:0
    v_mfma_f32_32x32x16_bf16 v[32:47], v[212:215], v[100:103], v[32:47]
    v_mfma_f32_32x32x16_bf16 v[48:63], v[132:135], v[104:107], v[48:63]
    v_mfma_f32_32x32x16_bf16 v[64:79], v[132:135], v[108:111], v[64:79]
    ds_read_b128 v[96:99], v3 offset:23552
    ds_read_b128 v[100:103], v3 offset:56320
    ds_read_b128 v[104:107], v7 offset:3072
    ds_read_b128 v[108:111], v7 offset:35840
    s_waitcnt lgkmcnt(4)
    s_setprio 3
    v_mfma_f32_32x32x16_bf16 v[16:31], v[216:219], v[80:83], v[16:31]
    buffer_load_dwordx4 v[132:135], v9, s[8:11], 0 offen offset:0
    v_mfma_f32_32x32x16_bf16 v[32:47], v[216:219], v[84:87], v[32:47]
    v_mfma_f32_32x32x16_bf16 v[48:63], v[136:139], v[88:91], v[48:63]
    v_mfma_f32_32x32x16_bf16 v[64:79], v[136:139], v[92:95], v[64:79]
    ds_read_b128 v[80:83], v3 offset:24576
    ds_read_b128 v[84:87], v3 offset:57344
    ds_read_b128 v[88:91], v7 offset:4096
    ds_read_b128 v[92:95], v7 offset:36864
    s_waitcnt lgkmcnt(4)
    v_mfma_f32_32x32x16_bf16 v[16:31], v[220:223], v[96:99], v[16:31]
    buffer_load_dwordx4 v[136:139], v15, s[8:11], 0 offen offset:1024
    v_mfma_f32_32x32x16_bf16 v[32:47], v[220:223], v[100:103], v[32:47]
    v_mfma_f32_32x32x16_bf16 v[48:63], v[140:143], v[104:107], v[48:63]
    v_mfma_f32_32x32x16_bf16 v[64:79], v[140:143], v[108:111], v[64:79]
    ds_read_b128 v[96:99], v3 offset:25600
    ds_read_b128 v[100:103], v3 offset:58368
    ds_read_b128 v[104:107], v7 offset:5120
    ds_read_b128 v[108:111], v7 offset:37888
    s_waitcnt lgkmcnt(4)
    v_mfma_f32_32x32x16_bf16 v[16:31], v[224:227], v[80:83], v[16:31]
    buffer_load_dwordx4 v[140:143], v9, s[8:11], 0 offen offset:1024
    v_mfma_f32_32x32x16_bf16 v[32:47], v[224:227], v[84:87], v[32:47]
    v_mfma_f32_32x32x16_bf16 v[48:63], v[144:147], v[88:91], v[48:63]
    v_mfma_f32_32x32x16_bf16 v[64:79], v[144:147], v[92:95], v[64:79]
    ds_read_b128 v[80:83], v3 offset:26624
    ds_read_b128 v[84:87], v3 offset:59392
    ds_read_b128 v[88:91], v7 offset:6144
    ds_read_b128 v[92:95], v7 offset:38912
    s_waitcnt lgkmcnt(4)
    v_mfma_f32_32x32x16_bf16 v[16:31], v[228:231], v[96:99], v[16:31]
    buffer_load_dwordx4 v[144:147], v15, s[8:11], 0 offen offset:2048
    v_mfma_f32_32x32x16_bf16 v[32:47], v[228:231], v[100:103], v[32:47]
    v_mfma_f32_32x32x16_bf16 v[48:63], v[148:151], v[104:107], v[48:63]
    v_mfma_f32_32x32x16_bf16 v[64:79], v[148:151], v[108:111], v[64:79]
    ds_read_b128 v[96:99], v3 offset:27648
    ds_read_b128 v[100:103], v3 offset:60416
    ds_read_b128 v[104:107], v7 offset:7168
    ds_read_b128 v[108:111], v7 offset:39936
    s_waitcnt lgkmcnt(4)
    v_mfma_f32_32x32x16_bf16 v[16:31], v[232:235], v[80:83], v[16:31]
    buffer_load_dwordx4 v[148:151], v9, s[8:11], 0 offen offset:2048
    v_mfma_f32_32x32x16_bf16 v[32:47], v[232:235], v[84:87], v[32:47]
    v_mfma_f32_32x32x16_bf16 v[48:63], v[152:155], v[88:91], v[48:63]
    v_mfma_f32_32x32x16_bf16 v[64:79], v[152:155], v[92:95], v[64:79]
    ds_read_b128 v[80:83], v3 offset:28672
    ds_read_b128 v[84:87], v3 offset:61440
    ds_read_b128 v[88:91], v7 offset:8192
    ds_read_b128 v[92:95], v7 offset:40960
    s_waitcnt lgkmcnt(4)
    v_mfma_f32_32x32x16_bf16 v[16:31], v[236:239], v[96:99], v[16:31]
    buffer_load_dwordx4 v[152:155], v15, s[8:11], 0 offen offset:3072
    v_mfma_f32_32x32x16_bf16 v[32:47], v[236:239], v[100:103], v[32:47]
    v_mfma_f32_32x32x16_bf16 v[48:63], v[156:159], v[104:107], v[48:63]
    v_mfma_f32_32x32x16_bf16 v[64:79], v[156:159], v[108:111], v[64:79]
    ds_read_b128 v[96:99], v3 offset:29696
    ds_read_b128 v[100:103], v3 offset:62464
    ds_read_b128 v[104:107], v7 offset:9216
    ds_read_b128 v[108:111], v7 offset:41984
    s_waitcnt lgkmcnt(4)
    v_mfma_f32_32x32x16_bf16 v[16:31], v[240:243], v[80:83], v[16:31]
    buffer_load_dwordx4 v[156:159], v9, s[8:11], 0 offen offset:3072
    v_mfma_f32_32x32x16_bf16 v[32:47], v[240:243], v[84:87], v[32:47]
    v_mfma_f32_32x32x16_bf16 v[48:63], v[160:163], v[88:91], v[48:63]
    v_mfma_f32_32x32x16_bf16 v[64:79], v[160:163], v[92:95], v[64:79]
    s_barrier
    ds_read_b128 v[80:83], v3 offset:30720
    ds_read_b128 v[84:87], v3 offset:63488
    ds_read_b128 v[88:91], v7 offset:10240
    ds_read_b128 v[92:95], v7 offset:43008
    s_waitcnt lgkmcnt(4)
    v_mfma_f32_32x32x16_bf16 v[16:31], v[244:247], v[96:99], v[16:31]
    buffer_load_dwordx4 v[160:163], v15, s[8:11], s41 offen offset:0
    v_mfma_f32_32x32x16_bf16 v[32:47], v[244:247], v[100:103], v[32:47]
    v_mfma_f32_32x32x16_bf16 v[48:63], v[164:167], v[104:107], v[48:63]
    v_mfma_f32_32x32x16_bf16 v[64:79], v[164:167], v[108:111], v[64:79]
    ds_read_b128 v[96:99], v3 offset:31744
    ds_read_b128 v[100:103], v3 offset:64512
    ds_read_b128 v[104:107], v7 offset:11264
    ds_read_b128 v[108:111], v7 offset:44032
    ds_read_b128 v[112:115], v10 offset:0
    ds_read_b128 v[116:119], v10 offset:32
    ds_read_b128 v[120:123], v10 offset:64
    ds_read_b128 v[124:127], v10 offset:96
    s_waitcnt lgkmcnt(8)
    v_mfma_f32_32x32x16_bf16 v[16:31], v[248:251], v[80:83], v[16:31]
    buffer_load_dwordx4 v[164:167], v9, s[8:11], s41 offen offset:0
    v_mfma_f32_32x32x16_bf16 v[32:47], v[248:251], v[84:87], v[32:47]
    v_mfma_f32_32x32x16_bf16 v[48:63], v[168:171], v[88:91], v[48:63]
    v_mfma_f32_32x32x16_bf16 v[64:79], v[168:171], v[92:95], v[64:79]
    ds_read_b128 v[80:83], v7 offset:12288
    ds_read_b128 v[84:87], v7 offset:45056
    ds_read_b128 v[88:91], v7 offset:13312
    ds_read_b128 v[92:95], v7 offset:46080
    ds_read_b128 v[10:13], v8
    s_waitcnt lgkmcnt(9)
    v_mfma_f32_32x32x16_bf16 v[16:31], v[252:255], v[96:99], v[16:31]
    buffer_load_dwordx4 v[168:171], v15, s[8:11], s41 offen offset:1024
    v_mfma_f32_32x32x16_bf16 v[32:47], v[252:255], v[100:103], v[32:47]
    v_mfma_f32_32x32x16_bf16 v[48:63], v[172:175], v[104:107], v[48:63]
    v_mfma_f32_32x32x16_bf16 v[64:79], v[172:175], v[108:111], v[64:79]
    ds_read_b128 v[96:99], v7 offset:14336
    ds_read_b128 v[100:103], v7 offset:47104
    ds_read_b128 v[104:107], v7 offset:15360
    ds_read_b128 v[108:111], v7 offset:48128
    s_waitcnt lgkmcnt(5)
    v_mfma_f32_32x32x16_bf16 v[48:63], v[176:179], v[80:83], v[48:63]
    buffer_load_dwordx4 v[172:175], v9, s[8:11], s41 offen offset:1024
    v_mfma_f32_32x32x16_bf16 v[64:79], v[176:179], v[84:87], v[64:79]
    v_mfma_f32_32x32x16_bf16 v[48:63], v[180:183], v[88:91], v[48:63]
    v_mfma_f32_32x32x16_bf16 v[64:79], v[180:183], v[92:95], v[64:79]
    s_waitcnt lgkmcnt(4)
    s_nop 3
    v_pk_fma_f32 v[16:17], v[10:11], v[112:113], v[16:17]
    v_pk_fma_f32 v[18:19], v[10:11], v[114:115], v[18:19]
    v_pk_fma_f32 v[20:21], v[10:11], v[116:117], v[20:21]
    v_pk_fma_f32 v[22:23], v[10:11], v[118:119], v[22:23]
    v_pk_fma_f32 v[24:25], v[10:11], v[120:121], v[24:25]
    v_pk_fma_f32 v[26:27], v[10:11], v[122:123], v[26:27]
    v_pk_fma_f32 v[28:29], v[10:11], v[124:125], v[28:29]
    v_pk_fma_f32 v[30:31], v[10:11], v[126:127], v[30:31]
    v_pk_mul_f32 v[16:17], v[16:17], v[24:25]
    v_pk_mul_f32 v[18:19], v[18:19], v[26:27]
    v_pk_mul_f32 v[20:21], v[20:21], v[28:29]
    v_pk_mul_f32 v[22:23], v[22:23], v[30:31]
    v_pk_mul_f32 v[16:17], v[16:17], v[12:13]
    v_pk_mul_f32 v[18:19], v[18:19], v[12:13]
    v_pk_mul_f32 v[20:21], v[20:21], v[12:13]
    v_pk_mul_f32 v[22:23], v[22:23], v[12:13]
    v_cvt_pk_bf16_f32 v24, v16, v17
    v_cvt_pk_bf16_f32 v25, v18, v19
    v_cvt_pk_bf16_f32 v26, v20, v21
    v_cvt_pk_bf16_f32 v27, v22, v23
    buffer_store_dwordx4 v[24:27], v3, s[8:11], s39 offen sc0 sc1
    s_add_u32 s39, s39, 114688
    ds_read_b128 v[10:13], v8 offset:1024
    ds_read_b128 v[80:83], v7 offset:16384
    ds_read_b128 v[84:87], v7 offset:49152
    ds_read_b128 v[88:91], v7 offset:17408
    ds_read_b128 v[92:95], v7 offset:50176
    s_waitcnt lgkmcnt(5)
    v_mfma_f32_32x32x16_bf16 v[48:63], v[184:187], v[96:99], v[48:63]
    buffer_load_dwordx4 v[176:179], v15, s[8:11], s41 offen offset:2048
    v_mfma_f32_32x32x16_bf16 v[64:79], v[184:187], v[100:103], v[64:79]
    buffer_load_dwordx4 v[180:183], v9, s[8:11], s41 offen offset:2048
    v_mfma_f32_32x32x16_bf16 v[48:63], v[188:191], v[104:107], v[48:63]
    v_mfma_f32_32x32x16_bf16 v[64:79], v[188:191], v[108:111], v[64:79]
    s_waitcnt lgkmcnt(4)
    v_pk_fma_f32 v[32:33], v[10:11], v[112:113], v[32:33]
    v_pk_fma_f32 v[34:35], v[10:11], v[114:115], v[34:35]
    v_pk_fma_f32 v[36:37], v[10:11], v[116:117], v[36:37]
    v_pk_fma_f32 v[38:39], v[10:11], v[118:119], v[38:39]
    v_pk_fma_f32 v[40:41], v[10:11], v[120:121], v[40:41]
    v_pk_fma_f32 v[42:43], v[10:11], v[122:123], v[42:43]
    v_pk_fma_f32 v[44:45], v[10:11], v[124:125], v[44:45]
    v_pk_fma_f32 v[46:47], v[10:11], v[126:127], v[46:47]
    v_pk_mul_f32 v[32:33], v[32:33], v[40:41]
    v_pk_mul_f32 v[34:35], v[34:35], v[42:43]
    v_pk_mul_f32 v[36:37], v[36:37], v[44:45]
    v_pk_mul_f32 v[38:39], v[38:39], v[46:47]
    v_pk_mul_f32 v[32:33], v[32:33], v[12:13]
    v_pk_mul_f32 v[34:35], v[34:35], v[12:13]
    v_pk_mul_f32 v[36:37], v[36:37], v[12:13]
    v_pk_mul_f32 v[38:39], v[38:39], v[12:13]
    v_cvt_pk_bf16_f32 v40, v32, v33
    v_cvt_pk_bf16_f32 v41, v34, v35
    v_cvt_pk_bf16_f32 v42, v36, v37
    v_cvt_pk_bf16_f32 v43, v38, v39
    buffer_store_dwordx4 v[40:43], v3, s[8:11], s39 offen sc0 sc1
    s_add_u32 s39, s39, 114688
    ds_read_b128 v[96:99], v7 offset:18432
    ds_read_b128 v[100:103], v7 offset:51200
    ds_read_b128 v[104:107], v7 offset:19456
    ds_read_b128 v[108:111], v7 offset:52224
    s_waitcnt lgkmcnt(4)
    s_setprio 2
    v_mfma_f32_32x32x16_bf16 v[48:63], v[192:195], v[80:83], v[48:63]
    buffer_load_dwordx4 v[184:187], v15, s[8:11], s41 offen offset:3072
    v_mfma_f32_32x32x16_bf16 v[64:79], v[192:195], v[84:87], v[64:79]
    buffer_load_dwordx4 v[188:191], v9, s[8:11], s41 offen offset:3072
    v_mfma_f32_32x32x16_bf16 v[48:63], v[196:199], v[88:91], v[48:63]
    v_mfma_f32_32x32x16_bf16 v[64:79], v[196:199], v[92:95], v[64:79]
    ds_read_b128 v[80:83], v7 offset:20480
    ds_read_b128 v[84:87], v7 offset:53248
    ds_read_b128 v[88:91], v7 offset:21504
    ds_read_b128 v[92:95], v7 offset:54272
    ds_read_b128 v[16:19], v8 offset:2048
    ds_read_b128 v[20:23], v8 offset:3072
    s_waitcnt lgkmcnt(6)
    v_mfma_f32_32x32x16_bf16 v[48:63], v[200:203], v[96:99], v[48:63]
    buffer_load_dwordx4 v[192:195], v15, s[8:11], s42 offen offset:0
    v_mfma_f32_32x32x16_bf16 v[64:79], v[200:203], v[100:103], v[64:79]
    buffer_load_dwordx4 v[196:199], v9, s[8:11], s42 offen offset:0
    v_mfma_f32_32x32x16_bf16 v[48:63], v[204:207], v[104:107], v[48:63]
    v_mfma_f32_32x32x16_bf16 v[64:79], v[204:207], v[108:111], v[64:79]
    ds_read_b128 v[96:99], v7 offset:22528
    ds_read_b128 v[100:103], v7 offset:55296
    ds_read_b128 v[104:107], v7 offset:23552
    ds_read_b128 v[108:111], v7 offset:56320
    s_waitcnt lgkmcnt(6)
    v_mfma_f32_32x32x16_bf16 v[48:63], v[208:211], v[80:83], v[48:63]
    buffer_load_dwordx4 v[200:203], v15, s[8:11], s42 offen offset:1024
    v_mfma_f32_32x32x16_bf16 v[64:79], v[208:211], v[84:87], v[64:79]
    buffer_load_dwordx4 v[204:207], v9, s[8:11], s42 offen offset:1024
    v_mfma_f32_32x32x16_bf16 v[48:63], v[212:215], v[88:91], v[48:63]
    v_mfma_f32_32x32x16_bf16 v[64:79], v[212:215], v[92:95], v[64:79]
    s_waitcnt vmcnt(6)
    s_barrier
    ds_read_b128 v[80:83], v7 offset:24576
    ds_read_b128 v[84:87], v7 offset:57344
    ds_read_b128 v[88:91], v7 offset:25600
    ds_read_b128 v[92:95], v7 offset:58368
    s_waitcnt lgkmcnt(4)
    v_mfma_f32_32x32x16_bf16 v[48:63], v[216:219], v[96:99], v[48:63]
    buffer_load_dwordx4 v[208:211], v15, s[8:11], s42 offen offset:2048
    v_mfma_f32_32x32x16_bf16 v[64:79], v[216:219], v[100:103], v[64:79]
    buffer_load_dwordx4 v[212:215], v9, s[8:11], s42 offen offset:2048
    v_mfma_f32_32x32x16_bf16 v[48:63], v[220:223], v[104:107], v[48:63]
    v_mfma_f32_32x32x16_bf16 v[64:79], v[220:223], v[108:111], v[64:79]
    ds_read_b128 v[96:99], v7 offset:26624
    ds_read_b128 v[100:103], v7 offset:59392
    ds_read_b128 v[104:107], v7 offset:27648
    ds_read_b128 v[108:111], v7 offset:60416
    s_waitcnt lgkmcnt(4)
    v_mfma_f32_32x32x16_bf16 v[48:63], v[224:227], v[80:83], v[48:63]
    buffer_load_dwordx4 v[216:219], v15, s[8:11], s42 offen offset:3072
    v_mfma_f32_32x32x16_bf16 v[64:79], v[224:227], v[84:87], v[64:79]
    buffer_load_dwordx4 v[220:223], v9, s[8:11], s42 offen offset:3072
    v_mfma_f32_32x32x16_bf16 v[48:63], v[228:231], v[88:91], v[48:63]
    v_mfma_f32_32x32x16_bf16 v[64:79], v[228:231], v[92:95], v[64:79]
    ds_read_b128 v[80:83], v7 offset:28672
    ds_read_b128 v[84:87], v7 offset:61440
    ds_read_b128 v[88:91], v7 offset:29696
    ds_read_b128 v[92:95], v7 offset:62464
    s_waitcnt lgkmcnt(4)
    s_setprio 0
    v_mfma_f32_32x32x16_bf16 v[48:63], v[232:235], v[96:99], v[48:63]
    buffer_load_dwordx4 v[224:227], v15, s[8:11], s43 offen offset:0
    v_mfma_f32_32x32x16_bf16 v[64:79], v[232:235], v[100:103], v[64:79]
    buffer_load_dwordx4 v[228:231], v9, s[8:11], s43 offen offset:0
    v_mfma_f32_32x32x16_bf16 v[48:63], v[236:239], v[104:107], v[48:63]
    v_mfma_f32_32x32x16_bf16 v[64:79], v[236:239], v[108:111], v[64:79]
    ds_read_b128 v[96:99], v7 offset:30720
    ds_read_b128 v[100:103], v7 offset:63488
    ds_read_b128 v[104:107], v7 offset:31744
    ds_read_b128 v[108:111], v7 offset:64512
    s_waitcnt lgkmcnt(4)
    v_mfma_f32_32x32x16_bf16 v[48:63], v[240:243], v[80:83], v[48:63]
    buffer_load_dwordx4 v[232:235], v15, s[8:11], s43 offen offset:1024
    v_mfma_f32_32x32x16_bf16 v[64:79], v[240:243], v[84:87], v[64:79]
    buffer_load_dwordx4 v[236:239], v9, s[8:11], s43 offen offset:1024
    v_mfma_f32_32x32x16_bf16 v[48:63], v[244:247], v[88:91], v[48:63]
    v_mfma_f32_32x32x16_bf16 v[64:79], v[244:247], v[92:95], v[64:79]
    s_waitcnt lgkmcnt(0)
    v_mfma_f32_32x32x16_bf16 v[48:63], v[248:251], v[96:99], v[48:63]
    v_mfma_f32_32x32x16_bf16 v[64:79], v[248:251], v[100:103], v[64:79]
    v_mfma_f32_32x32x16_bf16 v[48:63], v[252:255], v[104:107], v[48:63]
    v_mfma_f32_32x32x16_bf16 v[64:79], v[252:255], v[108:111], v[64:79]
    s_lshl_b32 s30, s20, 1
    s_lshl_b32 s32, 3, s30
    s_lshl_b32 s35, s21, 8
    s_add_u32 s35, s35, 24743936
    s_mov_b64 exec, s[32:33]
    buffer_load_dword v2, v0, s[8:11], s35 offen sc1
    s_mov_b64 exec, -1
    s_waitcnt lgkmcnt(0)
    s_nop 11
    v_pk_fma_f32 v[48:49], v[16:17], v[112:113], v[48:49]
    v_pk_fma_f32 v[50:51], v[16:17], v[114:115], v[50:51]
    v_pk_fma_f32 v[52:53], v[16:17], v[116:117], v[52:53]
    v_pk_fma_f32 v[54:55], v[16:17], v[118:119], v[54:55]
    v_pk_fma_f32 v[56:57], v[16:17], v[120:121], v[56:57]
    v_pk_fma_f32 v[58:59], v[16:17], v[122:123], v[58:59]
    v_pk_fma_f32 v[60:61], v[16:17], v[124:125], v[60:61]
    v_pk_fma_f32 v[62:63], v[16:17], v[126:127], v[62:63]
    v_pk_mul_f32 v[48:49], v[48:49], v[56:57]
    v_pk_mul_f32 v[50:51], v[50:51], v[58:59]
    v_pk_mul_f32 v[52:53], v[52:53], v[60:61]
    v_pk_mul_f32 v[54:55], v[54:55], v[62:63]
    v_pk_mul_f32 v[48:49], v[48:49], v[18:19]
    v_pk_mul_f32 v[50:51], v[50:51], v[18:19]
    v_pk_mul_f32 v[52:53], v[52:53], v[18:19]
    v_pk_mul_f32 v[54:55], v[54:55], v[18:19]
    v_cvt_pk_bf16_f32 v56, v48, v49
    v_cvt_pk_bf16_f32 v57, v50, v51
    v_cvt_pk_bf16_f32 v58, v52, v53
    v_cvt_pk_bf16_f32 v59, v54, v55
    buffer_store_dwordx4 v[56:59], v3, s[8:11], s39 offen sc0 sc1
    s_add_u32 s39, s39, 114688
    v_pk_fma_f32 v[64:65], v[20:21], v[112:113], v[64:65]
    v_pk_fma_f32 v[66:67], v[20:21], v[114:115], v[66:67]
    v_pk_fma_f32 v[68:69], v[20:21], v[116:117], v[68:69]
    v_pk_fma_f32 v[70:71], v[20:21], v[118:119], v[70:71]
    v_pk_fma_f32 v[72:73], v[20:21], v[120:121], v[72:73]
    v_pk_fma_f32 v[74:75], v[20:21], v[122:123], v[74:75]
    v_pk_fma_f32 v[76:77], v[20:21], v[124:125], v[76:77]
    v_pk_fma_f32 v[78:79], v[20:21], v[126:127], v[78:79]
    v_pk_mul_f32 v[64:65], v[64:65], v[72:73]
    v_pk_mul_f32 v[66:67], v[66:67], v[74:75]
    v_pk_mul_f32 v[68:69], v[68:69], v[76:77]
    v_pk_mul_f32 v[70:71], v[70:71], v[78:79]
    v_pk_mul_f32 v[64:65], v[64:65], v[22:23]
    v_pk_mul_f32 v[66:67], v[66:67], v[22:23]
    v_pk_mul_f32 v[68:69], v[68:69], v[22:23]
    v_pk_mul_f32 v[70:71], v[70:71], v[22:23]
    v_cvt_pk_bf16_f32 v72, v64, v65
    v_cvt_pk_bf16_f32 v73, v66, v67
    v_cvt_pk_bf16_f32 v74, v68, v69
    v_cvt_pk_bf16_f32 v75, v70, v71
    buffer_store_dwordx4 v[72:75], v3, s[8:11], s39 offen sc0 sc1
    s_waitcnt vmcnt(2)
    s_mov_b64 exec, s[32:33]
    s_mov_b32 s31, 0
l0_qa34:
    v_cmp_ne_u32 vcc, 0, v2
    s_cmp_eq_u64 vcc, s[32:33]
    s_cbranch_scc1 l0_qd36
    buffer_load_dword v2, v0, s[8:11], s35 offen sc1
    s_add_u32 s31, s31, 1
    s_waitcnt vmcnt(0)
    s_cmp_lt_u32 s31, 64
    s_cbranch_scc1 l0_qa34
l0_qb35:
    buffer_load_dword v2, v0, s[8:11], s35 offen sc1
    s_waitcnt vmcnt(0)
    v_cmp_ne_u32 s[36:37], 0, v2
    buffer_load_dword v2, v0, s[8:11], s35 offen offset:128 sc0 sc1
    s_waitcnt vmcnt(0)
    v_cmp_ne_u32 vcc, 0, v2
    s_add_u32 s31, s31, 1
    s_or_b64 vcc, vcc, s[36:37]
    s_cmp_eq_u64 vcc, s[32:33]
    s_cbranch_scc1 l0_qd36
    s_sleep 4
    s_cmp_lt_u32 s31, 1048576
    s_cbranch_scc1 l0_qb35
    s_branch k_end
l0_qd36:
    s_mov_b64 exec, -1
    buffer_load_dwordx4 v[24:27], v5, s[8:11], 0 offen offset:0
    buffer_load_dwordx4 v[28:31], v5, s[8:11], 0 offen offset:1024
    buffer_load_dwordx4 v[32:35], v5, s[8:11], 0 offen offset:2048
    buffer_load_dwordx4 v[36:39], v5, s[8:11], 0 offen offset:3072
    buffer_load_dwordx4 v[40:43], v5, s[8:11], s41 offen offset:0
    buffer_load_dwordx4 v[44:47], v5, s[8:11], s41 offen offset:1024
    s_branch l0_ge32
l0_gs31:
    s_mul_i32 s39, s21, 448
    s_add_u32 s39, s39, s40
    s_lshl_b32 s39, s39, 10
    s_add_u32 s39, s39, 15147008
    s_waitcnt vmcnt(2)
    s_barrier
    s_add_u32 m0, s48, 16384
    s_nop 0
    buffer_load_dwordx4 v13, s[8:11], s44 offen offset:0 lds
    buffer_load_dwordx4 v13, s[8:11], s44 offen offset:1024 lds
    s_add_u32 m0, s48, 65536
    s_nop 0
    buffer_load_dwordx4 v14, s[8:11], 0 offen offset:0 lds
    buffer_load_dwordx4 v14, s[8:11], 0 offen offset:1024 lds
    s_add_u32 m0, s48, 24576
    s_nop 0
    buffer_load_dwordx4 v13, s[8:11], s46 offen offset:0 lds
    buffer_load_dwordx4 v13, s[8:11], s46 offen offset:1024 lds
    s_waitcnt vmcnt(6)
    s_barrier
    s_add_u32 m0, s48, 73728
    s_nop 0
    buffer_load_dwordx4 v14, s[8:11], s42 offen offset:0 lds
    buffer_load_dwordx4 v14, s[8:11], s42 offen offset:1024 lds
    s_add_u32 m0, s48, 81920
    s_nop 0
    buffer_load_dwordx4 v14, s[8:11], s44 offen offset:0 lds
    buffer_load_dwordx4 v14, s[8:11], s44 offen offset:1024 lds
    s_add_u32 m0, s48, 90112
    s_nop 0
    buffer_load_dwordx4 v14, s[8:11], s46 offen offset:0 lds
    buffer_load_dwordx4 v14, s[8:11], s46 offen offset:1024 lds
    v_mov_b32 v80, 0
    v_mov_b32 v81, 0
    v_mov_b32 v82, 137216
    ds_write_b64 v82, v[80:81]
    buffer_load_dwordx2 v[16:17], v12, s[8:11], 0 offen offset:0
    buffer_load_dwordx2 v[18:19], v12, s[8:11], 0 offen offset:256
    buffer_load_dwordx2 v[20:21], v12, s[8:11], 0 offen offset:512
    buffer_load_dwordx2 v[22:23], v12, s[8:11], 0 offen offset:768
    buffer_load_dwordx2 v[24:25], v12, s[8:11], 0 offen offset:1024
    buffer_load_dwordx2 v[26:27], v12, s[8:11], 0 offen offset:1280
    buffer_load_dwordx2 v[28:29], v12, s[8:11], 0 offen offset:1536
    buffer_load_dwordx2 v[30:31], v12, s[8:11], 0 offen offset:1792
    buffer_load_dwordx2 v[32:33], v12, s[8:11], 0 offen offset:2048
    buffer_load_dwordx2 v[34:35], v12, s[8:11], 0 offen offset:2304
    buffer_load_dwordx2 v[36:37], v12, s[8:11], 0 offen offset:2560
    buffer_load_dwordx2 v[38:39], v12, s[8:11], 0 offen offset:2816
    buffer_load_dwordx2 v[40:41], v12, s[8:11], 0 offen offset:3072
    buffer_load_dwordx2 v[42:43], v12, s[8:11], 0 offen offset:3328
    buffer_load_dwordx2 v[44:45], v12, s[8:11], 0 offen offset:3584
    buffer_load_dwordx2 v[46:47], v12, s[8:11], 0 offen offset:3840
    buffer_load_dwordx2 v[48:49], v12, s[8:11], s42 offen offset:0
    buffer_load_dwordx2 v[50:51], v12, s[8:11], s42 offen offset:256
    buffer_load_dwordx2 v[52:53], v12, s[8:11], s42 offen offset:512
    buffer_load_dwordx2 v[54:55], v12, s[8:11], s42 offen offset:768
    buffer_load_dwordx2 v[56:57], v12, s[8:11], s42 offen offset:1024
    buffer_load_dwordx2 v[58:59], v12, s[8:11], s42 offen offset:1280
    buffer_load_dwordx2 v[60:61], v12, s[8:11], s42 offen offset:1536
    buffer_load_dwordx2 v[62:63], v12, s[8:11], s42 offen offset:1792
    buffer_load_dwordx2 v[64:65], v12, s[8:11], s42 offen offset:2048
    buffer_load_dwordx2 v[66:67], v12, s[8:11], s42 offen offset:2304
    buffer_load_dwordx2 v[68:69], v12, s[8:11], s42 offen offset:2560
    buffer_load_dwordx2 v[70:71], v12, s[8:11], s42 offen offset:2816
    buffer_load_dwordx2 v[72:73], v12, s[8:11], s42 offen offset:3072
    buffer_load_dwordx2 v[74:75], v12, s[8:11], s42 offen offset:3328
    buffer_load_dwordx2 v[76:77], v12, s[8:11], s42 offen offset:3584
    buffer_load_dwordx2 v[78:79], v12, s[8:11], s42 offen offset:3840
    s_waitcnt vmcnt(40)
    s_barrier
    buffer_load_dwordx4 v[128:131], v15, s[8:11], 0 offen offset:0
    buffer_load_dwordx4 v[132:135], v9, s[8:11], 0 offen offset:0
    buffer_load_dwordx4 v[136:139], v15, s[8:11], 0 offen offset:1024
    buffer_load_dwordx4 v[140:143], v9, s[8:11], 0 offen offset:1024
    s_waitcnt vmcnt(20)
    v_add_f32 v16, v16, v32
    v_add_f32 v17, v17, v33
    v_add_f32 v18, v18, v34
    v_add_f32 v19, v19, v35
    v_add_f32 v20, v20, v36
    v_add_f32 v21, v21, v37
    v_add_f32 v22, v22, v38
    v_add_f32 v23, v23, v39
    v_add_f32 v24, v24, v40
    v_add_f32 v25, v25, v41
    v_add_f32 v26, v26, v42
    v_add_f32 v27, v27, v43
    v_add_f32 v28, v28, v44
    v_add_f32 v29, v29, v45
    v_add_f32 v30, v30, v46
    v_add_f32 v31, v31, v47
    v_add_f32 v16, v16, v24
    v_add_f32 v17, v17, v25
    v_add_f32 v18, v18, v26
    v_add_f32 v19, v19, v27
    v_add_f32 v20, v20, v28
    v_add_f32 v21, v21, v29
    v_add_f32 v22, v22, v30
    v_add_f32 v23, v23, v31
    v_add_f32 v16, v16, v20
    v_add_f32 v17, v17, v21
    v_add_f32 v18, v18, v22
    v_add_f32 v19, v19, v23
    v_add_f32 v16, v16, v18
    v_add_f32 v17, v17, v19
    v_mov_b32 v18, v16
    v_mov_b32 v19, v17
    s_nop 1
    v_permlane32_swap_b32 v16, v18
    v_permlane32_swap_b32 v17, v19
    v_add_f32 v16, v16, v18
    v_add_f32 v17, v17, v19
    v_mul_f32 v16, 0xbb000000, v16
    v_mul_f32 v17, 0x3b000000, v17
    v_fma_f32 v17, -v16, v16, v17
    v_max_f32 v17, 0, v17
    v_add_f32 v17, 0x3727c5ac, v17
    v_rcp_f32 v18, v17
    v_mov_b32 v17, v16
    v_mov_b32 v19, v18
    ds_write_b128 v8, v[16:19] offset:0
    s_waitcnt lgkmcnt(0)
    s_mul_i32 s30, s22, 896
    s_add_u32 s30, s30, 26370048
    buffer_load_dwordx4 v[16:19], v3, s[8:11], s30 offen
    s_add_u32 s30, s30, 14336
    buffer_load_dwordx4 v[20:23], v3, s[8:11], s30 offen
    s_add_u32 s30, s30, 14336
    buffer_load_dwordx4 v[24:27], v3, s[8:11], s30 offen
    s_add_u32 s30, s30, 14336
    buffer_load_dwordx4 v[28:31], v3, s[8:11], s30 offen
    s_add_u32 s30, s30, 14336
    buffer_load_dwordx4 v[32:35], v3, s[8:11], s30 offen
    s_add_u32 s30, s30, 14336
    buffer_load_dwordx4 v[36:39], v3, s[8:11], s30 offen
    s_add_u32 s30, s30, 14336
    buffer_load_dwordx4 v[40:43], v3, s[8:11], s30 offen
    s_add_u32 s30, s30, 14336
    buffer_load_dwordx4 v[44:47], v3, s[8:11], s30 offen
    s_waitcnt vmcnt(12)
    v_add_f32 v48, v48, v64
    v_add_f32 v49, v49, v65
    v_add_f32 v50, v50, v66
    v_add_f32 v51, v51, v67
    v_add_f32 v52, v52, v68
    v_add_f32 v53, v53, v69
    v_add_f32 v54, v54, v70
    v_add_f32 v55, v55, v71
    v_add_f32 v56, v56, v72
    v_add_f32 v57, v57, v73
    v_add_f32 v58, v58, v74
    v_add_f32 v59, v59, v75
    v_add_f32 v60, v60, v76
    v_add_f32 v61, v61, v77
    v_add_f32 v62, v62, v78
    v_add_f32 v63, v63, v79
    v_add_f32 v48, v48, v56
    v_add_f32 v49, v49, v57
    v_add_f32 v50, v50, v58
    v_add_f32 v51, v51, v59
    v_add_f32 v52, v52, v60
    v_add_f32 v53, v53, v61
    v_add_f32 v54, v54, v62
    v_add_f32 v55, v55, v63
    v_add_f32 v48, v48, v52
    v_add_f32 v49, v49, v53
    v_add_f32 v50, v50, v54
    v_add_f32 v51, v51, v55
    v_add_f32 v48, v48, v50
    v_add_f32 v49, v49, v51
    v_mov_b32 v50, v48
    v_mov_b32 v51, v49
    s_nop 1
    v_permlane32_swap_b32 v48, v50
    v_permlane32_swap_b32 v49, v51
    v_add_f32 v48, v48, v50
    v_add_f32 v49, v49, v51
    v_mul_f32 v48, 0xbb000000, v48
    v_mul_f32 v49, 0x3b000000, v49
    v_fma_f32 v49, -v48, v48, v49
    v_max_f32 v49, 0, v49
    v_add_f32 v49, 0x3727c5ac, v49
    v_rcp_f32 v50, v49
    v_mov_b32 v49, v48
    v_mov_b32 v51, v50
    ds_write_b128 v8, v[48:51] offset:1024
    s_waitcnt lgkmcnt(0)
    buffer_load_dwordx2 v[48:49], v12, s[8:11], s46 offen offset:0
    buffer_load_dwordx2 v[50:51], v12, s[8:11], s46 offen offset:256
    buffer_load_dwordx2 v[52:53], v12, s[8:11], s46 offen offset:512
    buffer_load_dwordx2 v[54:55], v12, s[8:11], s46 offen offset:768
    buffer_load_dwordx2 v[56:57], v12, s[8:11], s46 offen offset:1024
    buffer_load_dwordx2 v[58:59], v12, s[8:11], s46 offen offset:1280
    buffer_load_dwordx2 v[60:61], v12, s[8:11], s46 offen offset:1536
    buffer_load_dwordx2 v[62:63], v12, s[8:11], s46 offen offset:1792
    buffer_load_dwordx2 v[64:65], v12, s[8:11], s46 offen offset:2048
    buffer_load_dwordx2 v[66:67], v12, s[8:11], s46 offen offset:2304
    buffer_load_dwordx2 v[68:69], v12, s[8:11], s46 offen offset:2560
    buffer_load_dwordx2 v[70:71], v12, s[8:11], s46 offen offset:2816
    buffer_load_dwordx2 v[72:73], v12, s[8:11], s46 offen offset:3072
    buffer_load_dwordx2 v[74:75], v12, s[8:11], s46 offen offset:3328
    buffer_load_dwordx2 v[76:77], v12, s[8:11], s46 offen offset:3584
    buffer_load_dwordx2 v[78:79], v12, s[8:11], s46 offen offset:3840
    s_cmp_lg_u32 s20, 0
    s_cbranch_scc1 l0_fb37
    s_mov_b64 exec, 1
    buffer_store_dword v4, v0, s[8:11], s34 offen offset:128 sc0 sc1
    s_mov_b64 exec, -1
l0_fb37:
    buffer_load_dwordx4 v[144:147], v15, s[8:11], 0 offen offset:2048
    buffer_load_dwordx4 v[148:151], v9, s[8:11], 0 offen offset:2048
    s_barrier
    buffer_load_dwordx4 v[152:155], v15, s[8:11], 0 offen offset:3072
    buffer_load_dwordx4 v[156:159], v9, s[8:11], 0 offen offset:3072
    buffer_load_dwordx4 v[160:163], v15, s[8:11], s41 offen offset:0
    buffer_load_dwordx4 v[164:167], v9, s[8:11], s41 offen offset:0
    buffer_load_dwordx4 v[168:171], v15, s[8:11], s41 offen offset:1024
    buffer_load_dwordx4 v[172:175], v9, s[8:11], s41 offen offset:1024
    s_waitcnt vmcnt(24)
    v_add_f32 v16, v16, v32
    v_add_f32 v17, v17, v33
    v_add_f32 v18, v18, v34
    v_add_f32 v19, v19, v35
    v_add_f32 v20, v20, v36
    v_add_f32 v21, v21, v37
    v_add_f32 v22, v22, v38
    v_add_f32 v23, v23, v39
    v_add_f32 v24, v24, v40
    v_add_f32 v25, v25, v41
    v_add_f32 v26, v26, v42
    v_add_f32 v27, v27, v43
    v_add_f32 v28, v28, v44
    v_add_f32 v29, v29, v45
    v_add_f32 v30, v30, v46
    v_add_f32 v31, v31, v47
    v_add_f32 v16, v16, v24
    v_add_f32 v17, v17, v25
    v_add_f32 v18, v18, v26
    v_add_f32 v19, v19, v27
    v_add_f32 v20, v20, v28
    v_add_f32 v21, v21, v29
    v_add_f32 v22, v22, v30
    v_add_f32 v23, v23, v31
    v_add_f32 v16, v16, v20
    v_add_f32 v17, v17, v21
    v_add_f32 v18, v18, v22
    v_add_f32 v19, v19, v23
    v_add_u32 v10, 135168, v3
    ds_write_b128 v10, v[16:19]
    s_waitcnt lgkmcnt(0)
    buffer_load_dwordx2 v[16:17], v12, s[8:11], s44 offen offset:0
    buffer_load_dwordx2 v[18:19], v12, s[8:11], s44 offen offset:256
    buffer_load_dwordx2 v[20:21], v12, s[8:11], s44 offen offset:512
    buffer_load_dwordx2 v[22:23], v12, s[8:11], s44 offen offset:768
    buffer_load_dwordx2 v[24:25], v12, s[8:11], s44 offen offset:1024
    buffer_load_dwordx2 v[26:27], v12, s[8:11], s44 offen offset:1280
    buffer_load_dwordx2 v[28:29], v12, s[8:11], s44 offen offset:1536
    buffer_load_dwordx2 v[30:31], v12, s[8:11], s44 offen offset:1792
    buffer_load_dwordx2 v[32:33], v12, s[8:11], s44 offen offset:2048
    buffer_load_dwordx2 v[34:35], v12, s[8:11], s44 offen offset:2304
    buffer_load_dwordx2 v[36:37], v12, s[8:11], s44 offen offset:2560
    buffer_load_dwordx2 v[38:39], v12, s[8:11], s44 offen offset:2816
    buffer_load_dwordx2 v[40:41], v12, s[8:11], s44 offen offset:3072
    buffer_load_dwordx2 v[42:43], v12, s[8:11], s44 offen offset:3328
    buffer_load_dwordx2 v[44:45], v12, s[8:11], s44 offen offset:3584
    buffer_load_dwordx2 v[46:47], v12, s[8:11], s44 offen offset:3840
    s_waitcnt vmcnt(24)
    v_add_f32 v48, v48, v64
    v_add_f32 v49, v49, v65
    v_add_f32 v50, v50, v66
    v_add_f32 v51, v51, v67
    v_add_f32 v52, v52, v68
    v_add_f32 v53, v53, v69
    v_add_f32 v54, v54, v70
    v_add_f32 v55, v55, v71
    v_add_f32 v56, v56, v72
    v_add_f32 v57, v57, v73
    v_add_f32 v58, v58, v74
    v_add_f32 v59, v59, v75
    v_add_f32 v60, v60, v76
    v_add_f32 v61, v61, v77
    v_add_f32 v62, v62, v78
    v_add_f32 v63, v63, v79
    v_add_f32 v48, v48, v56
    v_add_f32 v49, v49, v57
    v_add_f32 v50, v50, v58
    v_add_f32 v51, v51, v59
    v_add_f32 v52, v52, v60
    v_add_f32 v53, v53, v61
    v_add_f32 v54, v54, v62
    v_add_f32 v55, v55, v63
    v_add_f32 v48, v48, v52
    v_add_f32 v49, v49, v53
    v_add_f32 v50, v50, v54
    v_add_f32 v51, v51, v55
    v_add_f32 v48, v48, v50
    v_add_f32 v49, v49, v51
    v_mov_b32 v50, v48
    v_mov_b32 v51, v49
    s_nop 1
    v_permlane32_swap_b32 v48, v50
    v_permlane32_swap_b32 v49, v51
    v_add_f32 v48, v48, v50
    v_add_f32 v49, v49, v51
    v_mul_f32 v48, 0xbb000000, v48
    v_mul_f32 v49, 0x3b000000, v49
    v_fma_f32 v49, -v48, v48, v49
    v_max_f32 v49, 0, v49
    v_add_f32 v49, 0x3727c5ac, v49
    v_rcp_f32 v50, v49
    v_mov_b32 v49, v48
    v_mov_b32 v51, v50
    ds_write_b128 v8, v[48:51] offset:3072
    s_waitcnt lgkmcnt(0)
    s_waitcnt vmcnt(0)
    v_add_f32 v16, v16, v32
    v_add_f32 v17, v17, v33
    v_add_f32 v18, v18, v34
    v_add_f32 v19, v19, v35
    v_add_f32 v20, v20, v36
    v_add_f32 v21, v21, v37
    v_add_f32 v22, v22, v38
    v_add_f32 v23, v23, v39
    v_add_f32 v24, v24, v40
    v_add_f32 v25, v25, v41
    v_add_f32 v26, v26, v42
    v_add_f32 v27, v27, v43
    v_add_f32 v28, v28, v44
    v_add_f32 v29, v29, v45
    v_add_f32 v30, v30, v46
    v_add_f32 v31, v31, v47
    v_add_f32 v16, v16, v24
    v_add_f32 v17, v17, v25
    v_add_f32 v18, v18, v26
    v_add_f32 v19, v19, v27
    v_add_f32 v20, v20, v28
    v_add_f32 v21, v21, v29
    v_add_f32 v22, v22, v30
    v_add_f32 v23, v23, v31
    v_add_f32 v16, v16, v20
    v_add_f32 v17, v17, v21
    v_add_f32 v18, v18, v22
    v_add_f32 v19, v19, v23
    v_add_f32 v16, v16, v18
    v_add_f32 v17, v17, v19
    v_mov_b32 v18, v16
    v_mov_b32 v19, v17
    s_nop 1
    v_permlane32_swap_b32 v16, v18
    v_permlane32_swap_b32 v17, v19
    v_add_f32 v16, v16, v18
    v_add_f32 v17, v17, v19
    v_mul_f32 v16, 0xbb000000, v16
    v_mul_f32 v17, 0x3b000000, v17
    v_fma_f32 v17, -v16, v16, v17
    v_max_f32 v17, 0, v17
    v_add_f32 v17, 0x3727c5ac, v17
    v_rcp_f32 v18, v17
    v_mov_b32 v17, v16
    v_mov_b32 v19, v18
    ds_write_b128 v8, v[16:19] offset:2048
    s_waitcnt lgkmcnt(0)
    buffer_load_dwordx4 v[176:179], v15, s[8:11], s41 offen offset:2048
    buffer_load_dwordx4 v[180:183], v9, s[8:11], s41 offen offset:2048
    buffer_load_dwordx4 v[184:187], v15, s[8:11], s41 offen offset:3072
    buffer_load_dwordx4 v[188:191], v9, s[8:11], s41 offen offset:3072
    buffer_load_dwordx4 v[192:195], v15, s[8:11], s42 offen offset:0
    buffer_load_dwordx4 v[196:199], v9, s[8:11], s42 offen offset:0
    buffer_load_dwordx4 v[200:203], v15, s[8:11], s42 offen offset:1024
    buffer_load_dwordx4 v[204:207], v9, s[8:11], s42 offen offset:1024
    buffer_load_dwordx4 v[208:211], v15, s[8:11], s42 offen offset:2048
    buffer_load_dwordx4 v[212:215], v9, s[8:11], s42 offen offset:2048
    s_barrier
    buffer_load_dwordx4 v[216:219], v15, s[8:11], s42 offen offset:3072
    buffer_load_dwordx4 v[220:223], v9, s[8:11], s42 offen offset:3072
    buffer_load_dwordx4 v[224:227], v15, s[8:11], s43 offen offset:0
    buffer_load_dwordx4 v[228:231], v9, s[8:11], s43 offen offset:0
    buffer_load_dwordx4 v[232:235], v15, s[8:11], s43 offen offset:1024
    buffer_load_dwordx4 v[236:239], v9, s[8:11], s43 offen offset:1024
    s_barrier
    s_cmp_lg_u32 s20, 7
    s_cbranch_scc1 l0_p738
    s_lshl_b32 s30, s21, 8
    s_add_u32 s30, s30, 24743936
    s_lshl_b32 s31, s22, 2
    s_add_u32 s30, s30, s31
    s_mov_b64 exec, 1
    buffer_store_dword v4, v0, s[8:11], s30 offen
    buffer_store_dword v4, v0, s[8:11], s30 offen offset:128 sc0 sc1
    s_mov_b64 exec, -1
l0_p738:
    s_lshl_b32 s30, s20, 1
    s_lshl_b32 s32, 3, s30
    s_lshl_b32 s35, s21, 8
    s_add_u32 s35, s35, 24743936
    s_mov_b64 exec, s[32:33]
    buffer_load_dword v2, v0, s[8:11], s35 offen sc1
    s_mov_b64 exec, -1
    s_waitcnt vmcnt(0)
    s_mov_b64 exec, s[32:33]
    s_mov_b32 s31, 0
l0_qa39:
    v_cmp_ne_u32 vcc, 0, v2
    s_cmp_eq_u64 vcc, s[32:33]
    s_cbranch_scc1 l0_qd41
    buffer_load_dword v2, v0, s[8:11], s35 offen sc1
    s_add_u32 s31, s31, 1
    s_waitcnt vmcnt(0)
    s_cmp_lt_u32 s31, 64
    s_cbranch_scc1 l0_qa39
l0_qb40:
    buffer_load_dword v2, v0, s[8:11], s35 offen sc1
    s_waitcnt vmcnt(0)
    v_cmp_ne_u32 s[36:37], 0, v2
    buffer_load_dword v2, v0, s[8:11], s35 offen offset:128 sc0 sc1
    s_waitcnt vmcnt(0)
    v_cmp_ne_u32 vcc, 0, v2
    s_add_u32 s31, s31, 1
    s_or_b64 vcc, vcc, s[36:37]
    s_cmp_eq_u64 vcc, s[32:33]
    s_cbranch_scc1 l0_qd41
    s_sleep 4
    s_cmp_lt_u32 s31, 1048576
    s_cbranch_scc1 l0_qb40
    s_branch k_end
l0_qd41:
    s_mov_b64 exec, -1
    buffer_load_dwordx4 v[24:27], v5, s[8:11], 0 offen offset:0
    buffer_load_dwordx4 v[28:31], v5, s[8:11], 0 offen offset:1024
    buffer_load_dwordx4 v[32:35], v5, s[8:11], 0 offen offset:2048
    buffer_load_dwordx4 v[36:39], v5, s[8:11], 0 offen offset:3072
    buffer_load_dwordx4 v[40:43], v5, s[8:11], s41 offen offset:0
    buffer_load_dwordx4 v[44:47], v5, s[8:11], s41 offen offset:1024
l0_ge32:
    s_add_u32 s31, s49, 8855552
    buffer_load_dwordx4 v[252:255], v3, s[8:11], s31 offen
    s_lshl_b32 s30, s20, 11
    v_add_u32 v8, s30, v3
    v_add_u32 v7, 0x10000, v8
    s_and_b32 s31, s20, 6
    s_xor_b32 s30, s31, 0
    s_lshl_b32 s30, s30, 11
    s_lshl_b32 s34, s20, 14
    s_add_u32 s30, s30, s34
    v_add_u32 v9, s30, v3
    s_xor_b32 s30, s31, 2
    s_lshl_b32 s30, s30, 11
    s_lshl_b32 s34, s20, 14
    s_add_u32 s30, s30, s34
    v_add_u32 v10, s30, v3
    s_xor_b32 s30, s31, 4
    s_lshl_b32 s30, s30, 11
    s_lshl_b32 s34, s20, 14
    s_add_u32 s30, s30, s34
    v_add_u32 v11, s30, v3
    s_xor_b32 s30, s31, 6
    s_lshl_b32 s30, s30, 11
    s_lshl_b32 s34, s20, 14
    s_add_u32 s30, s30, s34
    v_add_u32 v12, s30, v3
    s_waitcnt vmcnt(6)
    v_mfma_f32_32x32x16_bf16 v[48:63], v[128:131], v[24:27], 0
    v_mfma_f32_32x32x16_bf16 v[64:79], v[132:135], v[24:27], 0
    s_barrier
    s_cmp_lg_u32 s20, 7
    s_cbranch_scc1 l0_p742
    s_lshl_b32 s30, s21, 8
    s_add_u32 s30, s30, 24731648
    s_lshl_b32 s31, s22, 2
    s_add_u32 s30, s30, s31
    s_mov_b64 exec, 1
    buffer_store_dword v4, v0, s[8:11], s30 offen
    buffer_store_dword v4, v0, s[8:11], s30 offen offset:128 sc0 sc1
    s_mov_b64 exec, -1
l0_p742:
    buffer_load_dwordx4 v[80:83], v5, s[8:11], s41 offen offset:2048
    s_waitcnt vmcnt(6)
    v_mfma_f32_32x32x16_bf16 v[48:63], v[136:139], v[28:31], v[48:63]
    v_mfma_f32_32x32x16_bf16 v[64:79], v[140:143], v[28:31], v[64:79]
    buffer_load_dwordx4 v[84:87], v5, s[8:11], s41 offen offset:3072
    s_waitcnt vmcnt(6)
    v_mfma_f32_32x32x16_bf16 v[48:63], v[144:147], v[32:35], v[48:63]
    v_mfma_f32_32x32x16_bf16 v[64:79], v[148:151], v[32:35], v[64:79]
    buffer_load_dwordx4 v[88:91], v5, s[8:11], s42 offen offset:0
    s_waitcnt vmcnt(6)
    v_mfma_f32_32x32x16_bf16 v[48:63], v[152:155], v[36:39], v[48:63]
    v_mfma_f32_32x32x16_bf16 v[64:79], v[156:159], v[36:39], v[64:79]
    buffer_load_dwordx4 v[92:95], v5, s[8:11], s42 offen offset:1024
    s_waitcnt vmcnt(6)
    v_mfma_f32_32x32x16_bf16 v[48:63], v[160:163], v[40:43], v[48:63]
    v_mfma_f32_32x32x16_bf16 v[64:79], v[164:167], v[40:43], v[64:79]
    s_lshl_b32 s35, s21, 8
    s_add_u32 s35, s35, 24731648
    s_mov_b64 exec, s[32:33]
    buffer_load_dword v2, v0, s[8:11], s35 offen sc1
    s_mov_b64 exec, -1
    buffer_load_dwordx4 v[96:99], v5, s[8:11], s42 offen offset:2048
    s_waitcnt vmcnt(7)
    v_mfma_f32_32x32x16_bf16 v[48:63], v[168:171], v[44:47], v[48:63]
    v_mfma_f32_32x32x16_bf16 v[64:79], v[172:175], v[44:47], v[64:79]
    buffer_load_dwordx4 v[100:103], v5, s[8:11], s42 offen offset:3072
    s_waitcnt vmcnt(6)
    v_mfma_f32_32x32x16_bf16 v[48:63], v[176:179], v[80:83], v[48:63]
    v_mfma_f32_32x32x16_bf16 v[64:79], v[180:183], v[80:83], v[64:79]
    buffer_load_dwordx4 v[104:107], v5, s[8:11], s43 offen offset:0
    s_waitcnt vmcnt(6)
    v_mfma_f32_32x32x16_bf16 v[48:63], v[184:187], v[84:87], v[48:63]
    v_mfma_f32_32x32x16_bf16 v[64:79], v[188:191], v[84:87], v[64:79]
    buffer_load_dwordx4 v[108:111], v5, s[8:11], s43 offen offset:1024
    s_waitcnt vmcnt(6)
    v_mfma_f32_32x32x16_bf16 v[48:63], v[192:195], v[88:91], v[48:63]
    v_mfma_f32_32x32x16_bf16 v[64:79], v[196:199], v[88:91], v[64:79]
    s_waitcnt vmcnt(4)
    s_mov_b64 exec, s[32:33]
    s_mov_b32 s31, 0
l0_qa43:
    v_cmp_ne_u32 vcc, 0, v2
    s_cmp_eq_u64 vcc, s[32:33]
    s_cbranch_scc1 l0_qd45
    buffer_load_dword v2, v0, s[8:11], s35 offen sc1
    s_add_u32 s31, s31, 1
    s_waitcnt vmcnt(0)
    s_cmp_lt_u32 s31, 64
    s_cbranch_scc1 l0_qa43
l0_qb44:
    buffer_load_dword v2, v0, s[8:11], s35 offen sc1
    s_waitcnt vmcnt(0)
    v_cmp_ne_u32 s[36:37], 0, v2
    buffer_load_dword v2, v0, s[8:11], s35 offen offset:128 sc0 sc1
    s_waitcnt vmcnt(0)
    v_cmp_ne_u32 vcc, 0, v2
    s_add_u32 s31, s31, 1
    s_or_b64 vcc, vcc, s[36:37]
    s_cmp_eq_u64 vcc, s[32:33]
    s_cbranch_scc1 l0_qd45
    s_sleep 4
    s_cmp_lt_u32 s31, 1048576
    s_cbranch_scc1 l0_qb44
    s_branch k_end
l0_qd45:
    s_mov_b64 exec, -1
    buffer_load_dwordx4 v[112:115], v6, s[8:11], 0 offen offset:0
    v_mfma_f32_32x32x16_bf16 v[48:63], v[200:203], v[92:95], v[48:63]
    v_mfma_f32_32x32x16_bf16 v[64:79], v[204:207], v[92:95], v[64:79]
    buffer_load_dwordx4 v[116:119], v6, s[8:11], 0 offen offset:1024
    s_waitcnt vmcnt(5)
    v_mfma_f32_32x32x16_bf16 v[48:63], v[208:211], v[96:99], v[48:63]
    v_mfma_f32_32x32x16_bf16 v[64:79], v[212:215], v[96:99], v[64:79]
    buffer_load_dwordx4 v[120:123], v6, s[8:11], 0 offen offset:2048
    s_waitcnt vmcnt(5)
    v_mfma_f32_32x32x16_bf16 v[48:63], v[216:219], v[100:103], v[48:63]
    v_mfma_f32_32x32x16_bf16 v[64:79], v[220:223], v[100:103], v[64:79]
    buffer_load_dwordx4 v[124:127], v6, s[8:11], 0 offen offset:3072
    s_waitcnt vmcnt(5)
    v_mfma_f32_32x32x16_bf16 v[48:63], v[224:227], v[104:107], v[48:63]
    v_mfma_f32_32x32x16_bf16 v[64:79], v[228:231], v[104:107], v[64:79]
    buffer_load_dwordx4 v[80:83], v6, s[8:11], s41 offen offset:0
    s_waitcnt vmcnt(5)
    v_mfma_f32_32x32x16_bf16 v[48:63], v[232:235], v[108:111], v[48:63]
    v_mfma_f32_32x32x16_bf16 v[64:79], v[236:239], v[108:111], v[64:79]
    buffer_load_dwordx4 v[84:87], v6, s[8:11], s41 offen offset:1024
    s_waitcnt vmcnt(5)
    v_mfma_f32_32x32x16_bf16 v[16:31], v[128:131], v[112:115], 0
    v_mfma_f32_32x32x16_bf16 v[32:47], v[132:135], v[112:115], 0
    buffer_load_dwordx4 v[88:91], v6, s[8:11], s41 offen offset:2048
    s_waitcnt vmcnt(5)
    v_mfma_f32_32x32x16_bf16 v[16:31], v[136:139], v[116:119], v[16:31]
    v_mfma_f32_32x32x16_bf16 v[32:47], v[140:143], v[116:119], v[32:47]
    buffer_load_dwordx4 v[92:95], v6, s[8:11], s41 offen offset:3072
    s_waitcnt vmcnt(5)
    v_mfma_f32_32x32x16_bf16 v[16:31], v[144:147], v[120:123], v[16:31]
    v_mfma_f32_32x32x16_bf16 v[32:47], v[148:151], v[120:123], v[32:47]
    buffer_load_dwordx4 v[96:99], v6, s[8:11], s42 offen offset:0
    s_nop 2
    s_waitcnt vmcnt(5)
    v_mfma_f32_32x32x16_bf16 v[16:31], v[152:155], v[124:127], v[16:31]
    ds_write_b128 v9, v[48:51] offset:0
    v_mfma_f32_32x32x16_bf16 v[32:47], v[156:159], v[124:127], v[32:47]
    ds_write_b128 v9, v[52:55] offset:1024
    buffer_load_dwordx4 v[100:103], v6, s[8:11], s42 offen offset:1024
    s_waitcnt vmcnt(5)
    v_mfma_f32_32x32x16_bf16 v[16:31], v[160:163], v[80:83], v[16:31]
    ds_write_b128 v11, v[56:59] offset:0
    v_mfma_f32_32x32x16_bf16 v[32:47], v[164:167], v[80:83], v[32:47]
    ds_write_b128 v11, v[60:63] offset:1024
    buffer_load_dwordx4 v[104:107], v6, s[8:11], s42 offen offset:2048
    s_waitcnt vmcnt(5)
    v_mfma_f32_32x32x16_bf16 v[16:31], v[168:171], v[84:87], v[16:31]
    ds_write_b128 v10, v[64:67] offset:0
    v_mfma_f32_32x32x16_bf16 v[32:47], v[172:175], v[84:87], v[32:47]
    ds_write_b128 v10, v[68:71] offset:1024
    buffer_load_dwordx4 v[108:111], v6, s[8:11], s42 offen offset:3072
    s_waitcnt vmcnt(5)
    v_mfma_f32_32x32x16_bf16 v[16:31], v[176:179], v[88:91], v[16:31]
    ds_write_b128 v12, v[72:75] offset:0
    v_mfma_f32_32x32x16_bf16 v[32:47], v[180:183], v[88:91], v[32:47]
    ds_write_b128 v12, v[76:79] offset:1024
    buffer_load_dwordx4 v[112:115], v6, s[8:11], s43 offen offset:0
    s_waitcnt vmcnt(5)
    v_mfma_f32_32x32x16_bf16 v[16:31], v[184:187], v[92:95], v[16:31]
    v_mfma_f32_32x32x16_bf16 v[32:47], v[188:191], v[92:95], v[32:47]
    buffer_load_dwordx4 v[116:119], v6, s[8:11], s43 offen offset:1024
    s_waitcnt vmcnt(5)
    v_mfma_f32_32x32x16_bf16 v[16:31], v[192:195], v[96:99], v[16:31]
    v_mfma_f32_32x32x16_bf16 v[32:47], v[196:199], v[96:99], v[32:47]
    s_waitcnt vmcnt(4)
    v_mfma_f32_32x32x16_bf16 v[16:31], v[200:203], v[100:103], v[16:31]
    v_mfma_f32_32x32x16_bf16 v[32:47], v[204:207], v[100:103], v[32:47]
    s_waitcnt vmcnt(3)
    v_mfma_f32_32x32x16_bf16 v[16:31], v[208:211], v[104:107], v[16:31]
    v_mfma_f32_32x32x16_bf16 v[32:47], v[212:215], v[104:107], v[32:47]
    s_waitcnt vmcnt(2)
    v_mfma_f32_32x32x16_bf16 v[16:31], v[216:219], v[108:111], v[16:31]
    v_mfma_f32_32x32x16_bf16 v[32:47], v[220:223], v[108:111], v[32:47]
    s_waitcnt vmcnt(1)
    v_mfma_f32_32x32x16_bf16 v[16:31], v[224:227], v[112:115], v[16:31]
    v_mfma_f32_32x32x16_bf16 v[32:47], v[228:231], v[112:115], v[32:47]
    s_waitcnt vmcnt(0)
    v_mfma_f32_32x32x16_bf16 v[16:31], v[232:235], v[116:119], v[16:31]
    v_mfma_f32_32x32x16_bf16 v[32:47], v[236:239], v[116:119], v[32:47]
    v_lshlrev_b32 v80, 16, v252
    v_and_b32 v81, 0xffff0000, v252
    v_lshlrev_b32 v82, 16, v253
    v_and_b32 v83, 0xffff0000, v253
    v_lshlrev_b32 v84, 16, v254
    v_and_b32 v85, 0xffff0000, v254
    v_lshlrev_b32 v86, 16, v255
    v_and_b32 v87, 0xffff0000, v255
    s_nop 2
    ds_write_b128 v9, v[16:19] offset:2048
    ds_write_b128 v9, v[20:23] offset:3072
    ds_write_b128 v11, v[24:27] offset:2048
    ds_write_b128 v11, v[28:31] offset:3072
    ds_write_b128 v10, v[32:35] offset:2048
    ds_write_b128 v10, v[36:39] offset:3072
    ds_write_b128 v12, v[40:43] offset:2048
    ds_write_b128 v12, v[44:47] offset:3072
    s_lshl_b32 s30, s20, 12
    s_add_u32 s30, s30, 524288
    s_cmp_lg_u32 s3, 0
    s_cbranch_scc1 l0_kw46
    buffer_load_dwordx4 v[192:195], v3, s[8:11], s30 offen offset:0
    buffer_load_dwordx4 v[196:199], v3, s[8:11], s30 offen offset:1024
    buffer_load_dwordx4 v[200:203], v3, s[8:11], s30 offen offset:2048
    buffer_load_dwordx4 v[204:207], v3, s[8:11], s30 offen offset:3072
l0_kw46:
    s_waitcnt lgkmcnt(0)
    s_barrier
    ds_read_b128 v[16:19], v8 offset:0
    ds_read_b128 v[20:23], v8 offset:1024
    ds_read_b128 v[24:27], v8 offset:16384
    ds_read_b128 v[28:31], v8 offset:17408
    ds_read_b128 v[32:35], v8 offset:32768
    ds_read_b128 v[36:39], v8 offset:33792
    ds_read_b128 v[40:43], v8 offset:49152
    ds_read_b128 v[44:47], v8 offset:50176
    ds_read_b128 v[48:51], v7 offset:0
    ds_read_b128 v[52:55], v7 offset:1024
    ds_read_b128 v[56:59], v7 offset:16384
    ds_read_b128 v[60:63], v7 offset:17408
    ds_read_b128 v[64:67], v7 offset:32768
    ds_read_b128 v[68:71], v7 offset:33792
    s_waitcnt lgkmcnt(10)
    v_add_f32 v16, v16, v80
    v_add_f32 v17, v17, v81
    v_add_f32 v18, v18, v82
    v_add_f32 v19, v19, v83
    v_add_f32 v20, v20, v84
    v_add_f32 v21, v21, v85
    v_add_f32 v22, v22, v86
    v_add_f32 v23, v23, v87
    ds_read_b128 v[72:75], v7 offset:49152
    ds_read_b128 v[76:79], v7 offset:50176
    s_waitcnt lgkmcnt(0)
    v_add_f32 v16, v16, v48
    v_add_f32 v17, v17, v49
    v_add_f32 v18, v18, v50
    v_add_f32 v19, v19, v51
    v_add_f32 v20, v20, v52
    v_add_f32 v21, v21, v53
    v_add_f32 v22, v22, v54
    v_add_f32 v23, v23, v55
    v_add_f32 v24, v24, v56
    v_add_f32 v25, v25, v57
    v_add_f32 v26, v26, v58
    v_add_f32 v27, v27, v59
    v_add_f32 v28, v28, v60
    v_add_f32 v29, v29, v61
    v_add_f32 v30, v30, v62
    v_add_f32 v31, v31, v63
    v_add_f32 v32, v32, v64
    v_add_f32 v33, v33, v65
    v_add_f32 v34, v34, v66
    v_add_f32 v35, v35, v67
    v_add_f32 v36, v36, v68
    v_add_f32 v37, v37, v69
    v_add_f32 v38, v38, v70
    v_add_f32 v39, v39, v71
    v_add_f32 v40, v40, v72
    v_add_f32 v41, v41, v73
    v_add_f32 v42, v42, v74
    v_add_f32 v43, v43, v75
    v_add_f32 v44, v44, v76
    v_add_f32 v45, v45, v77
    v_add_f32 v46, v46, v78
    v_add_f32 v47, v47, v79
    v_add_f32 v16, v16, v32
    v_add_f32 v17, v17, v33
    v_add_f32 v18, v18, v34
    v_add_f32 v19, v19, v35
    v_add_f32 v20, v20, v36
    v_add_f32 v21, v21, v37
    v_add_f32 v22, v22, v38
    v_add_f32 v23, v23, v39
    v_add_f32 v24, v24, v40
    v_add_f32 v25, v25, v41
    v_add_f32 v26, v26, v42
    v_add_f32 v27, v27, v43
    v_add_f32 v28, v28, v44
    v_add_f32 v29, v29, v45
    v_add_f32 v30, v30, v46
    v_add_f32 v31, v31, v47
    v_add_f32 v16, v16, v24
    v_add_f32 v17, v17, v25
    v_add_f32 v18, v18, v26
    v_add_f32 v19, v19, v27
    v_add_f32 v20, v20, v28
    v_add_f32 v21, v21, v29
    v_add_f32 v22, v22, v30
    v_add_f32 v23, v23, v31
    v_cvt_pk_bf16_f32 v24, v16, v17
    v_cvt_pk_bf16_f32 v25, v18, v19
    v_cvt_pk_bf16_f32 v26, v20, v21
    v_cvt_pk_bf16_f32 v27, v22, v23
    s_add_u32 s31, s49, 22487040
    buffer_store_dwordx4 v[24:27], v3, s[8:11], s31 offen sc0 sc1
    v_mov_b32 v84, 0x3f803f80
    v_dot2_f32_bf16 v81, v24, v24, 0
    v_dot2_f32_bf16 v80, v24, v84, 0
    v_dot2_f32_bf16 v81, v25, v25, v81
    v_dot2_f32_bf16 v80, v25, v84, v80
    v_dot2_f32_bf16 v81, v26, v26, v81
    v_dot2_f32_bf16 v80, v26, v84, v80
    v_dot2_f32_bf16 v81, v27, v27, v81
    v_dot2_f32_bf16 v80, v27, v84, v80
    s_nop 2
    v_mov_b32 v82, v80
    v_mov_b32 v83, v81
    s_nop 1
    v_permlane32_swap_b32 v80, v82
    v_permlane32_swap_b32 v81, v83
    v_add_f32 v80, v80, v82
    v_add_f32 v81, v81, v83
    s_lshr_b32 s31, s49, 2
    s_add_u32 s31, s31, 25845760
    v_lshlrev_b32 v4, 3, v1
    s_mov_b32 exec_hi, 0
    buffer_store_dwordx2 v[80:81], v4, s[8:11], s31 offen sc0 sc1
    s_mov_b64 exec, -1
    s_lshl_b32 s30, s18, 15
    s_lshl_b32 s48, s20, 12
    s_add_u32 s30, s30, s48
    s_add_u32 s30, s30, 22487040
    v_add_u32 v5, s30, v3
    s_lshl_b32 s30, s26, 14
    s_add_u32 s30, s30, 36864
    v_add_u32 v6, s30, v3
    v_add_u32 v14, s48, v3
    s_add_u32 s48, s48, 36864
    s_lshl_b32 s30, s20, 11
    s_add_u32 s30, s30, 81920
    v_add_u32 v8, s30, v3
    v_xor_b32 v7, 0x2000, v8
    v_lshrrev_b32 v2, 5, v1
    v_lshlrev_b32 v4, 4, v2
    s_and_b32 s31, s19, 0x7fff
    s_lshr_b32 s31, s31, 4
    s_add_u32 s31, s31, 6586368
    buffer_load_dwordx4 v[96:99], v4, s[8:11], s31 offen
    buffer_load_dwordx4 v[100:103], v4, s[8:11], s31 offen offset:32
    s_lshl_b32 s31, s25, 5
    s_add_u32 s31, s31, 6588416
    buffer_load_dwordx4 v[104:107], v4, s[8:11], s31 offen
    v_and_b32 v9, 31, v1
    v_lshlrev_b32 v9, 3, v9
    v_add_u32 v11, 69632, v9
    s_lshl_b32 s30, s20, 8
    v_add_u32 v10, s30, v11
    v_lshl_add_u32 v9, v2, 9, v9
    s_lshl_b32 s30, s18, 13
    s_lshl_b32 s31, s20, 10
    s_add_u32 s30, s30, s31
    s_add_u32 s30, s30, 25845760
    v_add_u32 v9, s30, v9
    v_add_u32 v12, s48, v3
    s_lshl_b32 s30, s25, 10
    s_add_u32 s30, s30, 0
    v_add_u32 v13, s30, v3
    v_bfe_u32 v15, v1, 4, 1
    v_lshlrev_b32 v15, 9, v15
    v_bfe_u32 v4, v1, 2, 1
    v_lshl_add_u32 v15, v4, 8, v15
    v_and_b32 v4, 3, v1
    v_lshl_add_u32 v15, v4, 1, v15
    v_bfe_u32 v4, v1, 3, 1
    v_lshl_add_u32 v15, v4, 3, v15
    v_lshl_add_u32 v15, v2, 6, v15
    s_lshl_b32 s30, s26, 8
    v_xor_b32 v64, s30, v3
    s_and_b32 s30, s19, 0x7fff
    s_lshl_b32 s30, s30, 4
    s_add_u32 s30, s30, 0
    v_add_u32 v64, s30, v64
    s_lshl_b32 s30, s20, 1
    s_add_u32 s30, s30, s23
    s_lshl_b32 s32, 1, s30
    s_mov_b32 s33, 0
    v_lshlrev_b32 v0, 2, v1
    s_lshl_b32 s30, s21, 8
    s_add_u32 s30, s30, 24748032
    s_lshl_b32 s34, s22, 2
    s_add_u32 s34, s34, s30
    v_mov_b32 v4, 1
    s_waitcnt vmcnt(3) lgkmcnt(0)
    s_cmp_lg_u32 s20, 0
    s_barrier
    s_cbranch_scc1 l0_sig50
    s_mov_b64 exec, 1
    buffer_store_dword v4, v0, s[8:11], s34 offen
l0_sig50:
    s_mov_b32 s31, 0
    s_mov_b64 exec, s[32:33]
l0_pa47:
    buffer_load_dword v2, v0, s[8:11], s30 offen sc1
    s_add_u32 s31, s31, 1
    s_waitcnt vmcnt(0)
    v_cmp_ne_u32 vcc, 0, v2
    s_cmp_eq_u64 vcc, s[32:33]
    s_cbranch_scc1 l0_pd49
    s_cmp_lt_u32 s31, 64
    s_cbranch_scc1 l0_pa47
    s_mov_b64 exec, 1
    buffer_store_dword v4, v0, s[8:11], s34 offen offset:128 sc0 sc1
    s_mov_b64 exec, s[32:33]
l0_pb48:
    buffer_load_dword v2, v0, s[8:11], s30 offen sc1
    s_waitcnt vmcnt(0)
    v_cmp_ne_u32 s[36:37], 0, v2
    buffer_load_dword v2, v0, s[8:11], s30 offen offset:128 sc0 sc1
    s_waitcnt vmcnt(0)
    v_cmp_ne_u32 vcc, 0, v2
    s_add_u32 s31, s31, 1
    s_or_b64 vcc, vcc, s[36:37]
    s_cmp_eq_u64 vcc, s[32:33]
    s_cbranch_scc1 l0_pd49
    s_sleep 4
    s_cmp_lt_u32 s31, 1048576
    s_cbranch_scc1 l0_pb48
    s_branch k_end
l0_pd49:
    s_mov_b64 exec, -1
    s_mov_b32 m0, s48
    s_nop 0
    buffer_load_dwordx4 v5, s[8:11], 0 offen offset:0 lds
    buffer_load_dwordx4 v5, s[8:11], 0 offen offset:1024 lds
    buffer_load_dwordx4 v5, s[8:11], 0 offen offset:2048 lds
    buffer_load_dwordx4 v5, s[8:11], 0 offen offset:3072 lds
    s_add_u32 s35, s3, s26
    buffer_load_dwordx2 v[108:109], v9, s[8:11], 0 offen offset:0
    buffer_load_dwordx2 v[110:111], v9, s[8:11], 0 offen offset:256
    s_cmp_eq_u32 s3, 0
    s_cbranch_scc1 l0_w153
    s_cmp_lg_u32 s20, 0
    s_cbranch_scc1 l0_fb55
    s_mov_b64 exec, 1
    buffer_store_dword v4, v0, s[8:11], s34 offen offset:128 sc0 sc1
    s_mov_b64 exec, -1
l0_fb55:
    buffer_load_dwordx4 v[128:131], v64, s[8:11], 0 offen offset:0
    buffer_load_dwordx4 v[132:135], v64, s[8:11], 0 offen offset:1024
    buffer_load_dwordx4 v[136:139], v64, s[8:11], s41 offen offset:0
    buffer_load_dwordx4 v[140:143], v64, s[8:11], s41 offen offset:1024
    buffer_load_dwordx4 v[144:147], v64, s[8:11], s42 offen offset:0
    buffer_load_dwordx4 v[148:151], v64, s[8:11], s42 offen offset:1024
    buffer_load_dwordx4 v[152:155], v64, s[8:11], s43 offen offset:0
    buffer_load_dwordx4 v[156:159], v64, s[8:11], s43 offen offset:1024
    buffer_load_dwordx4 v[160:163], v64, s[8:11], 0 offen offset:2048
    buffer_load_dwordx4 v[164:167], v64, s[8:11], 0 offen offset:3072
    buffer_load_dwordx4 v[168:171], v64, s[8:11], s41 offen offset:2048
    buffer_load_dwordx4 v[172:175], v64, s[8:11], s41 offen offset:3072
    buffer_load_dwordx4 v[176:179], v64, s[8:11], s42 offen offset:2048
    buffer_load_dwordx4 v[180:183], v64, s[8:11], s42 offen offset:3072
    buffer_load_dwordx4 v[184:187], v64, s[8:11], s43 offen offset:2048
    buffer_load_dwordx4 v[188:191], v64, s[8:11], s43 offen offset:3072
    s_waitcnt vmcnt(16)
    s_branch l0_w254
l0_w153:
    s_waitcnt vmcnt(0)
l0_w254:
    s_cmp_lg_u32 s3, 0
    s_cbranch_scc1 l0_k456
    ds_read_b128 v[224:227], v12 offset:0
    ds_read_b128 v[228:231], v12 offset:1024
    ds_read_b128 v[232:235], v12 offset:2048
    ds_read_b128 v[236:239], v12 offset:3072
    s_waitcnt lgkmcnt(3)
    v_mfma_f32_32x32x16_bf16 v[208:223], v[192:195], v[224:227], 0
    s_waitcnt lgkmcnt(2)
    v_mfma_f32_32x32x16_bf16 v[208:223], v[196:199], v[228:231], v[208:223]
    s_waitcnt lgkmcnt(1)
    v_mfma_f32_32x32x16_bf16 v[208:223], v[200:203], v[232:235], v[208:223]
    s_waitcnt lgkmcnt(0)
    v_mfma_f32_32x32x16_bf16 v[208:223], v[204:207], v[236:239], v[208:223]
l0_k456:
    v_add_f32 v108, v108, v110
    v_add_f32 v109, v109, v111
    v_mov_b32 v110, v108
    v_mov_b32 v111, v109
    s_nop 1
    v_permlane32_swap_b32 v108, v110
    v_add_f32 v108, v108, v110
    v_permlane32_swap_b32 v109, v111
    v_add_f32 v109, v109, v111
    ds_write_b64 v10, v[108:109]
    v_mov_b32 v110, 0
    v_mov_b32 v9, 77824
    ds_write_b32 v9, v110
    s_cmp_lg_u32 s3, 0
    s_cbranch_scc1 l0_k557
    ds_write_b128 v14, v[208:211] offset:0
    ds_write_b128 v14, v[212:215] offset:1024
    ds_write_b128 v14, v[216:219] offset:2048
    ds_write_b128 v14, v[220:223] offset:3072
l0_k557:
    s_waitcnt lgkmcnt(0)
    s_barrier
    ds_read_b64 v[108:109], v11 offset:0
    ds_read_b64 v[110:111], v11 offset:256
    ds_read_b64 v[112:113], v11 offset:512
    ds_read_b64 v[114:115], v11 offset:768
    ds_read_b64 v[116:117], v11 offset:1024
    ds_read_b64 v[118:119], v11 offset:1280
    ds_read_b64 v[120:121], v11 offset:1536
    ds_read_b64 v[122:123], v11 offset:1792
    s_cmp_lg_u32 s35, 0
    s_cbranch_scc1 l0_e659
    s_setprio 3
    s_waitcnt lgkmcnt(4)
    ds_read_b128 v[224:227], v13 offset:0
    ds_read_b128 v[228:231], v13 offset:4096
    ds_read_b128 v[232:235], v13 offset:8192
    ds_read_b128 v[236:239], v13 offset:12288
    ds_read_b128 v[240:243], v13 offset:16384
    ds_read_b128 v[244:247], v13 offset:20480
    ds_read_b128 v[248:251], v13 offset:24576
    ds_read_b128 v[252:255], v13 offset:28672
    s_waitcnt lgkmcnt(8)
    v_mov_b32 v208, v108
    v_mov_b32 v209, v109
    v_mov_b32 v210, v110
    v_mov_b32 v211, v111
    v_mov_b32 v212, v112
    v_mov_b32 v213, v113
    v_mov_b32 v214, v114
    v_mov_b32 v215, v115
    v_mov_b32 v216, v116
    v_mov_b32 v217, v117
    v_mov_b32 v218, v118
    v_mov_b32 v219, v119
    v_mov_b32 v220, v120
    v_mov_b32 v221, v121
    v_mov_b32 v222, v122
    v_mov_b32 v223, v123
    v_add_f32 v208, v208, v216
    v_add_f32 v209, v209, v217
    v_add_f32 v210, v210, v218
    v_add_f32 v211, v211, v219
    v_add_f32 v212, v212, v220
    v_add_f32 v213, v213, v221
    v_add_f32 v214, v214, v222
    v_add_f32 v215, v215, v223
    v_add_f32 v208, v208, v212
    v_add_f32 v209, v209, v213
    v_add_f32 v210, v210, v214
    v_add_f32 v211, v211, v215
    v_add_f32 v208, v208, v210
    v_add_f32 v209, v209, v211
    v_mul_f32 v208, 0x3b000000, v208
    v_mul_f32 v209, 0x3b000000, v209
    v_fma_f32 v209, -v208, v208, v209
    v_max_f32 v209, 0, v209
    v_add_f32 v209, 0x3727c5ac, v209
    v_rsq_f32 v209, v209
    s_lshl_b32 s30, s18, 11
    s_add_u32 s30, s30, 24584192
    s_waitcnt lgkmcnt(0)
    v_add_f32 v224, v224, v240
    v_add_f32 v225, v225, v241
    v_add_f32 v226, v226, v242
    v_add_f32 v227, v227, v243
    v_add_f32 v228, v228, v244
    v_add_f32 v229, v229, v245
    v_add_f32 v230, v230, v246
    v_add_f32 v231, v231, v247
    v_add_f32 v232, v232, v248
    v_add_f32 v233, v233, v249
    v_add_f32 v234, v234, v250
    v_add_f32 v235, v235, v251
    v_add_f32 v236, v236, v252
    v_add_f32 v237, v237, v253
    v_add_f32 v238, v238, v254
    v_add_f32 v239, v239, v255
    v_add_f32 v224, v224, v232
    v_add_f32 v225, v225, v233
    v_add_f32 v226, v226, v234
    v_add_f32 v227, v227, v235
    v_add_f32 v228, v228, v236
    v_add_f32 v229, v229, v237
    v_add_f32 v230, v230, v238
    v_add_f32 v231, v231, v239
    v_add_f32 v224, v224, v228
    v_add_f32 v225, v225, v229
    v_add_f32 v226, v226, v230
    v_add_f32 v227, v227, v231
    v_fma_f32 v224, -v208, v104, v224
    v_fma_f32 v225, -v208, v105, v225
    v_fma_f32 v226, -v208, v106, v226
    v_fma_f32 v227, -v208, v107, v227
    v_mul_f32 v224, v209, v224
    v_mul_f32 v225, v209, v225
    v_mul_f32 v226, v209, v226
    v_mul_f32 v227, v209, v227
    v_cvt_pk_bf16_f32 v232, v224, v225
    v_cvt_pk_bf16_f32 v233, v226, v227
    s_cmp_ge_u32 s20, 2
    s_cbranch_scc1 l0_v658
    s_lshl_b32 s31, s20, 3
    s_add_u32 s31, s31, s30
    buffer_store_dwordx2 v[232:233], v3, s[8:11], s31 offen sc0 sc1
    s_branch l0_f660
l0_v658:
    s_lshl_b32 s31, s29, 10
    s_add_u32 s31, s31, 73728
    v_add_u32 v15, s31, v15
    ds_write_b16 v15, v232 offset:0
    ds_write_b16_d16_hi v15, v232 offset:16
    ds_write_b16 v15, v233 offset:32
    ds_write_b16_d16_hi v15, v233 offset:48
    v_lshrrev_b32 v2, 3, v1
    v_lshlrev_b32 v2, 8, v2
    v_and_b32 v224, 7, v1
    v_lshl_add_u32 v2, v224, 4, v2
    v_add_u32 v15, s31, v2
    s_mov_b32 exec_hi, 0
    ds_read_b128 v[236:239], v15
    s_lshl_b32 s31, s29, 7
    s_add_u32 s31, s31, s30
    s_waitcnt lgkmcnt(0)
    buffer_store_dwordx4 v[236:239], v2, s[8:11], s31 offen offset:1024 sc0 sc1
    s_mov_b64 exec, -1
l0_f660:
    s_lshl_b32 s30, s18, 7
    s_add_u32 s30, s30, 26624000
    s_mov_b64 exec, 1
    s_waitcnt vmcnt(0)
    ds_add_rtn_u32 v2, v9, v4
    s_waitcnt lgkmcnt(0)
    v_cmp_eq_u32 vcc, 3, v2
    s_cbranch_vccz l0_g661
    buffer_store_dword v4, v0, s[8:11], s30 offen sc0 sc1
l0_g661:
    s_mov_b64 exec, -1
    s_setprio 0
l0_e659:
    s_waitcnt lgkmcnt(0)
    s_cmp_lg_u32 s3, 0
    s_cbranch_scc1 l0_w362
    s_cmp_lg_u32 s20, 0
    s_cbranch_scc1 l0_fb63
    s_mov_b64 exec, 1
    buffer_store_dword v4, v0, s[8:11], s34 offen offset:128 sc0 sc1
    s_mov_b64 exec, -1
l0_fb63:
    buffer_load_dwordx4 v[128:131], v64, s[8:11], 0 offen offset:0
    buffer_load_dwordx4 v[132:135], v64, s[8:11], 0 offen offset:1024
    buffer_load_dwordx4 v[136:139], v64, s[8:11], s41 offen offset:0
    buffer_load_dwordx4 v[140:143], v64, s[8:11], s41 offen offset:1024
    buffer_load_dwordx4 v[144:147], v64, s[8:11], s42 offen offset:0
    buffer_load_dwordx4 v[148:151], v64, s[8:11], s42 offen offset:1024
    buffer_load_dwordx4 v[152:155], v64, s[8:11], s43 offen offset:0
    buffer_load_dwordx4 v[156:159], v64, s[8:11], s43 offen offset:1024
    buffer_load_dwordx4 v[160:163], v64, s[8:11], 0 offen offset:2048
    buffer_load_dwordx4 v[164:167], v64, s[8:11], 0 offen offset:3072
    buffer_load_dwordx4 v[168:171], v64, s[8:11], s41 offen offset:2048
    buffer_load_dwordx4 v[172:175], v64, s[8:11], s41 offen offset:3072
    buffer_load_dwordx4 v[176:179], v64, s[8:11], s42 offen offset:2048
    buffer_load_dwordx4 v[180:183], v64, s[8:11], s42 offen offset:3072
    buffer_load_dwordx4 v[184:187], v64, s[8:11], s43 offen offset:2048
    buffer_load_dwordx4 v[188:191], v64, s[8:11], s43 offen offset:3072
l0_w362:
    ds_read_b128 v[32:35], v6 offset:0
    ds_read_b128 v[36:39], v6 offset:1024
    ds_read_b128 v[40:43], v6 offset:4096
    ds_read_b128 v[44:47], v6 offset:5120
    ds_read_b128 v[48:51], v6 offset:8192
    ds_read_b128 v[52:55], v6 offset:9216
    ds_read_b128 v[56:59], v6 offset:12288
    ds_read_b128 v[60:63], v6 offset:13312
    v_add_f32 v108, v108, v116
    v_add_f32 v109, v109, v117
    v_add_f32 v110, v110, v118
    v_add_f32 v111, v111, v119
    v_add_f32 v112, v112, v120
    v_add_f32 v113, v113, v121
    v_add_f32 v114, v114, v122
    v_add_f32 v115, v115, v123
    v_add_f32 v108, v108, v112
    v_add_f32 v109, v109, v113
    v_add_f32 v110, v110, v114
    v_add_f32 v111, v111, v115
    v_add_f32 v108, v108, v110
    v_add_f32 v109, v109, v111
    v_mul_f32 v108, 0x3b000000, v108
    v_mul_f32 v109, 0x3b000000, v109
    v_fma_f32 v109, -v108, v108, v109
    v_max_f32 v109, 0, v109
    v_add_f32 v109, 0x3727c5ac, v109
    v_rsq_f32 v109, v109
    s_waitcnt lgkmcnt(7) vmcnt(15)
    v_mfma_f32_32x32x16_bf16 v[16:31], v[128:131], v[32:35], 0
    ds_read_b128 v[32:35], v6 offset:2048
    s_waitcnt lgkmcnt(7) vmcnt(14)
    v_mfma_f32_32x32x16_bf16 v[16:31], v[132:135], v[36:39], v[16:31]
    ds_read_b128 v[36:39], v6 offset:3072
    s_waitcnt lgkmcnt(7) vmcnt(13)
    v_mfma_f32_32x32x16_bf16 v[16:31], v[136:139], v[40:43], v[16:31]
    ds_read_b128 v[40:43], v6 offset:6144
    s_waitcnt lgkmcnt(7) vmcnt(12)
    v_mfma_f32_32x32x16_bf16 v[16:31], v[140:143], v[44:47], v[16:31]
    ds_read_b128 v[44:47], v6 offset:7168
    s_waitcnt lgkmcnt(7) vmcnt(11)
    v_mfma_f32_32x32x16_bf16 v[16:31], v[144:147], v[48:51], v[16:31]
    ds_read_b128 v[48:51], v6 offset:10240
    s_waitcnt lgkmcnt(7) vmcnt(10)
    v_mfma_f32_32x32x16_bf16 v[16:31], v[148:151], v[52:55], v[16:31]
    ds_read_b128 v[52:55], v6 offset:11264
    s_waitcnt lgkmcnt(7) vmcnt(9)
    v_mfma_f32_32x32x16_bf16 v[16:31], v[152:155], v[56:59], v[16:31]
    ds_read_b128 v[56:59], v6 offset:14336
    s_waitcnt lgkmcnt(7) vmcnt(8)
    v_mfma_f32_32x32x16_bf16 v[16:31], v[156:159], v[60:63], v[16:31]
    ds_read_b128 v[60:63], v6 offset:15360
    s_waitcnt lgkmcnt(7) vmcnt(7)
    v_mfma_f32_32x32x16_bf16 v[16:31], v[160:163], v[32:35], v[16:31]
    s_waitcnt lgkmcnt(6) vmcnt(6)
    v_mfma_f32_32x32x16_bf16 v[16:31], v[164:167], v[36:39], v[16:31]
    s_waitcnt lgkmcnt(5) vmcnt(5)
    v_mfma_f32_32x32x16_bf16 v[16:31], v[168:171], v[40:43], v[16:31]
    s_waitcnt lgkmcnt(4) vmcnt(4)
    v_mfma_f32_32x32x16_bf16 v[16:31], v[172:175], v[44:47], v[16:31]
    s_waitcnt lgkmcnt(3) vmcnt(3)
    v_mfma_f32_32x32x16_bf16 v[16:31], v[176:179], v[48:51], v[16:31]
    s_waitcnt lgkmcnt(2) vmcnt(2)
    v_mfma_f32_32x32x16_bf16 v[16:31], v[180:183], v[52:55], v[16:31]
    s_waitcnt lgkmcnt(1) vmcnt(1)
    v_mfma_f32_32x32x16_bf16 v[16:31], v[184:187], v[56:59], v[16:31]
    s_waitcnt lgkmcnt(0) vmcnt(0)
    v_mfma_f32_32x32x16_bf16 v[16:31], v[188:191], v[60:63], v[16:31]
    s_mul_i32 s37, s20, 2128
    s_lshl_b32 s38, s20, 11
    s_add_u32 s38, s38, 24584192
    s_lshr_b32 s30, s21, 1
    s_lshl_b32 s39, s30, 14
    v_add_u32 v0, s30, v1
    v_and_b32 v0, 7, v0
    v_lshlrev_b32 v0, 10, v0
    s_lshl_b32 s33, s20, 7
    s_add_u32 s33, s33, 26624000
    s_mov_b64 exec, 0xff
    buffer_load_dword v2, v0, s[8:11], s33 offen sc1
    s_mov_b64 exec, -1
    v_mul_f32 v110, 0x3eb8aa3b, v109
    ds_write_b128 v7, v[24:27] offset:0
    ds_write_b128 v7, v[28:31] offset:1024
    v_fma_f32 v16, -v108, v96, v16
    v_fma_f32 v17, -v108, v97, v17
    v_fma_f32 v18, -v108, v98, v18
    v_fma_f32 v19, -v108, v99, v19
    v_fma_f32 v20, -v108, v100, v20
    v_fma_f32 v21, -v108, v101, v21
    v_fma_f32 v22, -v108, v102, v22
    v_fma_f32 v23, -v108, v103, v23
    s_waitcnt lgkmcnt(0)
    s_barrier
    ds_read_b128 v[24:27], v8 offset:0
    ds_read_b128 v[28:31], v8 offset:1024
    s_mov_b32 s31, 0
    s_mov_b64 exec, 0xff
l0_kp64:
    s_add_u32 s31, s31, 1
    s_waitcnt vmcnt(0)
    v_cmp_ne_u32 vcc, 0, v2
    s_and_b32 s30, vcc_lo, 1
    s_cmp_eq_u32 s30, 1
    s_cbranch_scc1 l0_kpd65
    s_sleep 2
    buffer_load_dword v2, v0, s[8:11], s33 offen sc1
    s_cmp_lt_u32 s31, 2097152
    s_cbranch_scc1 l0_kp64
    s_branch k_end
l0_kpd65:
    s_mov_b64 exec, -1
    s_add_u32 s30, s39, 0
    s_and_b32 s30, s30, 0x1ffff
    s_add_u32 m0, s37, 0
    s_add_u32 s30, s30, s38
    buffer_load_dwordx4 v3, s[8:11], s30 offen lds
    buffer_load_dwordx4 v3, s[8:11], s30 offen offset:1024 lds
    s_mov_b64 exec, 0xff
    buffer_load_dword v2, v0, s[8:11], s33 offen sc1
    s_mov_b64 exec, -1
    s_waitcnt lgkmcnt(0)
    v_add_f32 v16, v16, v24
    v_add_f32 v17, v17, v25
    v_add_f32 v18, v18, v26
    v_add_f32 v19, v19, v27
    v_add_f32 v20, v20, v28
    v_add_f32 v21, v21, v29
    v_add_f32 v22, v22, v30
    v_add_f32 v23, v23, v31
    v_mul_f32 v16, v110, v16
    v_mul_f32 v17, v110, v17
    v_mul_f32 v18, v110, v18
    v_mul_f32 v19, v110, v19
    v_mul_f32 v20, v110, v20
    v_mul_f32 v21, v110, v21
    v_mul_f32 v22, v110, v22
    v_mul_f32 v23, v110, v23
    v_cvt_pk_bf16_f32 v124, v16, v17
    v_cvt_pk_bf16_f32 v125, v18, v19
    v_cvt_pk_bf16_f32 v126, v20, v21
    v_cvt_pk_bf16_f32 v127, v22, v23
    s_barrier
    s_add_u32 s36, s19, 28729344
    s_load_dwordx2 s[12:13], s[0:1], 72
    v_mov_b32 v104, v3
    v_and_b32 v106, 15, v1
    v_lshrrev_b32 v107, 5, v1
    v_lshl_add_u32 v106, v107, 4, v106
    v_lshlrev_b32 v106, 4, v106
    v_add_u32 v105, 1024, v106
    v_add_u32 v111, 1536, v106
    v_and_b32 v107, 31, v1
    v_cmp_eq_u32 vcc, 16, v107
    v_mov_b32 v108, 2048
    s_nop 0
    v_cndmask_b32 v105, v105, v108, vcc
    v_cndmask_b32 v111, v111, v108, vcc
    v_cmp_lt_u32 vcc, 16, v107
    v_mov_b32 v108, 2064
    s_nop 0
    v_cndmask_b32 v105, v105, v108, vcc
    v_cndmask_b32 v111, v111, v108, vcc
    v_subrev_u32 v107, 20, v107
    v_cmp_gt_u32 vcc, 8, v107
    v_mov_b32 v108, 2112
    s_nop 0
    v_cndmask_b32 v105, v105, v108, vcc
    v_cndmask_b32 v111, v111, v108, vcc
    v_mov_b32 v56, 0
    v_mov_b32 v57, 0
    v_mov_b32 v58, 0
    v_mov_b32 v59, 0
    v_mov_b32 v60, 0
    v_mov_b32 v61, 0
    v_mov_b32 v62, 0
    v_mov_b32 v63, 0
    v_mov_b32 v64, 0
    v_mov_b32 v65, 0
    v_mov_b32 v66, 0
    v_mov_b32 v67, 0
    v_mov_b32 v68, 0
    v_mov_b32 v69, 0
    v_mov_b32 v70, 0
    v_mov_b32 v71, 0
    v_mov_b32 v76, 0
    v_mov_b32 v77, 0
    v_mov_b32 v78, 0
    v_mov_b32 v79, 0
    v_mov_b32 v100, 0
    v_mov_b32 v72, 0x3f803f80
    v_mov_b32 v101, 0
    v_mov_b32 v73, 0x3f803f80
    v_mov_b32 v102, 0
    v_mov_b32 v74, 0x3f803f80
    v_mov_b32 v103, 0
    v_mov_b32 v75, 0x3f803f80
    v_mul_u32_u24 v106, 2128, v1
    s_cmp_lg_u32 s20, 7
    s_cbranch_scc1 l1_cw66
    ds_write_b128 v106, v[72:75] offset:2048
    ds_write_b128 v106, v[76:79] offset:2064
    ds_write_b128 v106, v[76:79] offset:2112
l1_cw66:
    s_waitcnt vmcnt(0) lgkmcnt(0)
    v_cmp_ne_u32 vcc, 0, v2
    s_barrier
    s_and_b32 s32, vcc_lo, 0xff
    s_cmp_lg_u32 s32, 0xff
    s_cbranch_scc1 l1_nd67
    s_add_u32 s30, s39, 16384
    s_and_b32 s30, s30, 0x1ffff
    s_add_u32 m0, s37, 17024
    s_add_u32 s30, s30, s38
    buffer_load_dwordx4 v3, s[8:11], s30 offen lds
    buffer_load_dwordx4 v3, s[8:11], s30 offen offset:1024 lds
    s_add_u32 s30, s39, 32768
    s_and_b32 s30, s30, 0x1ffff
    s_add_u32 m0, s37, 34048
    s_add_u32 s30, s30, s38
    buffer_load_dwordx4 v3, s[8:11], s30 offen lds
    buffer_load_dwordx4 v3, s[8:11], s30 offen offset:1024 lds
    s_add_u32 s30, s39, 49152
    s_and_b32 s30, s30, 0x1ffff
    s_add_u32 m0, s37, 51072
    s_add_u32 s30, s30, s38
    buffer_load_dwordx4 v3, s[8:11], s30 offen lds
    buffer_load_dwordx4 v3, s[8:11], s30 offen offset:1024 lds
l1_nd67:
    ds_read_b128 v[80:83], v104 offset:0
    ds_read_b128 v[84:87], v104 offset:2128
    ds_read_b128 v[88:91], v105 offset:0
    ds_read_b128 v[92:95], v111 offset:0
    s_waitcnt lgkmcnt(3)
    v_mfma_f32_32x32x16_bf16 v[24:39], v[80:83], v[124:127], 0
    s_nop 11
    v_max3_f32 v106, v24, v25, v26
    v_max3_f32 v106, v106, v27, v28
    v_max3_f32 v106, v106, v29, v30
    v_max3_f32 v106, v106, v31, v32
    v_max3_f32 v106, v106, v33, v34
    v_max3_f32 v106, v106, v35, v36
    v_max3_f32 v106, v106, v37, v38
    v_max_f32 v106, v106, v39
    v_mov_b32 v107, v106
    s_nop 1
    v_permlane32_swap_b32 v106, v107
    v_max_f32 v106, v106, v107
    v_sub_f32 v8, 0, v106
    v_sub_f32 v9, 0, v106
    v_sub_f32 v10, 0, v106
    v_sub_f32 v11, 0, v106
    v_sub_f32 v12, 0, v106
    v_sub_f32 v13, 0, v106
    v_sub_f32 v14, 0, v106
    v_sub_f32 v15, 0, v106
    v_sub_f32 v16, 0, v106
    v_sub_f32 v17, 0, v106
    v_sub_f32 v18, 0, v106
    v_sub_f32 v19, 0, v106
    v_sub_f32 v20, 0, v106
    v_sub_f32 v21, 0, v106
    v_sub_f32 v22, 0, v106
    v_sub_f32 v23, 0, v106
    v_sub_f32 v24, v24, v106
    v_sub_f32 v25, v25, v106
    v_sub_f32 v26, v26, v106
    v_sub_f32 v27, v27, v106
    v_sub_f32 v28, v28, v106
    v_sub_f32 v29, v29, v106
    v_sub_f32 v30, v30, v106
    v_sub_f32 v31, v31, v106
    v_sub_f32 v32, v32, v106
    v_sub_f32 v33, v33, v106
    v_sub_f32 v34, v34, v106
    v_sub_f32 v35, v35, v106
    v_sub_f32 v36, v36, v106
    v_sub_f32 v37, v37, v106
    v_sub_f32 v38, v38, v106
    v_sub_f32 v39, v39, v106
    s_setprio 3
    s_waitcnt lgkmcnt(0)
    v_mfma_f32_32x32x16_bf16 v[40:55], v[84:87], v[124:127], v[8:23]
    ds_read_b128 v[80:83], v104 offset:4256
    v_exp_f32 v24, v24
    v_exp_f32 v25, v25
    v_exp_f32 v26, v26
    v_exp_f32 v27, v27
    v_exp_f32 v28, v28
    v_exp_f32 v29, v29
    v_mfma_f32_32x32x16_bf16 v[56:71], v[100:103], v[76:79], v[56:71]
    v_exp_f32 v30, v30
    v_exp_f32 v31, v31
    v_cvt_pk_bf16_f32 v72, v24, v25
    v_cvt_pk_bf16_f32 v73, v26, v27
    v_cvt_pk_bf16_f32 v74, v28, v29
    v_cvt_pk_bf16_f32 v75, v30, v31
    v_exp_f32 v32, v32
    v_exp_f32 v33, v33
    s_waitcnt lgkmcnt(0)
    v_mfma_f32_32x32x16_bf16 v[56:71], v[88:91], v[72:75], v[56:71]
    ds_read_b128 v[96:99], v105 offset:2128
    ds_read_b128 v[100:103], v111 offset:2128
    v_exp_f32 v34, v34
    v_exp_f32 v35, v35
    v_exp_f32 v36, v36
    v_exp_f32 v37, v37
    v_exp_f32 v38, v38
    v_exp_f32 v39, v39
    v_cvt_pk_bf16_f32 v76, v32, v33
    v_cvt_pk_bf16_f32 v77, v34, v35
    v_cvt_pk_bf16_f32 v78, v36, v37
    v_cvt_pk_bf16_f32 v79, v38, v39
    v_mfma_f32_32x32x16_bf16 v[24:39], v[80:83], v[124:127], v[8:23]
    ds_read_b128 v[84:87], v104 offset:6384
    v_exp_f32 v40, v40
    v_exp_f32 v41, v41
    v_exp_f32 v42, v42
    v_exp_f32 v43, v43
    v_exp_f32 v44, v44
    v_exp_f32 v45, v45
    v_mfma_f32_32x32x16_bf16 v[56:71], v[92:95], v[76:79], v[56:71]
    v_exp_f32 v46, v46
    v_exp_f32 v47, v47
    v_cvt_pk_bf16_f32 v72, v40, v41
    v_cvt_pk_bf16_f32 v73, v42, v43
    v_cvt_pk_bf16_f32 v74, v44, v45
    v_cvt_pk_bf16_f32 v75, v46, v47
    v_exp_f32 v48, v48
    v_exp_f32 v49, v49
    s_waitcnt lgkmcnt(0)
    v_mfma_f32_32x32x16_bf16 v[56:71], v[96:99], v[72:75], v[56:71]
    ds_read_b128 v[88:91], v105 offset:4256
    ds_read_b128 v[92:95], v111 offset:4256
    v_exp_f32 v50, v50
    v_exp_f32 v51, v51
    v_exp_f32 v52, v52
    v_exp_f32 v53, v53
    v_exp_f32 v54, v54
    v_exp_f32 v55, v55
    v_cvt_pk_bf16_f32 v76, v48, v49
    v_cvt_pk_bf16_f32 v77, v50, v51
    v_cvt_pk_bf16_f32 v78, v52, v53
    v_cvt_pk_bf16_f32 v79, v54, v55
    s_cmp_eq_u32 s32, 0xff
    s_cbranch_scc1 l1_dn68
    s_mov_b64 exec, 0xff
    buffer_load_dword v2, v0, s[8:11], s33 offen sc1
    s_mov_b64 exec, -1
    s_mov_b32 s31, 0
    s_mov_b64 exec, 0xff
l1_kp69:
    s_add_u32 s31, s31, 1
    s_waitcnt vmcnt(0)
    v_cmp_ne_u32 vcc, 0, v2
    s_and_b32 s30, vcc_lo, 255
    s_cmp_eq_u32 s30, 255
    s_cbranch_scc1 l1_kpd70
    s_sleep 2
    buffer_load_dword v2, v0, s[8:11], s33 offen sc1
    s_cmp_lt_u32 s31, 2097152
    s_cbranch_scc1 l1_kp69
    s_branch k_end
l1_kpd70:
    s_mov_b64 exec, -1
    s_add_u32 s30, s39, 16384
    s_and_b32 s30, s30, 0x1ffff
    s_add_u32 m0, s37, 17024
    s_add_u32 s30, s30, s38
    buffer_load_dwordx4 v3, s[8:11], s30 offen lds
    buffer_load_dwordx4 v3, s[8:11], s30 offen offset:1024 lds
    s_add_u32 s30, s39, 32768
    s_and_b32 s30, s30, 0x1ffff
    s_add_u32 m0, s37, 34048
    s_add_u32 s30, s30, s38
    buffer_load_dwordx4 v3, s[8:11], s30 offen lds
    buffer_load_dwordx4 v3, s[8:11], s30 offen offset:1024 lds
    s_add_u32 s30, s39, 49152
    s_and_b32 s30, s30, 0x1ffff
    s_add_u32 m0, s37, 51072
    s_add_u32 s30, s30, s38
    buffer_load_dwordx4 v3, s[8:11], s30 offen lds
    buffer_load_dwordx4 v3, s[8:11], s30 offen offset:1024 lds
l1_dn68:
    v_mfma_f32_32x32x16_bf16 v[40:55], v[84:87], v[124:127], v[8:23]
    ds_read_b128 v[80:83], v104 offset:8512
    v_exp_f32 v24, v24
    v_exp_f32 v25, v25
    v_exp_f32 v26, v26
    v_exp_f32 v27, v27
    v_exp_f32 v28, v28
    v_exp_f32 v29, v29
    v_mfma_f32_32x32x16_bf16 v[56:71], v[100:103], v[76:79], v[56:71]
    s_add_u32 s30, s39, 65536
    s_and_b32 s30, s30, 0x1ffff
    s_add_u32 m0, s37, 68096
    s_add_u32 s30, s30, s38
    buffer_load_dwordx4 v3, s[8:11], s30 offen lds
    buffer_load_dwordx4 v3, s[8:11], s30 offen offset:1024 lds
    s_add_u32 s30, s39, 81920
    s_and_b32 s30, s30, 0x1ffff
    s_add_u32 m0, s37, 85120
    s_add_u32 s30, s30, s38
    buffer_load_dwordx4 v3, s[8:11], s30 offen lds
    buffer_load_dwordx4 v3, s[8:11], s30 offen offset:1024 lds
    s_add_u32 s30, s39, 98304
    s_and_b32 s30, s30, 0x1ffff
    s_add_u32 m0, s37, 102144
    s_add_u32 s30, s30, s38
    buffer_load_dwordx4 v3, s[8:11], s30 offen lds
    buffer_load_dwordx4 v3, s[8:11], s30 offen offset:1024 lds
    s_add_u32 s30, s39, 114688
    s_and_b32 s30, s30, 0x1ffff
    s_add_u32 m0, s37, 119168
    s_add_u32 s30, s30, s38
    buffer_load_dwordx4 v3, s[8:11], s30 offen lds
    buffer_load_dwordx4 v3, s[8:11], s30 offen offset:1024 lds
    v_exp_f32 v30, v30
    v_exp_f32 v31, v31
    v_cvt_pk_bf16_f32 v72, v24, v25
    v_cvt_pk_bf16_f32 v73, v26, v27
    v_cvt_pk_bf16_f32 v74, v28, v29
    v_cvt_pk_bf16_f32 v75, v30, v31
    v_exp_f32 v32, v32
    v_exp_f32 v33, v33
    s_waitcnt lgkmcnt(0)
    v_mfma_f32_32x32x16_bf16 v[56:71], v[88:91], v[72:75], v[56:71]
    ds_read_b128 v[96:99], v105 offset:6384
    ds_read_b128 v[100:103], v111 offset:6384
    v_exp_f32 v34, v34
    v_exp_f32 v35, v35
    v_exp_f32 v36, v36
    v_exp_f32 v37, v37
    v_exp_f32 v38, v38
    v_exp_f32 v39, v39
    v_cvt_pk_bf16_f32 v76, v32, v33
    v_cvt_pk_bf16_f32 v77, v34, v35
    v_cvt_pk_bf16_f32 v78, v36, v37
    v_cvt_pk_bf16_f32 v79, v38, v39
    v_mfma_f32_32x32x16_bf16 v[24:39], v[80:83], v[124:127], v[8:23]
    ds_read_b128 v[84:87], v104 offset:10640
    v_exp_f32 v40, v40
    v_exp_f32 v41, v41
    v_exp_f32 v42, v42
    v_exp_f32 v43, v43
    v_exp_f32 v44, v44
    v_exp_f32 v45, v45
    v_mfma_f32_32x32x16_bf16 v[56:71], v[92:95], v[76:79], v[56:71]
    v_exp_f32 v46, v46
    v_exp_f32 v47, v47
    v_cvt_pk_bf16_f32 v72, v40, v41
    v_cvt_pk_bf16_f32 v73, v42, v43
    v_cvt_pk_bf16_f32 v74, v44, v45
    v_cvt_pk_bf16_f32 v75, v46, v47
    v_exp_f32 v48, v48
    v_exp_f32 v49, v49
    s_waitcnt lgkmcnt(0)
    v_mfma_f32_32x32x16_bf16 v[56:71], v[96:99], v[72:75], v[56:71]
    ds_read_b128 v[88:91], v105 offset:8512
    ds_read_b128 v[92:95], v111 offset:8512
    v_exp_f32 v50, v50
    v_exp_f32 v51, v51
    v_exp_f32 v52, v52
    v_exp_f32 v53, v53
    v_exp_f32 v54, v54
    v_exp_f32 v55, v55
    v_cvt_pk_bf16_f32 v76, v48, v49
    v_cvt_pk_bf16_f32 v77, v50, v51
    v_cvt_pk_bf16_f32 v78, v52, v53
    v_cvt_pk_bf16_f32 v79, v54, v55
    v_mfma_f32_32x32x16_bf16 v[40:55], v[84:87], v[124:127], v[8:23]
    ds_read_b128 v[80:83], v104 offset:12768
    v_exp_f32 v24, v24
    v_exp_f32 v25, v25
    v_exp_f32 v26, v26
    v_exp_f32 v27, v27
    v_exp_f32 v28, v28
    v_exp_f32 v29, v29
    v_mfma_f32_32x32x16_bf16 v[56:71], v[100:103], v[76:79], v[56:71]
    v_exp_f32 v30, v30
    v_exp_f32 v31, v31
    v_cvt_pk_bf16_f32 v72, v24, v25
    v_cvt_pk_bf16_f32 v73, v26, v27
    v_cvt_pk_bf16_f32 v74, v28, v29
    v_cvt_pk_bf16_f32 v75, v30, v31
    v_exp_f32 v32, v32
    v_exp_f32 v33, v33
    s_waitcnt lgkmcnt(0)
    v_mfma_f32_32x32x16_bf16 v[56:71], v[88:91], v[72:75], v[56:71]
    ds_read_b128 v[96:99], v105 offset:10640
    ds_read_b128 v[100:103], v111 offset:10640
    v_exp_f32 v34, v34
    v_exp_f32 v35, v35
    v_exp_f32 v36, v36
    v_exp_f32 v37, v37
    v_exp_f32 v38, v38
    v_exp_f32 v39, v39
    v_cvt_pk_bf16_f32 v76, v32, v33
    v_cvt_pk_bf16_f32 v77, v34, v35
    v_cvt_pk_bf16_f32 v78, v36, v37
    v_cvt_pk_bf16_f32 v79, v38, v39
    v_mfma_f32_32x32x16_bf16 v[24:39], v[80:83], v[124:127], v[8:23]
    ds_read_b128 v[84:87], v104 offset:14896
    v_exp_f32 v40, v40
    v_exp_f32 v41, v41
    v_exp_f32 v42, v42
    v_exp_f32 v43, v43
    v_exp_f32 v44, v44
    v_exp_f32 v45, v45
    v_mfma_f32_32x32x16_bf16 v[56:71], v[92:95], v[76:79], v[56:71]
    v_exp_f32 v46, v46
    v_exp_f32 v47, v47
    v_cvt_pk_bf16_f32 v72, v40, v41
    v_cvt_pk_bf16_f32 v73, v42, v43
    v_cvt_pk_bf16_f32 v74, v44, v45
    v_cvt_pk_bf16_f32 v75, v46, v47
    v_exp_f32 v48, v48
    v_exp_f32 v49, v49
    s_waitcnt lgkmcnt(0)
    v_mfma_f32_32x32x16_bf16 v[56:71], v[96:99], v[72:75], v[56:71]
    ds_read_b128 v[88:91], v105 offset:12768
    ds_read_b128 v[92:95], v111 offset:12768
    v_exp_f32 v50, v50
    v_exp_f32 v51, v51
    v_exp_f32 v52, v52
    v_exp_f32 v53, v53
    v_exp_f32 v54, v54
    v_exp_f32 v55, v55
    v_cvt_pk_bf16_f32 v76, v48, v49
    v_cvt_pk_bf16_f32 v77, v50, v51
    v_cvt_pk_bf16_f32 v78, v52, v53
    v_cvt_pk_bf16_f32 v79, v54, v55
    s_waitcnt vmcnt(0)
    s_barrier
    v_mfma_f32_32x32x16_bf16 v[40:55], v[84:87], v[124:127], v[8:23]
    ds_read_b128 v[80:83], v104 offset:17024
    v_exp_f32 v24, v24
    v_exp_f32 v25, v25
    v_exp_f32 v26, v26
    v_exp_f32 v27, v27
    v_exp_f32 v28, v28
    v_exp_f32 v29, v29
    v_mfma_f32_32x32x16_bf16 v[56:71], v[100:103], v[76:79], v[56:71]
    v_exp_f32 v30, v30
    v_exp_f32 v31, v31
    v_cvt_pk_bf16_f32 v72, v24, v25
    v_cvt_pk_bf16_f32 v73, v26, v27
    v_cvt_pk_bf16_f32 v74, v28, v29
    v_cvt_pk_bf16_f32 v75, v30, v31
    v_exp_f32 v32, v32
    v_exp_f32 v33, v33
    s_waitcnt lgkmcnt(0)
    v_mfma_f32_32x32x16_bf16 v[56:71], v[88:91], v[72:75], v[56:71]
    ds_read_b128 v[96:99], v105 offset:14896
    ds_read_b128 v[100:103], v111 offset:14896
    v_exp_f32 v34, v34
    v_exp_f32 v35, v35
    v_exp_f32 v36, v36
    v_exp_f32 v37, v37
    v_exp_f32 v38, v38
    v_exp_f32 v39, v39
    v_cvt_pk_bf16_f32 v76, v32, v33
    v_cvt_pk_bf16_f32 v77, v34, v35
    v_cvt_pk_bf16_f32 v78, v36, v37
    v_cvt_pk_bf16_f32 v79, v38, v39
    v_mfma_f32_32x32x16_bf16 v[24:39], v[80:83], v[124:127], v[8:23]
    ds_read_b128 v[84:87], v104 offset:19152
    v_exp_f32 v40, v40
    v_exp_f32 v41, v41
    v_exp_f32 v42, v42
    v_exp_f32 v43, v43
    v_exp_f32 v44, v44
    v_exp_f32 v45, v45
    v_mfma_f32_32x32x16_bf16 v[56:71], v[92:95], v[76:79], v[56:71]
    s_mul_i32 s30, s22, 7
    s_min_u32 s31, s20, 6
    s_add_u32 s40, s30, s31
    s_lshl_b32 s30, s40, 15
    s_add_u32 s30, s30, 1081344
    s_cmp_eq_u32 s20, 7
    s_cselect_b32 s30, 0x70000000, s30
    v_add_u32 v112, s30, v3
    s_lshl_b32 s30, s26, 8
    v_xor_b32 v113, s30, v3
    s_mul_i32 s31, s20, 14336
    s_add_u32 s31, s31, 4751360
    s_xor_b32 s30, s28, 1
    s_mul_i32 s30, s30, 114688
    s_add_u32 s30, s30, s31
    v_add_u32 v114, s30, v113
    s_mul_i32 s30, s28, 114688
    s_add_u32 s30, s30, s31
    v_add_u32 v113, s30, v113
    s_lshl_b32 s30, s26, 8
    v_xor_b32 v116, s30, v3
    s_and_b32 s30, s19, 0x7fff
    s_lshl_b32 s30, s30, 4
    s_add_u32 s30, s30, 557056
    v_add_u32 v116, s30, v116
    buffer_load_dwordx4 v[128:131], v112, s[8:11], 0 offen offset:0
    v_exp_f32 v46, v46
    v_exp_f32 v47, v47
    v_cvt_pk_bf16_f32 v72, v40, v41
    v_cvt_pk_bf16_f32 v73, v42, v43
    v_cvt_pk_bf16_f32 v74, v44, v45
    v_cvt_pk_bf16_f32 v75, v46, v47
    v_exp_f32 v48, v48
    v_exp_f32 v49, v49
    s_waitcnt lgkmcnt(0)
    v_mfma_f32_32x32x16_bf16 v[56:71], v[96:99], v[72:75], v[56:71]
    ds_read_b128 v[88:91], v105 offset:17024
    ds_read_b128 v[92:95], v111 offset:17024
    v_exp_f32 v50, v50
    v_exp_f32 v51, v51
    v_exp_f32 v52, v52
    v_exp_f32 v53, v53
    v_exp_f32 v54, v54
    v_exp_f32 v55, v55
    v_cvt_pk_bf16_f32 v76, v48, v49
    v_cvt_pk_bf16_f32 v77, v50, v51
    v_cvt_pk_bf16_f32 v78, v52, v53
    v_cvt_pk_bf16_f32 v79, v54, v55
    v_mfma_f32_32x32x16_bf16 v[40:55], v[84:87], v[124:127], v[8:23]
    ds_read_b128 v[80:83], v104 offset:21280
    v_exp_f32 v24, v24
    v_exp_f32 v25, v25
    v_exp_f32 v26, v26
    v_exp_f32 v27, v27
    v_exp_f32 v28, v28
    v_exp_f32 v29, v29
    v_mfma_f32_32x32x16_bf16 v[56:71], v[100:103], v[76:79], v[56:71]
    v_exp_f32 v30, v30
    v_exp_f32 v31, v31
    v_cvt_pk_bf16_f32 v72, v24, v25
    v_cvt_pk_bf16_f32 v73, v26, v27
    v_cvt_pk_bf16_f32 v74, v28, v29
    v_cvt_pk_bf16_f32 v75, v30, v31
    v_exp_f32 v32, v32
    v_exp_f32 v33, v33
    s_waitcnt lgkmcnt(0)
    v_mfma_f32_32x32x16_bf16 v[56:71], v[88:91], v[72:75], v[56:71]
    ds_read_b128 v[96:99], v105 offset:19152
    ds_read_b128 v[100:103], v111 offset:19152
    v_exp_f32 v34, v34
    v_exp_f32 v35, v35
    v_exp_f32 v36, v36
    v_exp_f32 v37, v37
    v_exp_f32 v38, v38
    v_exp_f32 v39, v39
    v_cvt_pk_bf16_f32 v76, v32, v33
    v_cvt_pk_bf16_f32 v77, v34, v35
    v_cvt_pk_bf16_f32 v78, v36, v37
    v_cvt_pk_bf16_f32 v79, v38, v39
    v_mfma_f32_32x32x16_bf16 v[24:39], v[80:83], v[124:127], v[8:23]
    ds_read_b128 v[84:87], v104 offset:23408
    v_exp_f32 v40, v40
    v_exp_f32 v41, v41
    v_exp_f32 v42, v42
    v_exp_f32 v43, v43
    v_exp_f32 v44, v44
    v_exp_f32 v45, v45
    v_mfma_f32_32x32x16_bf16 v[56:71], v[92:95], v[76:79], v[56:71]
    buffer_load_dwordx4 v[132:135], v112, s[8:11], 0 offen offset:1024
    v_exp_f32 v46, v46
    v_exp_f32 v47, v47
    v_cvt_pk_bf16_f32 v72, v40, v41
    v_cvt_pk_bf16_f32 v73, v42, v43
    v_cvt_pk_bf16_f32 v74, v44, v45
    v_cvt_pk_bf16_f32 v75, v46, v47
    v_exp_f32 v48, v48
    v_exp_f32 v49, v49
    s_waitcnt lgkmcnt(0)
    v_mfma_f32_32x32x16_bf16 v[56:71], v[96:99], v[72:75], v[56:71]
    ds_read_b128 v[88:91], v105 offset:21280
    ds_read_b128 v[92:95], v111 offset:21280
    v_exp_f32 v50, v50
    v_exp_f32 v51, v51
    v_exp_f32 v52, v52
    v_exp_f32 v53, v53
    v_exp_f32 v54, v54
    v_exp_f32 v55, v55
    v_cvt_pk_bf16_f32 v76, v48, v49
    v_cvt_pk_bf16_f32 v77, v50, v51
    v_cvt_pk_bf16_f32 v78, v52, v53
    v_cvt_pk_bf16_f32 v79, v54, v55
    v_mfma_f32_32x32x16_bf16 v[40:55], v[84:87], v[124:127], v[8:23]
    ds_read_b128 v[80:83], v104 offset:25536
    v_exp_f32 v24, v24
    v_exp_f32 v25, v25
    v_exp_f32 v26, v26
    v_exp_f32 v27, v27
    v_exp_f32 v28, v28
    v_exp_f32 v29, v29
    v_mfma_f32_32x32x16_bf16 v[56:71], v[100:103], v[76:79], v[56:71]
    buffer_load_dwordx4 v[136:139], v112, s[8:11], 0 offen offset:2048
    v_exp_f32 v30, v30
    v_exp_f32 v31, v31
    v_cvt_pk_bf16_f32 v72, v24, v25
    v_cvt_pk_bf16_f32 v73, v26, v27
    v_cvt_pk_bf16_f32 v74, v28, v29
    v_cvt_pk_bf16_f32 v75, v30, v31
    v_exp_f32 v32, v32
    v_exp_f32 v33, v33
    s_waitcnt lgkmcnt(0)
    v_mfma_f32_32x32x16_bf16 v[56:71], v[88:91], v[72:75], v[56:71]
    ds_read_b128 v[96:99], v105 offset:23408
    ds_read_b128 v[100:103], v111 offset:23408
    v_exp_f32 v34, v34
    v_exp_f32 v35, v35
    v_exp_f32 v36, v36
    v_exp_f32 v37, v37
    v_exp_f32 v38, v38
    v_exp_f32 v39, v39
    v_cvt_pk_bf16_f32 v76, v32, v33
    v_cvt_pk_bf16_f32 v77, v34, v35
    v_cvt_pk_bf16_f32 v78, v36, v37
    v_cvt_pk_bf16_f32 v79, v38, v39
    v_mfma_f32_32x32x16_bf16 v[24:39], v[80:83], v[124:127], v[8:23]
    ds_read_b128 v[84:87], v104 offset:27664
    v_exp_f32 v40, v40
    v_exp_f32 v41, v41
    v_exp_f32 v42, v42
    v_exp_f32 v43, v43
    v_exp_f32 v44, v44
    v_exp_f32 v45, v45
    v_mfma_f32_32x32x16_bf16 v[56:71], v[92:95], v[76:79], v[56:71]
    v_exp_f32 v46, v46
    v_exp_f32 v47, v47
    v_cvt_pk_bf16_f32 v72, v40, v41
    v_cvt_pk_bf16_f32 v73, v42, v43
    v_cvt_pk_bf16_f32 v74, v44, v45
    v_cvt_pk_bf16_f32 v75, v46, v47
    v_exp_f32 v48, v48
    v_exp_f32 v49, v49
    s_waitcnt lgkmcnt(0)
    v_mfma_f32_32x32x16_bf16 v[56:71], v[96:99], v[72:75], v[56:71]
    ds_read_b128 v[88:91], v105 offset:25536
    ds_read_b128 v[92:95], v111 offset:25536
    v_exp_f32 v50, v50
    v_exp_f32 v51, v51
    v_exp_f32 v52, v52
    v_exp_f32 v53, v53
    v_exp_f32 v54, v54
    v_exp_f32 v55, v55
    v_cvt_pk_bf16_f32 v76, v48, v49
    v_cvt_pk_bf16_f32 v77, v50, v51
    v_cvt_pk_bf16_f32 v78, v52, v53
    v_cvt_pk_bf16_f32 v79, v54, v55
    v_mfma_f32_32x32x16_bf16 v[40:55], v[84:87], v[124:127], v[8:23]
    ds_read_b128 v[80:83], v104 offset:29792
    v_exp_f32 v24, v24
    v_exp_f32 v25, v25
    v_exp_f32 v26, v26
    v_exp_f32 v27, v27
    v_exp_f32 v28, v28
    v_exp_f32 v29, v29
    v_mfma_f32_32x32x16_bf16 v[56:71], v[100:103], v[76:79], v[56:71]
    buffer_load_dwordx4 v[140:143], v112, s[8:11], 0 offen offset:3072
    v_exp_f32 v30, v30
    v_exp_f32 v31, v31
    v_cvt_pk_bf16_f32 v72, v24, v25
    v_cvt_pk_bf16_f32 v73, v26, v27
    v_cvt_pk_bf16_f32 v74, v28, v29
    v_cvt_pk_bf16_f32 v75, v30, v31
    v_exp_f32 v32, v32
    v_exp_f32 v33, v33
    s_waitcnt lgkmcnt(0)
    v_mfma_f32_32x32x16_bf16 v[56:71], v[88:91], v[72:75], v[56:71]
    ds_read_b128 v[96:99], v105 offset:27664
    ds_read_b128 v[100:103], v111 offset:27664
    v_exp_f32 v34, v34
    v_exp_f32 v35, v35
    v_exp_f32 v36, v36
    v_exp_f32 v37, v37
    v_exp_f32 v38, v38
    v_exp_f32 v39, v39
    v_cvt_pk_bf16_f32 v76, v32, v33
    v_cvt_pk_bf16_f32 v77, v34, v35
    v_cvt_pk_bf16_f32 v78, v36, v37
    v_cvt_pk_bf16_f32 v79, v38, v39
    v_mfma_f32_32x32x16_bf16 v[24:39], v[80:83], v[124:127], v[8:23]
    ds_read_b128 v[84:87], v104 offset:31920
    v_exp_f32 v40, v40
    v_exp_f32 v41, v41
    v_exp_f32 v42, v42
    v_exp_f32 v43, v43
    v_exp_f32 v44, v44
    v_exp_f32 v45, v45
    v_mfma_f32_32x32x16_bf16 v[56:71], v[92:95], v[76:79], v[56:71]
    buffer_load_dwordx4 v[144:147], v112, s[8:11], s41 offen offset:0
    v_exp_f32 v46, v46
    v_exp_f32 v47, v47
    v_cvt_pk_bf16_f32 v72, v40, v41
    v_cvt_pk_bf16_f32 v73, v42, v43
    v_cvt_pk_bf16_f32 v74, v44, v45
    v_cvt_pk_bf16_f32 v75, v46, v47
    v_exp_f32 v48, v48
    v_exp_f32 v49, v49
    s_waitcnt lgkmcnt(0)
    v_mfma_f32_32x32x16_bf16 v[56:71], v[96:99], v[72:75], v[56:71]
    ds_read_b128 v[88:91], v105 offset:29792
    ds_read_b128 v[92:95], v111 offset:29792
    v_exp_f32 v50, v50
    v_exp_f32 v51, v51
    v_exp_f32 v52, v52
    v_exp_f32 v53, v53
    v_exp_f32 v54, v54
    v_exp_f32 v55, v55
    v_cvt_pk_bf16_f32 v76, v48, v49
    v_cvt_pk_bf16_f32 v77, v50, v51
    v_cvt_pk_bf16_f32 v78, v52, v53
    v_cvt_pk_bf16_f32 v79, v54, v55
    v_mfma_f32_32x32x16_bf16 v[40:55], v[84:87], v[124:127], v[8:23]
    ds_read_b128 v[80:83], v104 offset:34048
    v_exp_f32 v24, v24
    v_exp_f32 v25, v25
    v_exp_f32 v26, v26
    v_exp_f32 v27, v27
    v_exp_f32 v28, v28
    v_exp_f32 v29, v29
    v_mfma_f32_32x32x16_bf16 v[56:71], v[100:103], v[76:79], v[56:71]
    v_exp_f32 v30, v30
    v_exp_f32 v31, v31
    v_cvt_pk_bf16_f32 v72, v24, v25
    v_cvt_pk_bf16_f32 v73, v26, v27
    v_cvt_pk_bf16_f32 v74, v28, v29
    v_cvt_pk_bf16_f32 v75, v30, v31
    v_exp_f32 v32, v32
    v_exp_f32 v33, v33
    s_waitcnt lgkmcnt(0)
    v_mfma_f32_32x32x16_bf16 v[56:71], v[88:91], v[72:75], v[56:71]
    ds_read_b128 v[96:99], v105 offset:31920
    ds_read_b128 v[100:103], v111 offset:31920
    v_exp_f32 v34, v34
    v_exp_f32 v35, v35
    v_exp_f32 v36, v36
    v_exp_f32 v37, v37
    v_exp_f32 v38, v38
    v_exp_f32 v39, v39
    v_cvt_pk_bf16_f32 v76, v32, v33
    v_cvt_pk_bf16_f32 v77, v34, v35
    v_cvt_pk_bf16_f32 v78, v36, v37
    v_cvt_pk_bf16_f32 v79, v38, v39
    v_mfma_f32_32x32x16_bf16 v[24:39], v[80:83], v[124:127], v[8:23]
    ds_read_b128 v[84:87], v104 offset:36176
    v_exp_f32 v40, v40
    v_exp_f32 v41, v41
    v_exp_f32 v42, v42
    v_exp_f32 v43, v43
    v_exp_f32 v44, v44
    v_exp_f32 v45, v45
    v_mfma_f32_32x32x16_bf16 v[56:71], v[92:95], v[76:79], v[56:71]
    buffer_load_dwordx4 v[148:151], v112, s[8:11], s41 offen offset:1024
    v_exp_f32 v46, v46
    v_exp_f32 v47, v47
    v_cvt_pk_bf16_f32 v72, v40, v41
    v_cvt_pk_bf16_f32 v73, v42, v43
    v_cvt_pk_bf16_f32 v74, v44, v45
    v_cvt_pk_bf16_f32 v75, v46, v47
    v_exp_f32 v48, v48
    v_exp_f32 v49, v49
    s_waitcnt lgkmcnt(0)
    v_mfma_f32_32x32x16_bf16 v[56:71], v[96:99], v[72:75], v[56:71]
    ds_read_b128 v[88:91], v105 offset:34048
    ds_read_b128 v[92:95], v111 offset:34048
    v_exp_f32 v50, v50
    v_exp_f32 v51, v51
    v_exp_f32 v52, v52
    v_exp_f32 v53, v53
    v_exp_f32 v54, v54
    v_exp_f32 v55, v55
    v_cvt_pk_bf16_f32 v76, v48, v49
    v_cvt_pk_bf16_f32 v77, v50, v51
    v_cvt_pk_bf16_f32 v78, v52, v53
    v_cvt_pk_bf16_f32 v79, v54, v55
    v_mfma_f32_32x32x16_bf16 v[40:55], v[84:87], v[124:127], v[8:23]
    ds_read_b128 v[80:83], v104 offset:38304
    v_exp_f32 v24, v24
    v_exp_f32 v25, v25
    v_exp_f32 v26, v26
    v_exp_f32 v27, v27
    v_exp_f32 v28, v28
    v_exp_f32 v29, v29
    v_mfma_f32_32x32x16_bf16 v[56:71], v[100:103], v[76:79], v[56:71]
    buffer_load_dwordx4 v[152:155], v112, s[8:11], s41 offen offset:2048
    v_exp_f32 v30, v30
    v_exp_f32 v31, v31
    v_cvt_pk_bf16_f32 v72, v24, v25
    v_cvt_pk_bf16_f32 v73, v26, v27
    v_cvt_pk_bf16_f32 v74, v28, v29
    v_cvt_pk_bf16_f32 v75, v30, v31
    v_exp_f32 v32, v32
    v_exp_f32 v33, v33
    s_waitcnt lgkmcnt(0)
    v_mfma_f32_32x32x16_bf16 v[56:71], v[88:91], v[72:75], v[56:71]
    ds_read_b128 v[96:99], v105 offset:36176
    ds_read_b128 v[100:103], v111 offset:36176
    v_exp_f32 v34, v34
    v_exp_f32 v35, v35
    v_exp_f32 v36, v36
    v_exp_f32 v37, v37
    v_exp_f32 v38, v38
    v_exp_f32 v39, v39
    v_cvt_pk_bf16_f32 v76, v32, v33
    v_cvt_pk_bf16_f32 v77, v34, v35
    v_cvt_pk_bf16_f32 v78, v36, v37
    v_cvt_pk_bf16_f32 v79, v38, v39
    v_mfma_f32_32x32x16_bf16 v[24:39], v[80:83], v[124:127], v[8:23]
    ds_read_b128 v[84:87], v104 offset:40432
    v_exp_f32 v40, v40
    v_exp_f32 v41, v41
    v_exp_f32 v42, v42
    v_exp_f32 v43, v43
    v_exp_f32 v44, v44
    v_exp_f32 v45, v45
    v_mfma_f32_32x32x16_bf16 v[56:71], v[92:95], v[76:79], v[56:71]
    v_exp_f32 v46, v46
    v_exp_f32 v47, v47
    v_cvt_pk_bf16_f32 v72, v40, v41
    v_cvt_pk_bf16_f32 v73, v42, v43
    v_cvt_pk_bf16_f32 v74, v44, v45
    v_cvt_pk_bf16_f32 v75, v46, v47
    v_exp_f32 v48, v48
    v_exp_f32 v49, v49
    s_waitcnt lgkmcnt(0)
    v_mfma_f32_32x32x16_bf16 v[56:71], v[96:99], v[72:75], v[56:71]
    ds_read_b128 v[88:91], v105 offset:38304
    ds_read_b128 v[92:95], v111 offset:38304
    v_exp_f32 v50, v50
    v_exp_f32 v51, v51
    v_exp_f32 v52, v52
    v_exp_f32 v53, v53
    v_exp_f32 v54, v54
    v_exp_f32 v55, v55
    v_cvt_pk_bf16_f32 v76, v48, v49
    v_cvt_pk_bf16_f32 v77, v50, v51
    v_cvt_pk_bf16_f32 v78, v52, v53
    v_cvt_pk_bf16_f32 v79, v54, v55
    v_mfma_f32_32x32x16_bf16 v[40:55], v[84:87], v[124:127], v[8:23]
    ds_read_b128 v[80:83], v104 offset:42560
    v_exp_f32 v24, v24
    v_exp_f32 v25, v25
    v_exp_f32 v26, v26
    v_exp_f32 v27, v27
    v_exp_f32 v28, v28
    v_exp_f32 v29, v29
    v_mfma_f32_32x32x16_bf16 v[56:71], v[100:103], v[76:79], v[56:71]
    buffer_load_dwordx4 v[156:159], v112, s[8:11], s41 offen offset:3072
    v_exp_f32 v30, v30
    v_exp_f32 v31, v31
    v_cvt_pk_bf16_f32 v72, v24, v25
    v_cvt_pk_bf16_f32 v73, v26, v27
    v_cvt_pk_bf16_f32 v74, v28, v29
    v_cvt_pk_bf16_f32 v75, v30, v31
    v_exp_f32 v32, v32
    v_exp_f32 v33, v33
    s_waitcnt lgkmcnt(0)
    v_mfma_f32_32x32x16_bf16 v[56:71], v[88:91], v[72:75], v[56:71]
    ds_read_b128 v[96:99], v105 offset:40432
    ds_read_b128 v[100:103], v111 offset:40432
    v_exp_f32 v34, v34
    v_exp_f32 v35, v35
    v_exp_f32 v36, v36
    v_exp_f32 v37, v37
    v_exp_f32 v38, v38
    v_exp_f32 v39, v39
    v_cvt_pk_bf16_f32 v76, v32, v33
    v_cvt_pk_bf16_f32 v77, v34, v35
    v_cvt_pk_bf16_f32 v78, v36, v37
    v_cvt_pk_bf16_f32 v79, v38, v39
    v_mfma_f32_32x32x16_bf16 v[24:39], v[80:83], v[124:127], v[8:23]
    ds_read_b128 v[84:87], v104 offset:44688
    v_exp_f32 v40, v40
    v_exp_f32 v41, v41
    v_exp_f32 v42, v42
    v_exp_f32 v43, v43
    v_exp_f32 v44, v44
    v_exp_f32 v45, v45
    v_mfma_f32_32x32x16_bf16 v[56:71], v[92:95], v[76:79], v[56:71]
    buffer_load_dwordx4 v[160:163], v112, s[8:11], s42 offen offset:0
    v_exp_f32 v46, v46
    v_exp_f32 v47, v47
    v_cvt_pk_bf16_f32 v72, v40, v41
    v_cvt_pk_bf16_f32 v73, v42, v43
    v_cvt_pk_bf16_f32 v74, v44, v45
    v_cvt_pk_bf16_f32 v75, v46, v47
    v_exp_f32 v48, v48
    v_exp_f32 v49, v49
    s_waitcnt lgkmcnt(0)
    v_mfma_f32_32x32x16_bf16 v[56:71], v[96:99], v[72:75], v[56:71]
    ds_read_b128 v[88:91], v105 offset:42560
    ds_read_b128 v[92:95], v111 offset:42560
    v_exp_f32 v50, v50
    v_exp_f32 v51, v51
    v_exp_f32 v52, v52
    v_exp_f32 v53, v53
    v_exp_f32 v54, v54
    v_exp_f32 v55, v55
    v_cvt_pk_bf16_f32 v76, v48, v49
    v_cvt_pk_bf16_f32 v77, v50, v51
    v_cvt_pk_bf16_f32 v78, v52, v53
    v_cvt_pk_bf16_f32 v79, v54, v55
    v_mfma_f32_32x32x16_bf16 v[40:55], v[84:87], v[124:127], v[8:23]
    ds_read_b128 v[80:83], v104 offset:46816
    v_exp_f32 v24, v24
    v_exp_f32 v25, v25
    v_exp_f32 v26, v26
    v_exp_f32 v27, v27
    v_exp_f32 v28, v28
    v_exp_f32 v29, v29
    v_mfma_f32_32x32x16_bf16 v[56:71], v[100:103], v[76:79], v[56:71]
    v_exp_f32 v30, v30
    v_exp_f32 v31, v31
    v_cvt_pk_bf16_f32 v72, v24, v25
    v_cvt_pk_bf16_f32 v73, v26, v27
    v_cvt_pk_bf16_f32 v74, v28, v29
    v_cvt_pk_bf16_f32 v75, v30, v31
    v_exp_f32 v32, v32
    v_exp_f32 v33, v33
    s_waitcnt lgkmcnt(0)
    v_mfma_f32_32x32x16_bf16 v[56:71], v[88:91], v[72:75], v[56:71]
    ds_read_b128 v[96:99], v105 offset:44688
    ds_read_b128 v[100:103], v111 offset:44688
    v_exp_f32 v34, v34
    v_exp_f32 v35, v35
    v_exp_f32 v36, v36
    v_exp_f32 v37, v37
    v_exp_f32 v38, v38
    v_exp_f32 v39, v39
    v_cvt_pk_bf16_f32 v76, v32, v33
    v_cvt_pk_bf16_f32 v77, v34, v35
    v_cvt_pk_bf16_f32 v78, v36, v37
    v_cvt_pk_bf16_f32 v79, v38, v39
    v_mfma_f32_32x32x16_bf16 v[24:39], v[80:83], v[124:127], v[8:23]
    ds_read_b128 v[84:87], v104 offset:48944
    v_exp_f32 v40, v40
    v_exp_f32 v41, v41
    v_exp_f32 v42, v42
    v_exp_f32 v43, v43
    v_exp_f32 v44, v44
    v_exp_f32 v45, v45
    v_mfma_f32_32x32x16_bf16 v[56:71], v[92:95], v[76:79], v[56:71]
    buffer_load_dwordx4 v[164:167], v112, s[8:11], s42 offen offset:1024
    v_exp_f32 v46, v46
    v_exp_f32 v47, v47
    v_cvt_pk_bf16_f32 v72, v40, v41
    v_cvt_pk_bf16_f32 v73, v42, v43
    v_cvt_pk_bf16_f32 v74, v44, v45
    v_cvt_pk_bf16_f32 v75, v46, v47
    v_exp_f32 v48, v48
    v_exp_f32 v49, v49
    s_waitcnt lgkmcnt(0)
    v_mfma_f32_32x32x16_bf16 v[56:71], v[96:99], v[72:75], v[56:71]
    ds_read_b128 v[88:91], v105 offset:46816
    ds_read_b128 v[92:95], v111 offset:46816
    v_exp_f32 v50, v50
    v_exp_f32 v51, v51
    v_exp_f32 v52, v52
    v_exp_f32 v53, v53
    v_exp_f32 v54, v54
    v_exp_f32 v55, v55
    v_cvt_pk_bf16_f32 v76, v48, v49
    v_cvt_pk_bf16_f32 v77, v50, v51
    v_cvt_pk_bf16_f32 v78, v52, v53
    v_cvt_pk_bf16_f32 v79, v54, v55
    v_mfma_f32_32x32x16_bf16 v[40:55], v[84:87], v[124:127], v[8:23]
    ds_read_b128 v[80:83], v104 offset:51072
    v_exp_f32 v24, v24
    v_exp_f32 v25, v25
    v_exp_f32 v26, v26
    v_exp_f32 v27, v27
    v_exp_f32 v28, v28
    v_exp_f32 v29, v29
    v_mfma_f32_32x32x16_bf16 v[56:71], v[100:103], v[76:79], v[56:71]
    buffer_load_dwordx4 v[168:171], v112, s[8:11], s42 offen offset:2048
    v_exp_f32 v30, v30
    v_exp_f32 v31, v31
    v_cvt_pk_bf16_f32 v72, v24, v25
    v_cvt_pk_bf16_f32 v73, v26, v27
    v_cvt_pk_bf16_f32 v74, v28, v29
    v_cvt_pk_bf16_f32 v75, v30, v31
    v_exp_f32 v32, v32
    v_exp_f32 v33, v33
    s_waitcnt lgkmcnt(0)
    v_mfma_f32_32x32x16_bf16 v[56:71], v[88:91], v[72:75], v[56:71]
    ds_read_b128 v[96:99], v105 offset:48944
    ds_read_b128 v[100:103], v111 offset:48944
    v_exp_f32 v34, v34
    v_exp_f32 v35, v35
    v_exp_f32 v36, v36
    v_exp_f32 v37, v37
    v_exp_f32 v38, v38
    v_exp_f32 v39, v39
    v_cvt_pk_bf16_f32 v76, v32, v33
    v_cvt_pk_bf16_f32 v77, v34, v35
    v_cvt_pk_bf16_f32 v78, v36, v37
    v_cvt_pk_bf16_f32 v79, v38, v39
    v_mfma_f32_32x32x16_bf16 v[24:39], v[80:83], v[124:127], v[8:23]
    ds_read_b128 v[84:87], v104 offset:53200
    v_exp_f32 v40, v40
    v_exp_f32 v41, v41
    v_exp_f32 v42, v42
    v_exp_f32 v43, v43
    v_exp_f32 v44, v44
    v_exp_f32 v45, v45
    v_mfma_f32_32x32x16_bf16 v[56:71], v[92:95], v[76:79], v[56:71]
    v_exp_f32 v46, v46
    v_exp_f32 v47, v47
    v_cvt_pk_bf16_f32 v72, v40, v41
    v_cvt_pk_bf16_f32 v73, v42, v43
    v_cvt_pk_bf16_f32 v74, v44, v45
    v_cvt_pk_bf16_f32 v75, v46, v47
    v_exp_f32 v48, v48
    v_exp_f32 v49, v49
    s_waitcnt lgkmcnt(0)
    v_mfma_f32_32x32x16_bf16 v[56:71], v[96:99], v[72:75], v[56:71]
    ds_read_b128 v[88:91], v105 offset:51072
    ds_read_b128 v[92:95], v111 offset:51072
    v_exp_f32 v50, v50
    v_exp_f32 v51, v51
    v_exp_f32 v52, v52
    v_exp_f32 v53, v53
    v_exp_f32 v54, v54
    v_exp_f32 v55, v55
    v_cvt_pk_bf16_f32 v76, v48, v49
    v_cvt_pk_bf16_f32 v77, v50, v51
    v_cvt_pk_bf16_f32 v78, v52, v53
    v_cvt_pk_bf16_f32 v79, v54, v55
    v_add_u32 v104, 51072, v104
    v_add_u32 v105, 51072, v105
    v_add_u32 v111, 51072, v111
    v_mfma_f32_32x32x16_bf16 v[40:55], v[84:87], v[124:127], v[8:23]
    ds_read_b128 v[80:83], v104 offset:4256
    v_exp_f32 v24, v24
    v_exp_f32 v25, v25
    v_exp_f32 v26, v26
    v_exp_f32 v27, v27
    v_exp_f32 v28, v28
    v_exp_f32 v29, v29
    v_mfma_f32_32x32x16_bf16 v[56:71], v[100:103], v[76:79], v[56:71]
    buffer_load_dwordx4 v[172:175], v112, s[8:11], s42 offen offset:3072
    v_exp_f32 v30, v30
    v_exp_f32 v31, v31
    v_cvt_pk_bf16_f32 v72, v24, v25
    v_cvt_pk_bf16_f32 v73, v26, v27
    v_cvt_pk_bf16_f32 v74, v28, v29
    v_cvt_pk_bf16_f32 v75, v30, v31
    v_exp_f32 v32, v32
    v_exp_f32 v33, v33
    s_waitcnt lgkmcnt(0)
    v_mfma_f32_32x32x16_bf16 v[56:71], v[88:91], v[72:75], v[56:71]
    ds_read_b128 v[96:99], v105 offset:2128
    ds_read_b128 v[100:103], v111 offset:2128
    v_exp_f32 v34, v34
    v_exp_f32 v35, v35
    v_exp_f32 v36, v36
    v_exp_f32 v37, v37
    v_exp_f32 v38, v38
    v_exp_f32 v39, v39
    v_cvt_pk_bf16_f32 v76, v32, v33
    v_cvt_pk_bf16_f32 v77, v34, v35
    v_cvt_pk_bf16_f32 v78, v36, v37
    v_cvt_pk_bf16_f32 v79, v38, v39
    v_mfma_f32_32x32x16_bf16 v[24:39], v[80:83], v[124:127], v[8:23]
    ds_read_b128 v[84:87], v104 offset:6384
    v_exp_f32 v40, v40
    v_exp_f32 v41, v41
    v_exp_f32 v42, v42
    v_exp_f32 v43, v43
    v_exp_f32 v44, v44
    v_exp_f32 v45, v45
    v_mfma_f32_32x32x16_bf16 v[56:71], v[92:95], v[76:79], v[56:71]
    buffer_load_dwordx4 v[176:179], v112, s[8:11], s43 offen offset:0
    v_exp_f32 v46, v46
    v_exp_f32 v47, v47
    v_cvt_pk_bf16_f32 v72, v40, v41
    v_cvt_pk_bf16_f32 v73, v42, v43
    v_cvt_pk_bf16_f32 v74, v44, v45
    v_cvt_pk_bf16_f32 v75, v46, v47
    v_exp_f32 v48, v48
    v_exp_f32 v49, v49
    s_waitcnt lgkmcnt(0)
    v_mfma_f32_32x32x16_bf16 v[56:71], v[96:99], v[72:75], v[56:71]
    ds_read_b128 v[88:91], v105 offset:4256
    ds_read_b128 v[92:95], v111 offset:4256
    v_exp_f32 v50, v50
    v_exp_f32 v51, v51
    v_exp_f32 v52, v52
    v_exp_f32 v53, v53
    v_exp_f32 v54, v54
    v_exp_f32 v55, v55
    v_cvt_pk_bf16_f32 v76, v48, v49
    v_cvt_pk_bf16_f32 v77, v50, v51
    v_cvt_pk_bf16_f32 v78, v52, v53
    v_cvt_pk_bf16_f32 v79, v54, v55
    v_mfma_f32_32x32x16_bf16 v[40:55], v[84:87], v[124:127], v[8:23]
    ds_read_b128 v[80:83], v104 offset:8512
    v_exp_f32 v24, v24
    v_exp_f32 v25, v25
    v_exp_f32 v26, v26
    v_exp_f32 v27, v27
    v_exp_f32 v28, v28
    v_exp_f32 v29, v29
    v_mfma_f32_32x32x16_bf16 v[56:71], v[100:103], v[76:79], v[56:71]
    v_exp_f32 v30, v30
    v_exp_f32 v31, v31
    v_cvt_pk_bf16_f32 v72, v24, v25
    v_cvt_pk_bf16_f32 v73, v26, v27
    v_cvt_pk_bf16_f32 v74, v28, v29
    v_cvt_pk_bf16_f32 v75, v30, v31
    v_exp_f32 v32, v32
    v_exp_f32 v33, v33
    s_waitcnt lgkmcnt(0)
    v_mfma_f32_32x32x16_bf16 v[56:71], v[88:91], v[72:75], v[56:71]
    ds_read_b128 v[96:99], v105 offset:6384
    ds_read_b128 v[100:103], v111 offset:6384
    v_exp_f32 v34, v34
    v_exp_f32 v35, v35
    v_exp_f32 v36, v36
    v_exp_f32 v37, v37
    v_exp_f32 v38, v38
    v_exp_f32 v39, v39
    v_cvt_pk_bf16_f32 v76, v32, v33
    v_cvt_pk_bf16_f32 v77, v34, v35
    v_cvt_pk_bf16_f32 v78, v36, v37
    v_cvt_pk_bf16_f32 v79, v38, v39
    v_mfma_f32_32x32x16_bf16 v[24:39], v[80:83], v[124:127], v[8:23]
    ds_read_b128 v[84:87], v104 offset:10640
    v_exp_f32 v40, v40
    v_exp_f32 v41, v41
    v_exp_f32 v42, v42
    v_exp_f32 v43, v43
    v_exp_f32 v44, v44
    v_exp_f32 v45, v45
    v_mfma_f32_32x32x16_bf16 v[56:71], v[92:95], v[76:79], v[56:71]
    buffer_load_dwordx4 v[180:183], v112, s[8:11], s43 offen offset:1024
    v_exp_f32 v46, v46
    v_exp_f32 v47, v47
    v_cvt_pk_bf16_f32 v72, v40, v41
    v_cvt_pk_bf16_f32 v73, v42, v43
    v_cvt_pk_bf16_f32 v74, v44, v45
    v_cvt_pk_bf16_f32 v75, v46, v47
    v_exp_f32 v48, v48
    v_exp_f32 v49, v49
    s_waitcnt lgkmcnt(0)
    v_mfma_f32_32x32x16_bf16 v[56:71], v[96:99], v[72:75], v[56:71]
    ds_read_b128 v[88:91], v105 offset:8512
    ds_read_b128 v[92:95], v111 offset:8512
    v_exp_f32 v50, v50
    v_exp_f32 v51, v51
    v_exp_f32 v52, v52
    v_exp_f32 v53, v53
    v_exp_f32 v54, v54
    v_exp_f32 v55, v55
    v_cvt_pk_bf16_f32 v76, v48, v49
    v_cvt_pk_bf16_f32 v77, v50, v51
    v_cvt_pk_bf16_f32 v78, v52, v53
    v_cvt_pk_bf16_f32 v79, v54, v55
    s_setprio 2
    v_mfma_f32_32x32x16_bf16 v[40:55], v[84:87], v[124:127], v[8:23]
    ds_read_b128 v[80:83], v104 offset:12768
    v_exp_f32 v24, v24
    v_exp_f32 v25, v25
    v_exp_f32 v26, v26
    v_exp_f32 v27, v27
    v_exp_f32 v28, v28
    v_exp_f32 v29, v29
    v_mfma_f32_32x32x16_bf16 v[56:71], v[100:103], v[76:79], v[56:71]
    buffer_load_dwordx4 v[184:187], v112, s[8:11], s43 offen offset:2048
    v_exp_f32 v30, v30
    v_exp_f32 v31, v31
    v_cvt_pk_bf16_f32 v72, v24, v25
    v_cvt_pk_bf16_f32 v73, v26, v27
    v_cvt_pk_bf16_f32 v74, v28, v29
    v_cvt_pk_bf16_f32 v75, v30, v31
    v_exp_f32 v32, v32
    v_exp_f32 v33, v33
    s_waitcnt lgkmcnt(0)
    v_mfma_f32_32x32x16_bf16 v[56:71], v[88:91], v[72:75], v[56:71]
    ds_read_b128 v[96:99], v105 offset:10640
    ds_read_b128 v[100:103], v111 offset:10640
    v_exp_f32 v34, v34
    v_exp_f32 v35, v35
    v_exp_f32 v36, v36
    v_exp_f32 v37, v37
    v_exp_f32 v38, v38
    v_exp_f32 v39, v39
    v_cvt_pk_bf16_f32 v76, v32, v33
    v_cvt_pk_bf16_f32 v77, v34, v35
    v_cvt_pk_bf16_f32 v78, v36, v37
    v_cvt_pk_bf16_f32 v79, v38, v39
    v_mfma_f32_32x32x16_bf16 v[24:39], v[80:83], v[124:127], v[8:23]
    ds_read_b128 v[84:87], v104 offset:14896
    v_exp_f32 v40, v40
    v_exp_f32 v41, v41
    v_exp_f32 v42, v42
    v_exp_f32 v43, v43
    v_exp_f32 v44, v44
    v_exp_f32 v45, v45
    v_mfma_f32_32x32x16_bf16 v[56:71], v[92:95], v[76:79], v[56:71]
    v_exp_f32 v46, v46
    v_exp_f32 v47, v47
    v_cvt_pk_bf16_f32 v72, v40, v41
    v_cvt_pk_bf16_f32 v73, v42, v43
    v_cvt_pk_bf16_f32 v74, v44, v45
    v_cvt_pk_bf16_f32 v75, v46, v47
    v_exp_f32 v48, v48
    v_exp_f32 v49, v49
    s_waitcnt lgkmcnt(0)
    v_mfma_f32_32x32x16_bf16 v[56:71], v[96:99], v[72:75], v[56:71]
    ds_read_b128 v[88:91], v105 offset:12768
    ds_read_b128 v[92:95], v111 offset:12768
    v_exp_f32 v50, v50
    v_exp_f32 v51, v51
    v_exp_f32 v52, v52
    v_exp_f32 v53, v53
    v_exp_f32 v54, v54
    v_exp_f32 v55, v55
    v_cvt_pk_bf16_f32 v76, v48, v49
    v_cvt_pk_bf16_f32 v77, v50, v51
    v_cvt_pk_bf16_f32 v78, v52, v53
    v_cvt_pk_bf16_f32 v79, v54, v55
    v_mfma_f32_32x32x16_bf16 v[40:55], v[84:87], v[124:127], v[8:23]
    ds_read_b128 v[80:83], v104 offset:17024
    v_exp_f32 v24, v24
    v_exp_f32 v25, v25
    v_exp_f32 v26, v26
    v_exp_f32 v27, v27
    v_exp_f32 v28, v28
    v_exp_f32 v29, v29
    v_mfma_f32_32x32x16_bf16 v[56:71], v[100:103], v[76:79], v[56:71]
    buffer_load_dwordx4 v[188:191], v112, s[8:11], s43 offen offset:3072
    v_exp_f32 v30, v30
    v_exp_f32 v31, v31
    v_cvt_pk_bf16_f32 v72, v24, v25
    v_cvt_pk_bf16_f32 v73, v26, v27
    v_cvt_pk_bf16_f32 v74, v28, v29
    v_cvt_pk_bf16_f32 v75, v30, v31
    v_exp_f32 v32, v32
    v_exp_f32 v33, v33
    s_waitcnt lgkmcnt(0)
    v_mfma_f32_32x32x16_bf16 v[56:71], v[88:91], v[72:75], v[56:71]
    ds_read_b128 v[96:99], v105 offset:14896
    ds_read_b128 v[100:103], v111 offset:14896
    v_exp_f32 v34, v34
    v_exp_f32 v35, v35
    v_exp_f32 v36, v36
    v_exp_f32 v37, v37
    v_exp_f32 v38, v38
    v_exp_f32 v39, v39
    v_cvt_pk_bf16_f32 v76, v32, v33
    v_cvt_pk_bf16_f32 v77, v34, v35
    v_cvt_pk_bf16_f32 v78, v36, v37
    v_cvt_pk_bf16_f32 v79, v38, v39
    v_mfma_f32_32x32x16_bf16 v[24:39], v[80:83], v[124:127], v[8:23]
    ds_read_b128 v[84:87], v104 offset:19152
    v_exp_f32 v40, v40
    v_exp_f32 v41, v41
    v_exp_f32 v42, v42
    v_exp_f32 v43, v43
    v_exp_f32 v44, v44
    v_exp_f32 v45, v45
    v_mfma_f32_32x32x16_bf16 v[56:71], v[92:95], v[76:79], v[56:71]
    buffer_load_dwordx4 v[192:195], v112, s[8:11], s44 offen offset:0
    v_exp_f32 v46, v46
    v_exp_f32 v47, v47
    v_cvt_pk_bf16_f32 v72, v40, v41
    v_cvt_pk_bf16_f32 v73, v42, v43
    v_cvt_pk_bf16_f32 v74, v44, v45
    v_cvt_pk_bf16_f32 v75, v46, v47
    v_exp_f32 v48, v48
    v_exp_f32 v49, v49
    s_waitcnt lgkmcnt(0)
    v_mfma_f32_32x32x16_bf16 v[56:71], v[96:99], v[72:75], v[56:71]
    ds_read_b128 v[88:91], v105 offset:17024
    ds_read_b128 v[92:95], v111 offset:17024
    v_exp_f32 v50, v50
    v_exp_f32 v51, v51
    v_exp_f32 v52, v52
    v_exp_f32 v53, v53
    v_exp_f32 v54, v54
    v_exp_f32 v55, v55
    v_cvt_pk_bf16_f32 v76, v48, v49
    v_cvt_pk_bf16_f32 v77, v50, v51
    v_cvt_pk_bf16_f32 v78, v52, v53
    v_cvt_pk_bf16_f32 v79, v54, v55
    v_mfma_f32_32x32x16_bf16 v[40:55], v[84:87], v[124:127], v[8:23]
    ds_read_b128 v[80:83], v104 offset:21280
    v_exp_f32 v24, v24
    v_exp_f32 v25, v25
    v_exp_f32 v26, v26
    v_exp_f32 v27, v27
    v_exp_f32 v28, v28
    v_exp_f32 v29, v29
    v_mfma_f32_32x32x16_bf16 v[56:71], v[100:103], v[76:79], v[56:71]
    v_exp_f32 v30, v30
    v_exp_f32 v31, v31
    v_cvt_pk_bf16_f32 v72, v24, v25
    v_cvt_pk_bf16_f32 v73, v26, v27
    v_cvt_pk_bf16_f32 v74, v28, v29
    v_cvt_pk_bf16_f32 v75, v30, v31
    v_exp_f32 v32, v32
    v_exp_f32 v33, v33
    s_waitcnt lgkmcnt(0)
    v_mfma_f32_32x32x16_bf16 v[56:71], v[88:91], v[72:75], v[56:71]
    ds_read_b128 v[96:99], v105 offset:19152
    ds_read_b128 v[100:103], v111 offset:19152
    v_exp_f32 v34, v34
    v_exp_f32 v35, v35
    v_exp_f32 v36, v36
    v_exp_f32 v37, v37
    v_exp_f32 v38, v38
    v_exp_f32 v39, v39
    v_cvt_pk_bf16_f32 v76, v32, v33
    v_cvt_pk_bf16_f32 v77, v34, v35
    v_cvt_pk_bf16_f32 v78, v36, v37
    v_cvt_pk_bf16_f32 v79, v38, v39
    v_mfma_f32_32x32x16_bf16 v[24:39], v[80:83], v[124:127], v[8:23]
    ds_read_b128 v[84:87], v104 offset:23408
    v_exp_f32 v40, v40
    v_exp_f32 v41, v41
    v_exp_f32 v42, v42
    v_exp_f32 v43, v43
    v_exp_f32 v44, v44
    v_exp_f32 v45, v45
    v_mfma_f32_32x32x16_bf16 v[56:71], v[92:95], v[76:79], v[56:71]
    buffer_load_dwordx4 v[196:199], v112, s[8:11], s44 offen offset:1024
    v_exp_f32 v46, v46
    v_exp_f32 v47, v47
    v_cvt_pk_bf16_f32 v72, v40, v41
    v_cvt_pk_bf16_f32 v73, v42, v43
    v_cvt_pk_bf16_f32 v74, v44, v45
    v_cvt_pk_bf16_f32 v75, v46, v47
    v_exp_f32 v48, v48
    v_exp_f32 v49, v49
    s_waitcnt lgkmcnt(0)
    v_mfma_f32_32x32x16_bf16 v[56:71], v[96:99], v[72:75], v[56:71]
    ds_read_b128 v[88:91], v105 offset:21280
    ds_read_b128 v[92:95], v111 offset:21280
    v_exp_f32 v50, v50
    v_exp_f32 v51, v51
    v_exp_f32 v52, v52
    v_exp_f32 v53, v53
    v_exp_f32 v54, v54
    v_exp_f32 v55, v55
    v_cvt_pk_bf16_f32 v76, v48, v49
    v_cvt_pk_bf16_f32 v77, v50, v51
    v_cvt_pk_bf16_f32 v78, v52, v53
    v_cvt_pk_bf16_f32 v79, v54, v55
    v_mfma_f32_32x32x16_bf16 v[40:55], v[84:87], v[124:127], v[8:23]
    ds_read_b128 v[80:83], v104 offset:25536
    v_exp_f32 v24, v24
    v_exp_f32 v25, v25
    v_exp_f32 v26, v26
    v_exp_f32 v27, v27
    v_exp_f32 v28, v28
    v_exp_f32 v29, v29
    v_mfma_f32_32x32x16_bf16 v[56:71], v[100:103], v[76:79], v[56:71]
    buffer_load_dwordx4 v[200:203], v112, s[8:11], s44 offen offset:2048
    v_exp_f32 v30, v30
    v_exp_f32 v31, v31
    v_cvt_pk_bf16_f32 v72, v24, v25
    v_cvt_pk_bf16_f32 v73, v26, v27
    v_cvt_pk_bf16_f32 v74, v28, v29
    v_cvt_pk_bf16_f32 v75, v30, v31
    v_exp_f32 v32, v32
    v_exp_f32 v33, v33
    s_waitcnt lgkmcnt(0)
    v_mfma_f32_32x32x16_bf16 v[56:71], v[88:91], v[72:75], v[56:71]
    ds_read_b128 v[96:99], v105 offset:23408
    ds_read_b128 v[100:103], v111 offset:23408
    v_exp_f32 v34, v34
    v_exp_f32 v35, v35
    v_exp_f32 v36, v36
    v_exp_f32 v37, v37
    v_exp_f32 v38, v38
    v_exp_f32 v39, v39
    v_cvt_pk_bf16_f32 v76, v32, v33
    v_cvt_pk_bf16_f32 v77, v34, v35
    v_cvt_pk_bf16_f32 v78, v36, v37
    v_cvt_pk_bf16_f32 v79, v38, v39
    v_mfma_f32_32x32x16_bf16 v[24:39], v[80:83], v[124:127], v[8:23]
    ds_read_b128 v[84:87], v104 offset:27664
    v_exp_f32 v40, v40
    v_exp_f32 v41, v41
    v_exp_f32 v42, v42
    v_exp_f32 v43, v43
    v_exp_f32 v44, v44
    v_exp_f32 v45, v45
    v_mfma_f32_32x32x16_bf16 v[56:71], v[92:95], v[76:79], v[56:71]
    v_exp_f32 v46, v46
    v_exp_f32 v47, v47
    v_cvt_pk_bf16_f32 v72, v40, v41
    v_cvt_pk_bf16_f32 v73, v42, v43
    v_cvt_pk_bf16_f32 v74, v44, v45
    v_cvt_pk_bf16_f32 v75, v46, v47
    v_exp_f32 v48, v48
    v_exp_f32 v49, v49
    s_waitcnt lgkmcnt(0)
    v_mfma_f32_32x32x16_bf16 v[56:71], v[96:99], v[72:75], v[56:71]
    ds_read_b128 v[88:91], v105 offset:25536
    ds_read_b128 v[92:95], v111 offset:25536
    v_exp_f32 v50, v50
    v_exp_f32 v51, v51
    v_exp_f32 v52, v52
    v_exp_f32 v53, v53
    v_exp_f32 v54, v54
    v_exp_f32 v55, v55
    v_cvt_pk_bf16_f32 v76, v48, v49
    v_cvt_pk_bf16_f32 v77, v50, v51
    v_cvt_pk_bf16_f32 v78, v52, v53
    v_cvt_pk_bf16_f32 v79, v54, v55
    v_mfma_f32_32x32x16_bf16 v[40:55], v[84:87], v[124:127], v[8:23]
    ds_read_b128 v[80:83], v104 offset:29792
    v_exp_f32 v24, v24
    v_exp_f32 v25, v25
    v_exp_f32 v26, v26
    v_exp_f32 v27, v27
    v_exp_f32 v28, v28
    v_exp_f32 v29, v29
    v_mfma_f32_32x32x16_bf16 v[56:71], v[100:103], v[76:79], v[56:71]
    buffer_load_dwordx4 v[204:207], v112, s[8:11], s44 offen offset:3072
    v_exp_f32 v30, v30
    v_exp_f32 v31, v31
    v_cvt_pk_bf16_f32 v72, v24, v25
    v_cvt_pk_bf16_f32 v73, v26, v27
    v_cvt_pk_bf16_f32 v74, v28, v29
    v_cvt_pk_bf16_f32 v75, v30, v31
    v_exp_f32 v32, v32
    v_exp_f32 v33, v33
    s_waitcnt lgkmcnt(0)
    v_mfma_f32_32x32x16_bf16 v[56:71], v[88:91], v[72:75], v[56:71]
    ds_read_b128 v[96:99], v105 offset:27664
    ds_read_b128 v[100:103], v111 offset:27664
    v_exp_f32 v34, v34
    v_exp_f32 v35, v35
    v_exp_f32 v36, v36
    v_exp_f32 v37, v37
    v_exp_f32 v38, v38
    v_exp_f32 v39, v39
    v_cvt_pk_bf16_f32 v76, v32, v33
    v_cvt_pk_bf16_f32 v77, v34, v35
    v_cvt_pk_bf16_f32 v78, v36, v37
    v_cvt_pk_bf16_f32 v79, v38, v39
    v_mfma_f32_32x32x16_bf16 v[24:39], v[80:83], v[124:127], v[8:23]
    ds_read_b128 v[84:87], v104 offset:31920
    v_exp_f32 v40, v40
    v_exp_f32 v41, v41
    v_exp_f32 v42, v42
    v_exp_f32 v43, v43
    v_exp_f32 v44, v44
    v_exp_f32 v45, v45
    v_mfma_f32_32x32x16_bf16 v[56:71], v[92:95], v[76:79], v[56:71]
    buffer_load_dwordx4 v[208:211], v112, s[8:11], s45 offen offset:0
    v_exp_f32 v46, v46
    v_exp_f32 v47, v47
    v_cvt_pk_bf16_f32 v72, v40, v41
    v_cvt_pk_bf16_f32 v73, v42, v43
    v_cvt_pk_bf16_f32 v74, v44, v45
    v_cvt_pk_bf16_f32 v75, v46, v47
    v_exp_f32 v48, v48
    v_exp_f32 v49, v49
    s_waitcnt lgkmcnt(0)
    v_mfma_f32_32x32x16_bf16 v[56:71], v[96:99], v[72:75], v[56:71]
    ds_read_b128 v[88:91], v105 offset:29792
    ds_read_b128 v[92:95], v111 offset:29792
    v_exp_f32 v50, v50
    v_exp_f32 v51, v51
    v_exp_f32 v52, v52
    v_exp_f32 v53, v53
    v_exp_f32 v54, v54
    v_exp_f32 v55, v55
    v_cvt_pk_bf16_f32 v76, v48, v49
    v_cvt_pk_bf16_f32 v77, v50, v51
    v_cvt_pk_bf16_f32 v78, v52, v53
    v_cvt_pk_bf16_f32 v79, v54, v55
    v_mfma_f32_32x32x16_bf16 v[40:55], v[84:87], v[124:127], v[8:23]
    ds_read_b128 v[80:83], v104 offset:34048
    v_exp_f32 v24, v24
    v_exp_f32 v25, v25
    v_exp_f32 v26, v26
    v_exp_f32 v27, v27
    v_exp_f32 v28, v28
    v_exp_f32 v29, v29
    v_mfma_f32_32x32x16_bf16 v[56:71], v[100:103], v[76:79], v[56:71]
    v_exp_f32 v30, v30
    v_exp_f32 v31, v31
    v_cvt_pk_bf16_f32 v72, v24, v25
    v_cvt_pk_bf16_f32 v73, v26, v27
    v_cvt_pk_bf16_f32 v74, v28, v29
    v_cvt_pk_bf16_f32 v75, v30, v31
    v_exp_f32 v32, v32
    v_exp_f32 v33, v33
    s_waitcnt lgkmcnt(0)
    v_mfma_f32_32x32x16_bf16 v[56:71], v[88:91], v[72:75], v[56:71]
    ds_read_b128 v[96:99], v105 offset:31920
    ds_read_b128 v[100:103], v111 offset:31920
    v_exp_f32 v34, v34
    v_exp_f32 v35, v35
    v_exp_f32 v36, v36
    v_exp_f32 v37, v37
    v_exp_f32 v38, v38
    v_exp_f32 v39, v39
    v_cvt_pk_bf16_f32 v76, v32, v33
    v_cvt_pk_bf16_f32 v77, v34, v35
    v_cvt_pk_bf16_f32 v78, v36, v37
    v_cvt_pk_bf16_f32 v79, v38, v39
    v_mfma_f32_32x32x16_bf16 v[24:39], v[80:83], v[124:127], v[8:23]
    ds_read_b128 v[84:87], v104 offset:36176
    v_exp_f32 v40, v40
    v_exp_f32 v41, v41
    v_exp_f32 v42, v42
    v_exp_f32 v43, v43
    v_exp_f32 v44, v44
    v_exp_f32 v45, v45
    v_mfma_f32_32x32x16_bf16 v[56:71], v[92:95], v[76:79], v[56:71]
    buffer_load_dwordx4 v[212:215], v112, s[8:11], s45 offen offset:1024
    v_exp_f32 v46, v46
    v_exp_f32 v47, v47
    v_cvt_pk_bf16_f32 v72, v40, v41
    v_cvt_pk_bf16_f32 v73, v42, v43
    v_cvt_pk_bf16_f32 v74, v44, v45
    v_cvt_pk_bf16_f32 v75, v46, v47
    v_exp_f32 v48, v48
    v_exp_f32 v49, v49
    s_waitcnt lgkmcnt(0)
    v_mfma_f32_32x32x16_bf16 v[56:71], v[96:99], v[72:75], v[56:71]
    ds_read_b128 v[88:91], v105 offset:34048
    ds_read_b128 v[92:95], v111 offset:34048
    v_exp_f32 v50, v50
    v_exp_f32 v51, v51
    v_exp_f32 v52, v52
    v_exp_f32 v53, v53
    v_exp_f32 v54, v54
    v_exp_f32 v55, v55
    v_cvt_pk_bf16_f32 v76, v48, v49
    v_cvt_pk_bf16_f32 v77, v50, v51
    v_cvt_pk_bf16_f32 v78, v52, v53
    v_cvt_pk_bf16_f32 v79, v54, v55
    v_mfma_f32_32x32x16_bf16 v[40:55], v[84:87], v[124:127], v[8:23]
    ds_read_b128 v[80:83], v104 offset:38304
    v_exp_f32 v24, v24
    v_exp_f32 v25, v25
    v_exp_f32 v26, v26
    v_exp_f32 v27, v27
    v_exp_f32 v28, v28
    v_exp_f32 v29, v29
    v_mfma_f32_32x32x16_bf16 v[56:71], v[100:103], v[76:79], v[56:71]
    buffer_load_dwordx4 v[216:219], v112, s[8:11], s45 offen offset:2048
    v_exp_f32 v30, v30
    v_exp_f32 v31, v31
    v_cvt_pk_bf16_f32 v72, v24, v25
    v_cvt_pk_bf16_f32 v73, v26, v27
    v_cvt_pk_bf16_f32 v74, v28, v29
    v_cvt_pk_bf16_f32 v75, v30, v31
    v_exp_f32 v32, v32
    v_exp_f32 v33, v33
    s_waitcnt lgkmcnt(0)
    v_mfma_f32_32x32x16_bf16 v[56:71], v[88:91], v[72:75], v[56:71]
    ds_read_b128 v[96:99], v105 offset:36176
    ds_read_b128 v[100:103], v111 offset:36176
    v_exp_f32 v34, v34
    v_exp_f32 v35, v35
    v_exp_f32 v36, v36
    v_exp_f32 v37, v37
    v_exp_f32 v38, v38
    v_exp_f32 v39, v39
    v_cvt_pk_bf16_f32 v76, v32, v33
    v_cvt_pk_bf16_f32 v77, v34, v35
    v_cvt_pk_bf16_f32 v78, v36, v37
    v_cvt_pk_bf16_f32 v79, v38, v39
    v_mfma_f32_32x32x16_bf16 v[24:39], v[80:83], v[124:127], v[8:23]
    ds_read_b128 v[84:87], v104 offset:40432
    v_exp_f32 v40, v40
    v_exp_f32 v41, v41
    v_exp_f32 v42, v42
    v_exp_f32 v43, v43
    v_exp_f32 v44, v44
    v_exp_f32 v45, v45
    v_mfma_f32_32x32x16_bf16 v[56:71], v[92:95], v[76:79], v[56:71]
    v_exp_f32 v46, v46
    v_exp_f32 v47, v47
    v_cvt_pk_bf16_f32 v72, v40, v41
    v_cvt_pk_bf16_f32 v73, v42, v43
    v_cvt_pk_bf16_f32 v74, v44, v45
    v_cvt_pk_bf16_f32 v75, v46, v47
    v_exp_f32 v48, v48
    v_exp_f32 v49, v49
    s_waitcnt lgkmcnt(0)
    v_mfma_f32_32x32x16_bf16 v[56:71], v[96:99], v[72:75], v[56:71]
    ds_read_b128 v[88:91], v105 offset:38304
    ds_read_b128 v[92:95], v111 offset:38304
    v_exp_f32 v50, v50
    v_exp_f32 v51, v51
    v_exp_f32 v52, v52
    v_exp_f32 v53, v53
    v_exp_f32 v54, v54
    v_exp_f32 v55, v55
    v_cvt_pk_bf16_f32 v76, v48, v49
    v_cvt_pk_bf16_f32 v77, v50, v51
    v_cvt_pk_bf16_f32 v78, v52, v53
    v_cvt_pk_bf16_f32 v79, v54, v55
    v_mfma_f32_32x32x16_bf16 v[40:55], v[84:87], v[124:127], v[8:23]
    ds_read_b128 v[80:83], v104 offset:42560
    v_exp_f32 v24, v24
    v_exp_f32 v25, v25
    v_exp_f32 v26, v26
    v_exp_f32 v27, v27
    v_exp_f32 v28, v28
    v_exp_f32 v29, v29
    v_mfma_f32_32x32x16_bf16 v[56:71], v[100:103], v[76:79], v[56:71]
    buffer_load_dwordx4 v[220:223], v112, s[8:11], s45 offen offset:3072
    v_exp_f32 v30, v30
    v_exp_f32 v31, v31
    v_cvt_pk_bf16_f32 v72, v24, v25
    v_cvt_pk_bf16_f32 v73, v26, v27
    v_cvt_pk_bf16_f32 v74, v28, v29
    v_cvt_pk_bf16_f32 v75, v30, v31
    v_exp_f32 v32, v32
    v_exp_f32 v33, v33
    s_waitcnt lgkmcnt(0)
    v_mfma_f32_32x32x16_bf16 v[56:71], v[88:91], v[72:75], v[56:71]
    ds_read_b128 v[96:99], v105 offset:40432
    ds_read_b128 v[100:103], v111 offset:40432
    v_exp_f32 v34, v34
    v_exp_f32 v35, v35
    v_exp_f32 v36, v36
    v_exp_f32 v37, v37
    v_exp_f32 v38, v38
    v_exp_f32 v39, v39
    v_cvt_pk_bf16_f32 v76, v32, v33
    v_cvt_pk_bf16_f32 v77, v34, v35
    v_cvt_pk_bf16_f32 v78, v36, v37
    v_cvt_pk_bf16_f32 v79, v38, v39
    v_mfma_f32_32x32x16_bf16 v[24:39], v[80:83], v[124:127], v[8:23]
    ds_read_b128 v[84:87], v104 offset:44688
    v_exp_f32 v40, v40
    v_exp_f32 v41, v41
    v_exp_f32 v42, v42
    v_exp_f32 v43, v43
    v_exp_f32 v44, v44
    v_exp_f32 v45, v45
    v_mfma_f32_32x32x16_bf16 v[56:71], v[92:95], v[76:79], v[56:71]
    buffer_load_dwordx4 v[224:227], v116, s[8:11], 0 offen offset:0
    v_exp_f32 v46, v46
    v_exp_f32 v47, v47
    v_cvt_pk_bf16_f32 v72, v40, v41
    v_cvt_pk_bf16_f32 v73, v42, v43
    v_cvt_pk_bf16_f32 v74, v44, v45
    v_cvt_pk_bf16_f32 v75, v46, v47
    v_exp_f32 v48, v48
    v_exp_f32 v49, v49
    s_waitcnt lgkmcnt(0)
    v_mfma_f32_32x32x16_bf16 v[56:71], v[96:99], v[72:75], v[56:71]
    ds_read_b128 v[88:91], v105 offset:42560
    ds_read_b128 v[92:95], v111 offset:42560
    v_exp_f32 v50, v50
    v_exp_f32 v51, v51
    v_exp_f32 v52, v52
    v_exp_f32 v53, v53
    v_exp_f32 v54, v54
    v_exp_f32 v55, v55
    v_cvt_pk_bf16_f32 v76, v48, v49
    v_cvt_pk_bf16_f32 v77, v50, v51
    v_cvt_pk_bf16_f32 v78, v52, v53
    v_cvt_pk_bf16_f32 v79, v54, v55
    v_mfma_f32_32x32x16_bf16 v[40:55], v[84:87], v[124:127], v[8:23]
    ds_read_b128 v[80:83], v104 offset:46816
    v_exp_f32 v24, v24
    v_exp_f32 v25, v25
    v_exp_f32 v26, v26
    v_exp_f32 v27, v27
    v_exp_f32 v28, v28
    v_exp_f32 v29, v29
    v_mfma_f32_32x32x16_bf16 v[56:71], v[100:103], v[76:79], v[56:71]
    v_exp_f32 v30, v30
    v_exp_f32 v31, v31
    v_cvt_pk_bf16_f32 v72, v24, v25
    v_cvt_pk_bf16_f32 v73, v26, v27
    v_cvt_pk_bf16_f32 v74, v28, v29
    v_cvt_pk_bf16_f32 v75, v30, v31
    v_exp_f32 v32, v32
    v_exp_f32 v33, v33
    s_waitcnt lgkmcnt(0)
    v_mfma_f32_32x32x16_bf16 v[56:71], v[88:91], v[72:75], v[56:71]
    ds_read_b128 v[96:99], v105 offset:44688
    ds_read_b128 v[100:103], v111 offset:44688
    v_exp_f32 v34, v34
    v_exp_f32 v35, v35
    v_exp_f32 v36, v36
    v_exp_f32 v37, v37
    v_exp_f32 v38, v38
    v_exp_f32 v39, v39
    v_cvt_pk_bf16_f32 v76, v32, v33
    v_cvt_pk_bf16_f32 v77, v34, v35
    v_cvt_pk_bf16_f32 v78, v36, v37
    v_cvt_pk_bf16_f32 v79, v38, v39
    v_mfma_f32_32x32x16_bf16 v[24:39], v[80:83], v[124:127], v[8:23]
    ds_read_b128 v[84:87], v104 offset:48944
    v_exp_f32 v40, v40
    v_exp_f32 v41, v41
    v_exp_f32 v42, v42
    v_exp_f32 v43, v43
    v_exp_f32 v44, v44
    v_exp_f32 v45, v45
    v_mfma_f32_32x32x16_bf16 v[56:71], v[92:95], v[76:79], v[56:71]
    buffer_load_dwordx4 v[228:231], v116, s[8:11], 0 offen offset:1024
    v_exp_f32 v46, v46
    v_exp_f32 v47, v47
    v_cvt_pk_bf16_f32 v72, v40, v41
    v_cvt_pk_bf16_f32 v73, v42, v43
    v_cvt_pk_bf16_f32 v74, v44, v45
    v_cvt_pk_bf16_f32 v75, v46, v47
    v_exp_f32 v48, v48
    v_exp_f32 v49, v49
    s_waitcnt lgkmcnt(0)
    v_mfma_f32_32x32x16_bf16 v[56:71], v[96:99], v[72:75], v[56:71]
    ds_read_b128 v[88:91], v105 offset:46816
    ds_read_b128 v[92:95], v111 offset:46816
    v_exp_f32 v50, v50
    v_exp_f32 v51, v51
    v_exp_f32 v52, v52
    v_exp_f32 v53, v53
    v_exp_f32 v54, v54
    v_exp_f32 v55, v55
    v_cvt_pk_bf16_f32 v76, v48, v49
    v_cvt_pk_bf16_f32 v77, v50, v51
    v_cvt_pk_bf16_f32 v78, v52, v53
    v_cvt_pk_bf16_f32 v79, v54, v55
    s_setprio 1
    v_mfma_f32_32x32x16_bf16 v[40:55], v[84:87], v[124:127], v[8:23]
    ds_read_b128 v[80:83], v104 offset:51072
    v_exp_f32 v24, v24
    v_exp_f32 v25, v25
    v_exp_f32 v26, v26
    v_exp_f32 v27, v27
    v_exp_f32 v28, v28
    v_exp_f32 v29, v29
    v_mfma_f32_32x32x16_bf16 v[56:71], v[100:103], v[76:79], v[56:71]
    buffer_load_dwordx4 v[232:235], v116, s[8:11], s41 offen offset:0
    v_exp_f32 v30, v30
    v_exp_f32 v31, v31
    v_cvt_pk_bf16_f32 v72, v24, v25
    v_cvt_pk_bf16_f32 v73, v26, v27
    v_cvt_pk_bf16_f32 v74, v28, v29
    v_cvt_pk_bf16_f32 v75, v30, v31
    v_exp_f32 v32, v32
    v_exp_f32 v33, v33
    s_waitcnt lgkmcnt(0)
    v_mfma_f32_32x32x16_bf16 v[56:71], v[88:91], v[72:75], v[56:71]
    ds_read_b128 v[96:99], v105 offset:48944
    ds_read_b128 v[100:103], v111 offset:48944
    v_exp_f32 v34, v34
    v_exp_f32 v35, v35
    v_exp_f32 v36, v36
    v_exp_f32 v37, v37
    v_exp_f32 v38, v38
    v_exp_f32 v39, v39
    v_cvt_pk_bf16_f32 v76, v32, v33
    v_cvt_pk_bf16_f32 v77, v34, v35
    v_cvt_pk_bf16_f32 v78, v36, v37
    v_cvt_pk_bf16_f32 v79, v38, v39
    v_mfma_f32_32x32x16_bf16 v[24:39], v[80:83], v[124:127], v[8:23]
    ds_read_b128 v[84:87], v104 offset:53200
    v_exp_f32 v40, v40
    v_exp_f32 v41, v41
    v_exp_f32 v42, v42
    v_exp_f32 v43, v43
    v_exp_f32 v44, v44
    v_exp_f32 v45, v45
    v_mfma_f32_32x32x16_bf16 v[56:71], v[92:95], v[76:79], v[56:71]
    v_exp_f32 v46, v46
    v_exp_f32 v47, v47
    v_cvt_pk_bf16_f32 v72, v40, v41
    v_cvt_pk_bf16_f32 v73, v42, v43
    v_cvt_pk_bf16_f32 v74, v44, v45
    v_cvt_pk_bf16_f32 v75, v46, v47
    v_exp_f32 v48, v48
    v_exp_f32 v49, v49
    s_waitcnt lgkmcnt(0)
    v_mfma_f32_32x32x16_bf16 v[56:71], v[96:99], v[72:75], v[56:71]
    ds_read_b128 v[88:91], v105 offset:51072
    ds_read_b128 v[92:95], v111 offset:51072
    v_exp_f32 v50, v50
    v_exp_f32 v51, v51
    v_exp_f32 v52, v52
    v_exp_f32 v53, v53
    v_exp_f32 v54, v54
    v_exp_f32 v55, v55
    v_cvt_pk_bf16_f32 v76, v48, v49
    v_cvt_pk_bf16_f32 v77, v50, v51
    v_cvt_pk_bf16_f32 v78, v52, v53
    v_cvt_pk_bf16_f32 v79, v54, v55
    v_add_u32 v104, 51072, v104
    v_add_u32 v105, 51072, v105
    v_add_u32 v111, 51072, v111
    v_mfma_f32_32x32x16_bf16 v[40:55], v[84:87], v[124:127], v[8:23]
    ds_read_b128 v[80:83], v104 offset:4256
    v_exp_f32 v24, v24
    v_exp_f32 v25, v25
    v_exp_f32 v26, v26
    v_exp_f32 v27, v27
    v_exp_f32 v28, v28
    v_exp_f32 v29, v29
    v_mfma_f32_32x32x16_bf16 v[56:71], v[100:103], v[76:79], v[56:71]
    buffer_load_dwordx4 v[236:239], v116, s[8:11], s41 offen offset:1024
    v_exp_f32 v30, v30
    v_exp_f32 v31, v31
    v_cvt_pk_bf16_f32 v72, v24, v25
    v_cvt_pk_bf16_f32 v73, v26, v27
    v_cvt_pk_bf16_f32 v74, v28, v29
    v_cvt_pk_bf16_f32 v75, v30, v31
    v_exp_f32 v32, v32
    v_exp_f32 v33, v33
    s_waitcnt lgkmcnt(0)
    v_mfma_f32_32x32x16_bf16 v[56:71], v[88:91], v[72:75], v[56:71]
    ds_read_b128 v[96:99], v105 offset:2128
    ds_read_b128 v[100:103], v111 offset:2128
    v_exp_f32 v34, v34
    v_exp_f32 v35, v35
    v_exp_f32 v36, v36
    v_exp_f32 v37, v37
    v_exp_f32 v38, v38
    v_exp_f32 v39, v39
    v_cvt_pk_bf16_f32 v76, v32, v33
    v_cvt_pk_bf16_f32 v77, v34, v35
    v_cvt_pk_bf16_f32 v78, v36, v37
    v_cvt_pk_bf16_f32 v79, v38, v39
    v_mfma_f32_32x32x16_bf16 v[24:39], v[80:83], v[124:127], v[8:23]
    ds_read_b128 v[84:87], v104 offset:6384
    v_exp_f32 v40, v40
    v_exp_f32 v41, v41
    v_exp_f32 v42, v42
    v_exp_f32 v43, v43
    v_exp_f32 v44, v44
    v_exp_f32 v45, v45
    v_mfma_f32_32x32x16_bf16 v[56:71], v[92:95], v[76:79], v[56:71]
    buffer_load_dwordx4 v[240:243], v116, s[8:11], s42 offen offset:0
    v_exp_f32 v46, v46
    v_exp_f32 v47, v47
    v_cvt_pk_bf16_f32 v72, v40, v41
    v_cvt_pk_bf16_f32 v73, v42, v43
    v_cvt_pk_bf16_f32 v74, v44, v45
    v_cvt_pk_bf16_f32 v75, v46, v47
    v_exp_f32 v48, v48
    v_exp_f32 v49, v49
    s_waitcnt lgkmcnt(0)
    v_mfma_f32_32x32x16_bf16 v[56:71], v[96:99], v[72:75], v[56:71]
    ds_read_b128 v[88:91], v105 offset:4256
    ds_read_b128 v[92:95], v111 offset:4256
    v_exp_f32 v50, v50
    v_exp_f32 v51, v51
    v_exp_f32 v52, v52
    v_exp_f32 v53, v53
    v_exp_f32 v54, v54
    v_exp_f32 v55, v55
    v_cvt_pk_bf16_f32 v76, v48, v49
    v_cvt_pk_bf16_f32 v77, v50, v51
    v_cvt_pk_bf16_f32 v78, v52, v53
    v_cvt_pk_bf16_f32 v79, v54, v55
    v_mfma_f32_32x32x16_bf16 v[40:55], v[84:87], v[124:127], v[8:23]
    ds_read_b128 v[80:83], v104 offset:8512
    v_exp_f32 v24, v24
    v_exp_f32 v25, v25
    v_exp_f32 v26, v26
    v_exp_f32 v27, v27
    v_exp_f32 v28, v28
    v_exp_f32 v29, v29
    v_mfma_f32_32x32x16_bf16 v[56:71], v[100:103], v[76:79], v[56:71]
    v_exp_f32 v30, v30
    v_exp_f32 v31, v31
    v_cvt_pk_bf16_f32 v72, v24, v25
    v_cvt_pk_bf16_f32 v73, v26, v27
    v_cvt_pk_bf16_f32 v74, v28, v29
    v_cvt_pk_bf16_f32 v75, v30, v31
    v_exp_f32 v32, v32
    v_exp_f32 v33, v33
    s_waitcnt lgkmcnt(0)
    v_mfma_f32_32x32x16_bf16 v[56:71], v[88:91], v[72:75], v[56:71]
    ds_read_b128 v[96:99], v105 offset:6384
    ds_read_b128 v[100:103], v111 offset:6384
    v_exp_f32 v34, v34
    v_exp_f32 v35, v35
    v_exp_f32 v36, v36
    v_exp_f32 v37, v37
    v_exp_f32 v38, v38
    v_exp_f32 v39, v39
    v_cvt_pk_bf16_f32 v76, v32, v33
    v_cvt_pk_bf16_f32 v77, v34, v35
    v_cvt_pk_bf16_f32 v78, v36, v37
    v_cvt_pk_bf16_f32 v79, v38, v39
    v_mfma_f32_32x32x16_bf16 v[24:39], v[80:83], v[124:127], v[8:23]
    ds_read_b128 v[84:87], v104 offset:10640
    v_exp_f32 v40, v40
    v_exp_f32 v41, v41
    v_exp_f32 v42, v42
    v_exp_f32 v43, v43
    v_exp_f32 v44, v44
    v_exp_f32 v45, v45
    v_mfma_f32_32x32x16_bf16 v[56:71], v[92:95], v[76:79], v[56:71]
    buffer_load_dwordx4 v[244:247], v116, s[8:11], s42 offen offset:1024
    v_exp_f32 v46, v46
    v_exp_f32 v47, v47
    v_cvt_pk_bf16_f32 v72, v40, v41
    v_cvt_pk_bf16_f32 v73, v42, v43
    v_cvt_pk_bf16_f32 v74, v44, v45
    v_cvt_pk_bf16_f32 v75, v46, v47
    v_exp_f32 v48, v48
    v_exp_f32 v49, v49
    s_waitcnt lgkmcnt(0)
    v_mfma_f32_32x32x16_bf16 v[56:71], v[96:99], v[72:75], v[56:71]
    ds_read_b128 v[88:91], v105 offset:8512
    ds_read_b128 v[92:95], v111 offset:8512
    v_exp_f32 v50, v50
    v_exp_f32 v51, v51
    v_exp_f32 v52, v52
    v_exp_f32 v53, v53
    v_exp_f32 v54, v54
    v_exp_f32 v55, v55
    v_cvt_pk_bf16_f32 v76, v48, v49
    v_cvt_pk_bf16_f32 v77, v50, v51
    v_cvt_pk_bf16_f32 v78, v52, v53
    v_cvt_pk_bf16_f32 v79, v54, v55
    v_mfma_f32_32x32x16_bf16 v[40:55], v[84:87], v[124:127], v[8:23]
    ds_read_b128 v[80:83], v104 offset:12768
    v_exp_f32 v24, v24
    v_exp_f32 v25, v25
    v_exp_f32 v26, v26
    v_exp_f32 v27, v27
    v_exp_f32 v28, v28
    v_exp_f32 v29, v29
    v_mfma_f32_32x32x16_bf16 v[56:71], v[100:103], v[76:79], v[56:71]
    buffer_load_dwordx4 v[248:251], v116, s[8:11], s43 offen offset:0
    v_exp_f32 v30, v30
    v_exp_f32 v31, v31
    v_cvt_pk_bf16_f32 v72, v24, v25
    v_cvt_pk_bf16_f32 v73, v26, v27
    v_cvt_pk_bf16_f32 v74, v28, v29
    v_cvt_pk_bf16_f32 v75, v30, v31
    v_exp_f32 v32, v32
    v_exp_f32 v33, v33
    s_waitcnt lgkmcnt(0)
    v_mfma_f32_32x32x16_bf16 v[56:71], v[88:91], v[72:75], v[56:71]
    ds_read_b128 v[96:99], v105 offset:10640
    ds_read_b128 v[100:103], v111 offset:10640
    v_exp_f32 v34, v34
    v_exp_f32 v35, v35
    v_exp_f32 v36, v36
    v_exp_f32 v37, v37
    v_exp_f32 v38, v38
    v_exp_f32 v39, v39
    v_cvt_pk_bf16_f32 v76, v32, v33
    v_cvt_pk_bf16_f32 v77, v34, v35
    v_cvt_pk_bf16_f32 v78, v36, v37
    v_cvt_pk_bf16_f32 v79, v38, v39
    v_mfma_f32_32x32x16_bf16 v[24:39], v[80:83], v[124:127], v[8:23]
    ds_read_b128 v[84:87], v104 offset:14896
    v_exp_f32 v40, v40
    v_exp_f32 v41, v41
    v_exp_f32 v42, v42
    v_exp_f32 v43, v43
    v_exp_f32 v44, v44
    v_exp_f32 v45, v45
    v_mfma_f32_32x32x16_bf16 v[56:71], v[92:95], v[76:79], v[56:71]
    v_exp_f32 v46, v46
    v_exp_f32 v47, v47
    v_cvt_pk_bf16_f32 v72, v40, v41
    v_cvt_pk_bf16_f32 v73, v42, v43
    v_cvt_pk_bf16_f32 v74, v44, v45
    v_cvt_pk_bf16_f32 v75, v46, v47
    v_exp_f32 v48, v48
    v_exp_f32 v49, v49
    s_waitcnt lgkmcnt(0)
    v_mfma_f32_32x32x16_bf16 v[56:71], v[96:99], v[72:75], v[56:71]
    ds_read_b128 v[88:91], v105 offset:12768
    ds_read_b128 v[92:95], v111 offset:12768
    v_exp_f32 v50, v50
    v_exp_f32 v51, v51
    v_exp_f32 v52, v52
    v_exp_f32 v53, v53
    v_exp_f32 v54, v54
    v_exp_f32 v55, v55
    v_cvt_pk_bf16_f32 v76, v48, v49
    v_cvt_pk_bf16_f32 v77, v50, v51
    v_cvt_pk_bf16_f32 v78, v52, v53
    v_cvt_pk_bf16_f32 v79, v54, v55
    v_mfma_f32_32x32x16_bf16 v[40:55], v[84:87], v[124:127], v[8:23]
    ds_read_b128 v[80:83], v104 offset:17024
    v_exp_f32 v24, v24
    v_exp_f32 v25, v25
    v_exp_f32 v26, v26
    v_exp_f32 v27, v27
    v_exp_f32 v28, v28
    v_exp_f32 v29, v29
    v_mfma_f32_32x32x16_bf16 v[56:71], v[100:103], v[76:79], v[56:71]
    buffer_load_dwordx4 v[252:255], v116, s[8:11], s43 offen offset:1024
    v_exp_f32 v30, v30
    v_exp_f32 v31, v31
    v_cvt_pk_bf16_f32 v72, v24, v25
    v_cvt_pk_bf16_f32 v73, v26, v27
    v_cvt_pk_bf16_f32 v74, v28, v29
    v_cvt_pk_bf16_f32 v75, v30, v31
    v_exp_f32 v32, v32
    v_exp_f32 v33, v33
    s_waitcnt lgkmcnt(0)
    v_mfma_f32_32x32x16_bf16 v[56:71], v[88:91], v[72:75], v[56:71]
    ds_read_b128 v[96:99], v105 offset:14896
    ds_read_b128 v[100:103], v111 offset:14896
    v_exp_f32 v34, v34
    v_exp_f32 v35, v35
    v_exp_f32 v36, v36
    v_exp_f32 v37, v37
    v_exp_f32 v38, v38
    v_exp_f32 v39, v39
    v_cvt_pk_bf16_f32 v76, v32, v33
    v_cvt_pk_bf16_f32 v77, v34, v35
    v_cvt_pk_bf16_f32 v78, v36, v37
    v_cvt_pk_bf16_f32 v79, v38, v39
    v_mfma_f32_32x32x16_bf16 v[24:39], v[80:83], v[124:127], v[8:23]
    ds_read_b128 v[84:87], v104 offset:19152
    v_exp_f32 v40, v40
    v_exp_f32 v41, v41
    v_exp_f32 v42, v42
    v_exp_f32 v43, v43
    v_exp_f32 v44, v44
    v_exp_f32 v45, v45
    v_mfma_f32_32x32x16_bf16 v[56:71], v[92:95], v[76:79], v[56:71]
    s_and_b32 s30, s18, 7
    s_lshr_b32 s31, s30, 1
    s_lshl_b32 s31, s31, 2
    s_and_b32 s30, s30, 1
    s_add_u32 s30, s30, s31
    s_lshl_b32 s30, s30, 10
    buffer_load_dwordx4 v[120:123], v116, s[8:11], s30 offen offset:2048
    v_exp_f32 v46, v46
    v_exp_f32 v47, v47
    v_cvt_pk_bf16_f32 v72, v40, v41
    v_cvt_pk_bf16_f32 v73, v42, v43
    v_cvt_pk_bf16_f32 v74, v44, v45
    v_cvt_pk_bf16_f32 v75, v46, v47
    v_exp_f32 v48, v48
    v_exp_f32 v49, v49
    s_waitcnt lgkmcnt(0)
    v_mfma_f32_32x32x16_bf16 v[56:71], v[96:99], v[72:75], v[56:71]
    ds_read_b128 v[88:91], v105 offset:17024
    ds_read_b128 v[92:95], v111 offset:17024
    v_exp_f32 v50, v50
    v_exp_f32 v51, v51
    v_exp_f32 v52, v52
    v_exp_f32 v53, v53
    v_exp_f32 v54, v54
    v_exp_f32 v55, v55
    v_cvt_pk_bf16_f32 v76, v48, v49
    v_cvt_pk_bf16_f32 v77, v50, v51
    v_cvt_pk_bf16_f32 v78, v52, v53
    v_cvt_pk_bf16_f32 v79, v54, v55
    v_mfma_f32_32x32x16_bf16 v[40:55], v[84:87], v[124:127], v[8:23]
    ds_read_b128 v[80:83], v104 offset:21280
    v_exp_f32 v24, v24
    v_exp_f32 v25, v25
    v_exp_f32 v26, v26
    v_exp_f32 v27, v27
    v_exp_f32 v28, v28
    v_exp_f32 v29, v29
    v_mfma_f32_32x32x16_bf16 v[56:71], v[100:103], v[76:79], v[56:71]
    v_exp_f32 v30, v30
    v_exp_f32 v31, v31
    v_cvt_pk_bf16_f32 v72, v24, v25
    v_cvt_pk_bf16_f32 v73, v26, v27
    v_cvt_pk_bf16_f32 v74, v28, v29
    v_cvt_pk_bf16_f32 v75, v30, v31
    v_exp_f32 v32, v32
    v_exp_f32 v33, v33
    s_waitcnt lgkmcnt(0)
    v_mfma_f32_32x32x16_bf16 v[56:71], v[88:91], v[72:75], v[56:71]
    ds_read_b128 v[96:99], v105 offset:19152
    ds_read_b128 v[100:103], v111 offset:19152
    v_exp_f32 v34, v34
    v_exp_f32 v35, v35
    v_exp_f32 v36, v36
    v_exp_f32 v37, v37
    v_exp_f32 v38, v38
    v_exp_f32 v39, v39
    v_cvt_pk_bf16_f32 v76, v32, v33
    v_cvt_pk_bf16_f32 v77, v34, v35
    v_cvt_pk_bf16_f32 v78, v36, v37
    v_cvt_pk_bf16_f32 v79, v38, v39
    v_mfma_f32_32x32x16_bf16 v[24:39], v[80:83], v[124:127], v[8:23]
    ds_read_b128 v[84:87], v104 offset:23408
    v_exp_f32 v40, v40
    v_exp_f32 v41, v41
    v_exp_f32 v42, v42
    v_exp_f32 v43, v43
    v_exp_f32 v44, v44
    v_exp_f32 v45, v45
    v_mfma_f32_32x32x16_bf16 v[56:71], v[92:95], v[76:79], v[56:71]
    v_exp_f32 v46, v46
    v_exp_f32 v47, v47
    v_cvt_pk_bf16_f32 v72, v40, v41
    v_cvt_pk_bf16_f32 v73, v42, v43
    v_cvt_pk_bf16_f32 v74, v44, v45
    v_cvt_pk_bf16_f32 v75, v46, v47
    v_exp_f32 v48, v48
    v_exp_f32 v49, v49
    s_waitcnt lgkmcnt(0)
    v_mfma_f32_32x32x16_bf16 v[56:71], v[96:99], v[72:75], v[56:71]
    ds_read_b128 v[88:91], v105 offset:21280
    ds_read_b128 v[92:95], v111 offset:21280
    v_exp_f32 v50, v50
    v_exp_f32 v51, v51
    v_exp_f32 v52, v52
    v_exp_f32 v53, v53
    v_exp_f32 v54, v54
    v_exp_f32 v55, v55
    v_cvt_pk_bf16_f32 v76, v48, v49
    v_cvt_pk_bf16_f32 v77, v50, v51
    v_cvt_pk_bf16_f32 v78, v52, v53
    v_cvt_pk_bf16_f32 v79, v54, v55
    s_setprio 0
    v_mfma_f32_32x32x16_bf16 v[40:55], v[84:87], v[124:127], v[8:23]
    ds_read_b128 v[80:83], v104 offset:25536
    v_exp_f32 v24, v24
    v_exp_f32 v25, v25
    v_exp_f32 v26, v26
    v_exp_f32 v27, v27
    v_exp_f32 v28, v28
    v_exp_f32 v29, v29
    v_mfma_f32_32x32x16_bf16 v[56:71], v[100:103], v[76:79], v[56:71]
    v_exp_f32 v30, v30
    v_exp_f32 v31, v31
    v_cvt_pk_bf16_f32 v72, v24, v25
    v_cvt_pk_bf16_f32 v73, v26, v27
    v_cvt_pk_bf16_f32 v74, v28, v29
    v_cvt_pk_bf16_f32 v75, v30, v31
    v_exp_f32 v32, v32
    v_exp_f32 v33, v33
    s_waitcnt lgkmcnt(0)
    v_mfma_f32_32x32x16_bf16 v[56:71], v[88:91], v[72:75], v[56:71]
    ds_read_b128 v[96:99], v105 offset:23408
    ds_read_b128 v[100:103], v111 offset:23408
    v_exp_f32 v34, v34
    v_exp_f32 v35, v35
    v_exp_f32 v36, v36
    v_exp_f32 v37, v37
    v_exp_f32 v38, v38
    v_exp_f32 v39, v39
    v_cvt_pk_bf16_f32 v76, v32, v33
    v_cvt_pk_bf16_f32 v77, v34, v35
    v_cvt_pk_bf16_f32 v78, v36, v37
    v_cvt_pk_bf16_f32 v79, v38, v39
    v_mfma_f32_32x32x16_bf16 v[24:39], v[80:83], v[124:127], v[8:23]
    ds_read_b128 v[84:87], v104 offset:27664
    v_exp_f32 v40, v40
    v_exp_f32 v41, v41
    v_exp_f32 v42, v42
    v_exp_f32 v43, v43
    v_exp_f32 v44, v44
    v_exp_f32 v45, v45
    v_mfma_f32_32x32x16_bf16 v[56:71], v[92:95], v[76:79], v[56:71]
    v_exp_f32 v46, v46
    v_exp_f32 v47, v47
    v_cvt_pk_bf16_f32 v72, v40, v41
    v_cvt_pk_bf16_f32 v73, v42, v43
    v_cvt_pk_bf16_f32 v74, v44, v45
    v_cvt_pk_bf16_f32 v75, v46, v47
    v_exp_f32 v48, v48
    v_exp_f32 v49, v49
    s_waitcnt lgkmcnt(0)
    v_mfma_f32_32x32x16_bf16 v[56:71], v[96:99], v[72:75], v[56:71]
    ds_read_b128 v[88:91], v105 offset:25536
    ds_read_b128 v[92:95], v111 offset:25536
    v_exp_f32 v50, v50
    v_exp_f32 v51, v51
    v_exp_f32 v52, v52
    v_exp_f32 v53, v53
    v_exp_f32 v54, v54
    v_exp_f32 v55, v55
    v_cvt_pk_bf16_f32 v76, v48, v49
    v_cvt_pk_bf16_f32 v77, v50, v51
    v_cvt_pk_bf16_f32 v78, v52, v53
    v_cvt_pk_bf16_f32 v79, v54, v55
    v_mfma_f32_32x32x16_bf16 v[40:55], v[84:87], v[124:127], v[8:23]
    ds_read_b128 v[80:83], v104 offset:29792
    v_exp_f32 v24, v24
    v_exp_f32 v25, v25
    v_exp_f32 v26, v26
    v_exp_f32 v27, v27
    v_exp_f32 v28, v28
    v_exp_f32 v29, v29
    v_mfma_f32_32x32x16_bf16 v[56:71], v[100:103], v[76:79], v[56:71]
    v_exp_f32 v30, v30
    v_exp_f32 v31, v31
    v_cvt_pk_bf16_f32 v72, v24, v25
    v_cvt_pk_bf16_f32 v73, v26, v27
    v_cvt_pk_bf16_f32 v74, v28, v29
    v_cvt_pk_bf16_f32 v75, v30, v31
    v_exp_f32 v32, v32
    v_exp_f32 v33, v33
    s_waitcnt lgkmcnt(0)
    v_mfma_f32_32x32x16_bf16 v[56:71], v[88:91], v[72:75], v[56:71]
    ds_read_b128 v[96:99], v105 offset:27664
    ds_read_b128 v[100:103], v111 offset:27664
    v_exp_f32 v34, v34
    v_exp_f32 v35, v35
    v_exp_f32 v36, v36
    v_exp_f32 v37, v37
    v_exp_f32 v38, v38
    v_exp_f32 v39, v39
    v_cvt_pk_bf16_f32 v76, v32, v33
    v_cvt_pk_bf16_f32 v77, v34, v35
    v_cvt_pk_bf16_f32 v78, v36, v37
    v_cvt_pk_bf16_f32 v79, v38, v39
    v_mfma_f32_32x32x16_bf16 v[24:39], v[80:83], v[124:127], v[8:23]
    ds_read_b128 v[84:87], v104 offset:31920
    v_exp_f32 v40, v40
    v_exp_f32 v41, v41
    v_exp_f32 v42, v42
    v_exp_f32 v43, v43
    v_exp_f32 v44, v44
    v_exp_f32 v45, v45
    v_mfma_f32_32x32x16_bf16 v[56:71], v[92:95], v[76:79], v[56:71]
    v_exp_f32 v46, v46
    v_exp_f32 v47, v47
    v_cvt_pk_bf16_f32 v72, v40, v41
    v_cvt_pk_bf16_f32 v73, v42, v43
    v_cvt_pk_bf16_f32 v74, v44, v45
    v_cvt_pk_bf16_f32 v75, v46, v47
    v_exp_f32 v48, v48
    v_exp_f32 v49, v49
    s_waitcnt lgkmcnt(0)
    v_mfma_f32_32x32x16_bf16 v[56:71], v[96:99], v[72:75], v[56:71]
    ds_read_b128 v[88:91], v105 offset:29792
    ds_read_b128 v[92:95], v111 offset:29792
    v_exp_f32 v50, v50
    v_exp_f32 v51, v51
    v_exp_f32 v52, v52
    v_exp_f32 v53, v53
    v_exp_f32 v54, v54
    v_exp_f32 v55, v55
    v_cvt_pk_bf16_f32 v76, v48, v49
    v_cvt_pk_bf16_f32 v77, v50, v51
    v_cvt_pk_bf16_f32 v78, v52, v53
    v_cvt_pk_bf16_f32 v79, v54, v55
    v_mfma_f32_32x32x16_bf16 v[40:55], v[84:87], v[124:127], v[8:23]
    ds_read_b128 v[80:83], v104 offset:34048
    v_exp_f32 v24, v24
    v_exp_f32 v25, v25
    v_exp_f32 v26, v26
    v_exp_f32 v27, v27
    v_exp_f32 v28, v28
    v_exp_f32 v29, v29
    v_mfma_f32_32x32x16_bf16 v[56:71], v[100:103], v[76:79], v[56:71]
    v_exp_f32 v30, v30
    v_exp_f32 v31, v31
    v_cvt_pk_bf16_f32 v72, v24, v25
    v_cvt_pk_bf16_f32 v73, v26, v27
    v_cvt_pk_bf16_f32 v74, v28, v29
    v_cvt_pk_bf16_f32 v75, v30, v31
    v_exp_f32 v32, v32
    v_exp_f32 v33, v33
    s_waitcnt lgkmcnt(0)
    v_mfma_f32_32x32x16_bf16 v[56:71], v[88:91], v[72:75], v[56:71]
    ds_read_b128 v[96:99], v105 offset:31920
    ds_read_b128 v[100:103], v111 offset:31920
    v_exp_f32 v34, v34
    v_exp_f32 v35, v35
    v_exp_f32 v36, v36
    v_exp_f32 v37, v37
    v_exp_f32 v38, v38
    v_exp_f32 v39, v39
    v_cvt_pk_bf16_f32 v76, v32, v33
    v_cvt_pk_bf16_f32 v77, v34, v35
    v_cvt_pk_bf16_f32 v78, v36, v37
    v_cvt_pk_bf16_f32 v79, v38, v39
    v_mfma_f32_32x32x16_bf16 v[24:39], v[80:83], v[124:127], v[8:23]
    ds_read_b128 v[84:87], v104 offset:36176
    v_exp_f32 v40, v40
    v_exp_f32 v41, v41
    v_exp_f32 v42, v42
    v_exp_f32 v43, v43
    v_exp_f32 v44, v44
    v_exp_f32 v45, v45
    v_mfma_f32_32x32x16_bf16 v[56:71], v[92:95], v[76:79], v[56:71]
    v_exp_f32 v46, v46
    v_exp_f32 v47, v47
    v_cvt_pk_bf16_f32 v72, v40, v41
    v_cvt_pk_bf16_f32 v73, v42, v43
    v_cvt_pk_bf16_f32 v74, v44, v45
    v_cvt_pk_bf16_f32 v75, v46, v47
    v_exp_f32 v48, v48
    v_exp_f32 v49, v49
    s_waitcnt lgkmcnt(0)
    v_mfma_f32_32x32x16_bf16 v[56:71], v[96:99], v[72:75], v[56:71]
    ds_read_b128 v[88:91], v105 offset:34048
    ds_read_b128 v[92:95], v111 offset:34048
    v_exp_f32 v50, v50
    v_exp_f32 v51, v51
    v_exp_f32 v52, v52
    v_exp_f32 v53, v53
    v_exp_f32 v54, v54
    v_exp_f32 v55, v55
    v_cvt_pk_bf16_f32 v76, v48, v49
    v_cvt_pk_bf16_f32 v77, v50, v51
    v_cvt_pk_bf16_f32 v78, v52, v53
    v_cvt_pk_bf16_f32 v79, v54, v55
    v_add_u32 v104, 34048, v104
    v_add_u32 v105, 34048, v105
    v_add_u32 v111, 34048, v111
    v_mfma_f32_32x32x16_bf16 v[56:71], v[100:103], v[76:79], v[56:71]
    s_mov_b32 s39, 0
    s_waitcnt lgkmcnt(0)
    s_nop 10
l1_fin:
    v_mov_b32 v106, v64
    v_mov_b32 v107, v64
    v_mul_f32 v108, 0, v56
    v_fma_f32 v108, v57, 0, v108
    v_permlane32_swap_b32 v106, v107
    v_fma_f32 v108, v58, 0, v108
    v_fma_f32 v108, v59, 0, v108
    v_fma_f32 v108, v60, 0, v108
    v_fma_f32 v108, v61, 0, v108
    v_fma_f32 v108, v62, 0, v108
    v_fma_f32 v108, v63, 0, v108
    v_add_f32 v108, v108, v106
    v_mov_b32 v109, 0x4e800000
    v_cmp_nle_f32 vcc, v108, v109
    v_rcp_f32 v106, v106
    s_cmp_eq_u32 s39, 99
    s_cbranch_scc1 l1_store
    s_cbranch_vccnz l1_slow
l1_store:
    v_mul_f32 v56, v106, v56
    v_mul_f32 v57, v106, v57
    v_mul_f32 v58, v106, v58
    v_mul_f32 v59, v106, v59
    v_mul_f32 v60, v106, v60
    v_mul_f32 v61, v106, v61
    v_mul_f32 v62, v106, v62
    v_mul_f32 v63, v106, v63
    v_cvt_pk_bf16_f32 v72, v56, v57
    v_cvt_pk_bf16_f32 v73, v58, v59
    v_cvt_pk_bf16_f32 v74, v60, v61
    v_cvt_pk_bf16_f32 v75, v62, v63
    buffer_store_dwordx4 v[72:75], v3, s[8:11], s36 offen sc0 sc1
    s_nop 1
    buffer_load_dwordx4 v[64:67], v116, s[8:11], 0 offen offset:2048
    buffer_load_dwordx4 v[68:71], v116, s[8:11], 0 offen offset:3072
    buffer_load_dwordx4 v[72:75], v116, s[8:11], s41 offen offset:2048
    buffer_load_dwordx4 v[76:79], v116, s[8:11], s41 offen offset:3072
    buffer_load_dwordx4 v[80:83], v116, s[8:11], s42 offen offset:2048
    buffer_load_dwordx4 v[84:87], v116, s[8:11], s42 offen offset:3072
    buffer_load_dwordx4 v[88:91], v116, s[8:11], s43 offen offset:2048
    buffer_load_dwordx4 v[92:95], v116, s[8:11], s43 offen offset:3072
    s_lshl_b32 s30, s18, 15
    s_lshl_b32 s48, s20, 12
    s_add_u32 s30, s30, s48
    s_add_u32 s30, s30, 28729344
    v_add_u32 v5, s30, v3
    s_lshl_b32 s30, s26, 14
    s_add_u32 s30, s30, 36864
    v_add_u32 v6, s30, v3
    v_add_u32 v14, s48, v3
    s_add_u32 s48, s48, 36864
    s_lshl_b32 s30, s20, 11
    s_add_u32 s30, s30, 81920
    v_add_u32 v8, s30, v3
    v_xor_b32 v7, 0x2000, v8
    s_add_u32 s31, s19, 22487040
    buffer_load_dwordx4 v[96:99], v3, s[8:11], s31 offen
    s_lshr_b32 s30, s20, 1
    s_lshl_b32 s30, s30, 2
    s_and_b32 s31, s22, 3
    s_add_u32 s30, s30, s31
    s_lshl_b32 s32, 1, s30
    s_mov_b32 s33, 0
    v_lshlrev_b32 v0, 2, v1
    s_lshl_b32 s30, s21, 8
    s_add_u32 s30, s30, 24756224
    s_lshl_b32 s34, s22, 2
    s_add_u32 s34, s34, s30
    v_mov_b32 v4, 1
    s_waitcnt vmcnt(9) lgkmcnt(0)
    s_cmp_lg_u32 s20, 0
    s_barrier
    s_cbranch_scc1 l1_sig74
    s_mov_b64 exec, 1
    buffer_store_dword v4, v0, s[8:11], s34 offen
l1_sig74:
    s_mov_b32 s31, 0
    s_mov_b64 exec, s[32:33]
l1_pa71:
    buffer_load_dword v2, v0, s[8:11], s30 offen sc1
    s_add_u32 s31, s31, 1
    s_waitcnt vmcnt(0)
    v_cmp_ne_u32 vcc, 0, v2
    s_cmp_eq_u64 vcc, s[32:33]
    s_cbranch_scc1 l1_pd73
    s_cmp_lt_u32 s31, 64
    s_cbranch_scc1 l1_pa71
    s_mov_b64 exec, 1
    buffer_store_dword v4, v0, s[8:11], s34 offen offset:128 sc0 sc1
    s_mov_b64 exec, s[32:33]
l1_pb72:
    buffer_load_dword v2, v0, s[8:11], s30 offen sc1
    s_waitcnt vmcnt(0)
    v_cmp_ne_u32 s[36:37], 0, v2
    buffer_load_dword v2, v0, s[8:11], s30 offen offset:128 sc0 sc1
    s_waitcnt vmcnt(0)
    v_cmp_ne_u32 vcc, 0, v2
    s_add_u32 s31, s31, 1
    s_or_b64 vcc, vcc, s[36:37]
    s_cmp_eq_u64 vcc, s[32:33]
    s_cbranch_scc1 l1_pd73
    s_sleep 4
    s_cmp_lt_u32 s31, 1048576
    s_cbranch_scc1 l1_pb72
    s_branch k_end
l1_pd73:
    s_mov_b64 exec, -1
    s_mov_b32 m0, s48
    s_nop 0
    buffer_load_dwordx4 v5, s[8:11], 0 offen offset:0 lds
    buffer_load_dwordx4 v5, s[8:11], 0 offen offset:1024 lds
    buffer_load_dwordx4 v5, s[8:11], 0 offen offset:2048 lds
    buffer_load_dwordx4 v5, s[8:11], 0 offen offset:3072 lds
    s_waitcnt vmcnt(2)
    s_barrier
    ds_read_b128 v[32:35], v6 offset:0
    ds_read_b128 v[36:39], v6 offset:1024
    ds_read_b128 v[40:43], v6 offset:4096
    ds_read_b128 v[44:47], v6 offset:5120
    ds_read_b128 v[48:51], v6 offset:8192
    ds_read_b128 v[52:55], v6 offset:9216
    ds_read_b128 v[56:59], v6 offset:12288
    ds_read_b128 v[60:63], v6 offset:13312
    s_waitcnt lgkmcnt(7)
    v_mfma_f32_32x32x16_bf16 v[16:31], v[224:227], v[32:35], 0
    s_waitcnt lgkmcnt(6)
    v_mfma_f32_32x32x16_bf16 v[16:31], v[228:231], v[36:39], v[16:31]
    s_waitcnt lgkmcnt(5)
    v_mfma_f32_32x32x16_bf16 v[16:31], v[232:235], v[40:43], v[16:31]
    s_waitcnt lgkmcnt(4)
    v_mfma_f32_32x32x16_bf16 v[16:31], v[236:239], v[44:47], v[16:31]
    s_waitcnt vmcnt(0)
    s_barrier
    ds_read_b128 v[32:35], v6 offset:2048
    ds_read_b128 v[36:39], v6 offset:3072
    ds_read_b128 v[40:43], v6 offset:6144
    ds_read_b128 v[44:47], v6 offset:7168
    s_waitcnt lgkmcnt(7)
    v_mfma_f32_32x32x16_bf16 v[16:31], v[240:243], v[48:51], v[16:31]
    ds_read_b128 v[48:51], v6 offset:10240
    s_waitcnt lgkmcnt(7)
    v_mfma_f32_32x32x16_bf16 v[16:31], v[244:247], v[52:55], v[16:31]
    ds_read_b128 v[52:55], v6 offset:11264
    s_waitcnt lgkmcnt(7)
    v_mfma_f32_32x32x16_bf16 v[16:31], v[248:251], v[56:59], v[16:31]
    ds_read_b128 v[56:59], v6 offset:14336
    s_waitcnt lgkmcnt(7)
    v_mfma_f32_32x32x16_bf16 v[16:31], v[252:255], v[60:63], v[16:31]
    ds_read_b128 v[60:63], v6 offset:15360
    s_cmp_lg_u32 s20, 0
    s_cbranch_scc1 l1_fb77
    s_mov_b64 exec, 1
    buffer_store_dword v4, v0, s[8:11], s34 offen offset:128 sc0 sc1
    s_mov_b64 exec, -1
l1_fb77:
    s_waitcnt lgkmcnt(7)
    v_mfma_f32_32x32x16_bf16 v[16:31], v[64:67], v[32:35], v[16:31]
    buffer_load_dwordx4 v[224:227], v112, s[8:11], s46 offen offset:0
    s_waitcnt lgkmcnt(6)
    v_mfma_f32_32x32x16_bf16 v[16:31], v[68:71], v[36:39], v[16:31]
    buffer_load_dwordx4 v[228:231], v112, s[8:11], s46 offen offset:1024
    s_waitcnt lgkmcnt(5)
    v_mfma_f32_32x32x16_bf16 v[16:31], v[72:75], v[40:43], v[16:31]
    buffer_load_dwordx4 v[232:235], v112, s[8:11], s46 offen offset:2048
    s_waitcnt lgkmcnt(4)
    v_mfma_f32_32x32x16_bf16 v[16:31], v[76:79], v[44:47], v[16:31]
    buffer_load_dwordx4 v[236:239], v112, s[8:11], s46 offen offset:3072
    s_waitcnt lgkmcnt(3)
    v_mfma_f32_32x32x16_bf16 v[16:31], v[80:83], v[48:51], v[16:31]
    buffer_load_dwordx4 v[240:243], v112, s[8:11], s47 offen offset:0
    s_waitcnt lgkmcnt(2)
    v_mfma_f32_32x32x16_bf16 v[16:31], v[84:87], v[52:55], v[16:31]
    buffer_load_dwordx4 v[244:247], v112, s[8:11], s47 offen offset:1024
    s_waitcnt lgkmcnt(1)
    v_mfma_f32_32x32x16_bf16 v[16:31], v[88:91], v[56:59], v[16:31]
    buffer_load_dwordx4 v[248:251], v112, s[8:11], s47 offen offset:2048
    s_waitcnt lgkmcnt(0)
    v_mfma_f32_32x32x16_bf16 v[16:31], v[92:95], v[60:63], v[16:31]
    buffer_load_dwordx4 v[252:255], v112, s[8:11], s47 offen offset:3072
    v_lshlrev_b32 v32, 16, v96
    v_and_b32 v33, 0xffff0000, v96
    v_lshlrev_b32 v34, 16, v97
    v_and_b32 v35, 0xffff0000, v97
    v_lshlrev_b32 v36, 16, v98
    v_and_b32 v37, 0xffff0000, v98
    v_lshlrev_b32 v38, 16, v99
    v_and_b32 v39, 0xffff0000, v99
    s_nop 3
    ds_write_b128 v7, v[24:27] offset:0
    ds_write_b128 v7, v[28:31] offset:1024
    v_add_f32 v16, v16, v32
    v_add_f32 v17, v17, v33
    v_add_f32 v18, v18, v34
    v_add_f32 v19, v19, v35
    v_add_f32 v20, v20, v36
    v_add_f32 v21, v21, v37
    v_add_f32 v22, v22, v38
    v_add_f32 v23, v23, v39
    s_waitcnt lgkmcnt(0)
    s_barrier
    ds_read_b128 v[24:27], v8 offset:0
    ds_read_b128 v[28:31], v8 offset:1024
    s_waitcnt lgkmcnt(0)
    v_add_f32 v16, v16, v24
    v_add_f32 v17, v17, v25
    v_add_f32 v18, v18, v26
    v_add_f32 v19, v19, v27
    v_add_f32 v20, v20, v28
    v_add_f32 v21, v21, v29
    v_add_f32 v22, v22, v30
    v_add_f32 v23, v23, v31
    v_cvt_pk_bf16_f32 v24, v16, v17
    v_cvt_pk_bf16_f32 v25, v18, v19
    v_cvt_pk_bf16_f32 v26, v20, v21
    v_cvt_pk_bf16_f32 v27, v22, v23
    s_add_u32 s31, s19, 30826496
    buffer_store_dwordx4 v[24:27], v3, s[8:11], s31 offen sc0 sc1
    v_mov_b32 v36, 0x3f803f80
    v_dot2_f32_bf16 v33, v24, v24, 0
    v_dot2_f32_bf16 v32, v24, v36, 0
    v_dot2_f32_bf16 v33, v25, v25, v33
    v_dot2_f32_bf16 v32, v25, v36, v32
    v_dot2_f32_bf16 v33, v26, v26, v33
    v_dot2_f32_bf16 v32, v26, v36, v32
    v_dot2_f32_bf16 v33, v27, v27, v33
    v_dot2_f32_bf16 v32, v27, v36, v32
    s_nop 2
    v_mov_b32 v34, v32
    v_mov_b32 v35, v33
    s_nop 1
    v_permlane32_swap_b32 v32, v34
    v_permlane32_swap_b32 v33, v35
    v_add_f32 v32, v32, v34
    v_add_f32 v33, v33, v35
    s_lshr_b32 s31, s19, 2
    s_add_u32 s31, s31, 32923648
    v_lshlrev_b32 v4, 3, v1
    s_mov_b32 exec_hi, 0
    buffer_store_dwordx2 v[32:33], v4, s[8:11], s31 offen sc0 sc1
    s_mov_b64 exec, -1
    v_mov_b32 v15, v113
    v_mov_b32 v9, v114
    s_lshl_b32 s30, s21, 2
    s_add_u32 s30, s30, s29
    s_lshl_b32 s30, s30, 15
    s_lshr_b32 s31, s20, 1
    s_lshl_b32 s31, s31, 11
    s_add_u32 s30, s30, s31
    s_add_u32 s30, s30, 30826496
    v_add_u32 v13, s30, v3
    v_add_u32 v14, 0x10000, v13
    s_lshl_b32 s48, s29, 15
    s_add_u32 s48, s48, s31
    v_add_u32 v7, 0x10000, v3
    v_lshrrev_b32 v11, 5, v1
    v_lshlrev_b32 v11, 4, v11
    s_min_u32 s30, s20, 6
    s_lshl_b32 s30, s30, 7
    s_add_u32 s30, s30, 135168
    v_add_u32 v10, s30, v11
    v_and_b32 v12, 31, v1
    v_lshlrev_b32 v12, 3, v12
    v_lshl_add_u32 v12, v11, 8, v12
    s_lshl_b32 s30, s21, 15
    s_add_u32 s30, s30, 32923648
    v_add_u32 v12, s30, v12
    v_add_u32 v8, 131072, v3
    s_mul_i32 s31, s20, 14336
    s_mul_i32 s30, s27, 114688
    s_add_u32 s30, s30, s31
    s_add_u32 s30, s30, 33447936
    v_add_u32 v5, s30, v3
    v_add_u32 v6, 229376, v5
    s_lshl_b32 s32, 0x5555, s29
    s_cmp_eq_u32 s20, 7
    s_cselect_b32 s32, 0xffff, s32
    s_mov_b32 s33, 0
    v_lshlrev_b32 v0, 2, v1
    s_lshl_b32 s30, s21, 8
    s_add_u32 s30, s30, 24760320
    s_lshl_b32 s34, s22, 2
    s_add_u32 s34, s34, s30
    v_mov_b32 v4, 1
    s_waitcnt vmcnt(0) lgkmcnt(0)
    s_cmp_lg_u32 s20, 0
    s_barrier
    s_cbranch_scc1 l1_sig81
    s_mov_b64 exec, 1
    buffer_store_dword v4, v0, s[8:11], s34 offen
l1_sig81:
    s_mov_b32 s31, 0
    s_mov_b64 exec, s[32:33]
l1_pa78:
    buffer_load_dword v2, v0, s[8:11], s30 offen sc1
    s_add_u32 s31, s31, 1
    s_waitcnt vmcnt(0)
    v_cmp_ne_u32 vcc, 0, v2
    s_cmp_eq_u64 vcc, s[32:33]
    s_cbranch_scc1 l1_pd80
    s_cmp_lt_u32 s31, 64
    s_cbranch_scc1 l1_pa78
    s_mov_b64 exec, 1
    buffer_store_dword v4, v0, s[8:11], s34 offen offset:128 sc0 sc1
    s_mov_b64 exec, s[32:33]
l1_pb79:
    buffer_load_dword v2, v0, s[8:11], s30 offen sc1
    s_waitcnt vmcnt(0)
    v_cmp_ne_u32 s[36:37], 0, v2
    buffer_load_dword v2, v0, s[8:11], s30 offen offset:128 sc0 sc1
    s_waitcnt vmcnt(0)
    v_cmp_ne_u32 vcc, 0, v2
    s_add_u32 s31, s31, 1
    s_or_b64 vcc, vcc, s[36:37]
    s_cmp_eq_u64 vcc, s[32:33]
    s_cbranch_scc1 l1_pd80
    s_sleep 4
    s_cmp_lt_u32 s31, 1048576
    s_cbranch_scc1 l1_pb79
    s_branch k_end
l1_pd80:
    s_mov_b64 exec, -1
    s_add_u32 m0, s48, 0
    s_nop 0
    buffer_load_dwordx4 v13, s[8:11], 0 offen offset:0 lds
    buffer_load_dwordx4 v13, s[8:11], 0 offen offset:1024 lds
    s_add_u32 m0, s48, 8192
    s_nop 0
    buffer_load_dwordx4 v13, s[8:11], s42 offen offset:0 lds
    buffer_load_dwordx4 v13, s[8:11], s42 offen offset:1024 lds
    s_cmp_eq_u32 s20, 7
    s_cbranch_scc1 l1_gs84
    s_mul_i32 s39, s21, 448
    s_add_u32 s39, s39, s40
    s_lshl_b32 s39, s39, 10
    s_add_u32 s39, s39, 33447936
    s_waitcnt vmcnt(2)
    s_barrier
    ds_read_b128 v[80:83], v3 offset:0
    ds_read_b128 v[84:87], v3 offset:32768
    ds_read_b128 v[88:91], v3 offset:1024
    ds_read_b128 v[92:95], v3 offset:33792
    ds_read_b128 v[96:99], v3 offset:2048
    ds_read_b128 v[100:103], v3 offset:34816
    ds_read_b128 v[104:107], v3 offset:3072
    ds_read_b128 v[108:111], v3 offset:35840
    s_waitcnt lgkmcnt(4)
    v_mfma_f32_32x32x16_bf16 v[16:31], v[128:131], v[80:83], 0
    s_add_u32 m0, s48, 16384
    s_nop 0
    buffer_load_dwordx4 v13, s[8:11], s44 offen offset:0 lds
    buffer_load_dwordx4 v13, s[8:11], s44 offen offset:1024 lds
    v_mfma_f32_32x32x16_bf16 v[32:47], v[128:131], v[84:87], 0
    v_mfma_f32_32x32x16_bf16 v[16:31], v[132:135], v[88:91], v[16:31]
    v_mfma_f32_32x32x16_bf16 v[32:47], v[132:135], v[92:95], v[32:47]
    ds_read_b128 v[80:83], v3 offset:4096
    ds_read_b128 v[84:87], v3 offset:36864
    ds_read_b128 v[88:91], v3 offset:5120
    ds_read_b128 v[92:95], v3 offset:37888
    s_waitcnt lgkmcnt(4)
    v_mfma_f32_32x32x16_bf16 v[16:31], v[136:139], v[96:99], v[16:31]
    s_add_u32 m0, s48, 65536
    s_nop 0
    buffer_load_dwordx4 v14, s[8:11], 0 offen offset:0 lds
    buffer_load_dwordx4 v14, s[8:11], 0 offen offset:1024 lds
    v_mfma_f32_32x32x16_bf16 v[32:47], v[136:139], v[100:103], v[32:47]
    v_mfma_f32_32x32x16_bf16 v[16:31], v[140:143], v[104:107], v[16:31]
    v_mfma_f32_32x32x16_bf16 v[32:47], v[140:143], v[108:111], v[32:47]
    ds_read_b128 v[96:99], v3 offset:6144
    ds_read_b128 v[100:103], v3 offset:38912
    ds_read_b128 v[104:107], v3 offset:7168
    ds_read_b128 v[108:111], v3 offset:39936
    s_waitcnt lgkmcnt(4)
    v_mfma_f32_32x32x16_bf16 v[16:31], v[144:147], v[80:83], v[16:31]
    s_add_u32 m0, s48, 24576
    s_nop 0
    buffer_load_dwordx4 v13, s[8:11], s46 offen offset:0 lds
    buffer_load_dwordx4 v13, s[8:11], s46 offen offset:1024 lds
    v_mfma_f32_32x32x16_bf16 v[32:47], v[144:147], v[84:87], v[32:47]
    v_mfma_f32_32x32x16_bf16 v[16:31], v[148:151], v[88:91], v[16:31]
    v_mfma_f32_32x32x16_bf16 v[32:47], v[148:151], v[92:95], v[32:47]
    s_waitcnt vmcnt(6)
    s_barrier
    ds_read_b128 v[80:83], v3 offset:8192
    ds_read_b128 v[84:87], v3 offset:40960
    ds_read_b128 v[88:91], v3 offset:9216
    ds_read_b128 v[92:95], v3 offset:41984
    s_waitcnt lgkmcnt(4)
    v_mfma_f32_32x32x16_bf16 v[16:31], v[152:155], v[96:99], v[16:31]
    s_add_u32 m0, s48, 73728
    s_nop 0
    buffer_load_dwordx4 v14, s[8:11], s42 offen offset:0 lds
    buffer_load_dwordx4 v14, s[8:11], s42 offen offset:1024 lds
    v_mfma_f32_32x32x16_bf16 v[32:47], v[152:155], v[100:103], v[32:47]
    v_mfma_f32_32x32x16_bf16 v[16:31], v[156:159], v[104:107], v[16:31]
    v_mfma_f32_32x32x16_bf16 v[32:47], v[156:159], v[108:111], v[32:47]
    ds_read_b128 v[96:99], v3 offset:10240
    ds_read_b128 v[100:103], v3 offset:43008
    ds_read_b128 v[104:107], v3 offset:11264
    ds_read_b128 v[108:111], v3 offset:44032
    s_waitcnt lgkmcnt(4)
    v_mfma_f32_32x32x16_bf16 v[16:31], v[160:163], v[80:83], v[16:31]
    s_add_u32 m0, s48, 81920
    s_nop 0
    buffer_load_dwordx4 v14, s[8:11], s44 offen offset:0 lds
    buffer_load_dwordx4 v14, s[8:11], s44 offen offset:1024 lds
    v_mfma_f32_32x32x16_bf16 v[32:47], v[160:163], v[84:87], v[32:47]
    v_mfma_f32_32x32x16_bf16 v[16:31], v[164:167], v[88:91], v[16:31]
    v_mfma_f32_32x32x16_bf16 v[32:47], v[164:167], v[92:95], v[32:47]
    ds_read_b128 v[80:83], v3 offset:12288
    ds_read_b128 v[84:87], v3 offset:45056
    ds_read_b128 v[88:91], v3 offset:13312
    ds_read_b128 v[92:95], v3 offset:46080
    s_waitcnt lgkmcnt(4)
    v_mfma_f32_32x32x16_bf16 v[16:31], v[168:171], v[96:99], v[16:31]
    s_add_u32 m0, s48, 90112
    s_nop 0
    buffer_load_dwordx4 v14, s[8:11], s46 offen offset:0 lds
    buffer_load_dwordx4 v14, s[8:11], s46 offen offset:1024 lds
    v_mfma_f32_32x32x16_bf16 v[32:47], v[168:171], v[100:103], v[32:47]
    v_mfma_f32_32x32x16_bf16 v[16:31], v[172:175], v[104:107], v[16:31]
    v_mfma_f32_32x32x16_bf16 v[32:47], v[172:175], v[108:111], v[32:47]
    ds_read_b128 v[96:99], v3 offset:14336
    ds_read_b128 v[100:103], v3 offset:47104
    ds_read_b128 v[104:107], v3 offset:15360
    ds_read_b128 v[108:111], v3 offset:48128
    s_waitcnt lgkmcnt(4)
    v_mfma_f32_32x32x16_bf16 v[16:31], v[176:179], v[80:83], v[16:31]
    v_mfma_f32_32x32x16_bf16 v[32:47], v[176:179], v[84:87], v[32:47]
    v_mfma_f32_32x32x16_bf16 v[16:31], v[180:183], v[88:91], v[16:31]
    v_mfma_f32_32x32x16_bf16 v[32:47], v[180:183], v[92:95], v[32:47]
    s_waitcnt vmcnt(8)
    s_barrier
    ds_read_b128 v[80:83], v3 offset:16384
    ds_read_b128 v[84:87], v3 offset:49152
    ds_read_b128 v[88:91], v3 offset:17408
    ds_read_b128 v[92:95], v3 offset:50176
    s_waitcnt lgkmcnt(4)
    v_mfma_f32_32x32x16_bf16 v[16:31], v[184:187], v[96:99], v[16:31]
    v_mfma_f32_32x32x16_bf16 v[32:47], v[184:187], v[100:103], v[32:47]
    v_mfma_f32_32x32x16_bf16 v[16:31], v[188:191], v[104:107], v[16:31]
    v_mfma_f32_32x32x16_bf16 v[32:47], v[188:191], v[108:111], v[32:47]
    ds_read_b128 v[96:99], v3 offset:18432
    ds_read_b128 v[100:103], v3 offset:51200
    ds_read_b128 v[104:107], v3 offset:19456
    ds_read_b128 v[108:111], v3 offset:52224
    s_waitcnt lgkmcnt(4)
    v_mfma_f32_32x32x16_bf16 v[16:31], v[192:195], v[80:83], v[16:31]
    v_mfma_f32_32x32x16_bf16 v[32:47], v[192:195], v[84:87], v[32:47]
    v_mfma_f32_32x32x16_bf16 v[16:31], v[196:199], v[88:91], v[16:31]
    v_mfma_f32_32x32x16_bf16 v[32:47], v[196:199], v[92:95], v[32:47]
    ds_read_b128 v[80:83], v3 offset:20480
    ds_read_b128 v[84:87], v3 offset:53248
    ds_read_b128 v[88:91], v7 offset:0
    ds_read_b128 v[92:95], v7 offset:32768
    s_waitcnt lgkmcnt(4)
    v_mfma_f32_32x32x16_bf16 v[16:31], v[200:203], v[96:99], v[16:31]
    v_mfma_f32_32x32x16_bf16 v[32:47], v[200:203], v[100:103], v[32:47]
    v_mfma_f32_32x32x16_bf16 v[16:31], v[204:207], v[104:107], v[16:31]
    v_mfma_f32_32x32x16_bf16 v[32:47], v[204:207], v[108:111], v[32:47]
    ds_read_b128 v[96:99], v3 offset:21504
    ds_read_b128 v[100:103], v3 offset:54272
    ds_read_b128 v[104:107], v7 offset:1024
    ds_read_b128 v[108:111], v7 offset:33792
    s_waitcnt lgkmcnt(4)
    s_cmp_lg_u32 s20, 0
    s_cbranch_scc1 l1_fb86
    s_mov_b64 exec, 1
    buffer_store_dword v4, v0, s[8:11], s34 offen offset:128 sc0 sc1
    s_mov_b64 exec, -1
l1_fb86:
    v_mfma_f32_32x32x16_bf16 v[16:31], v[208:211], v[80:83], v[16:31]
    v_mfma_f32_32x32x16_bf16 v[32:47], v[208:211], v[84:87], v[32:47]
    v_mfma_f32_32x32x16_bf16 v[48:63], v[128:131], v[88:91], 0
    v_mfma_f32_32x32x16_bf16 v[64:79], v[128:131], v[92:95], 0
    s_waitcnt vmcnt(0)
    s_barrier
    ds_read_b128 v[80:83], v3 offset:22528
    ds_read_b128 v[84:87], v3 offset:55296
    ds_read_b128 v[88:91], v7 offset:2048
    ds_read_b128 v[92:95], v7 offset:34816
    s_waitcnt lgkmcnt(4)
    v_mfma_f32_32x32x16_bf16 v[16:31], v[212:215], v[96:99], v[16:31]
    buffer_load_dwordx4 v[128:131], v15, s[8:11], 0 offen offset:0
    v_mfma_f32_32x32x16_bf16 v[32:47], v[212:215], v[100:103], v[32:47]
    v_mfma_f32_32x32x16_bf16 v[48:63], v[132:135], v[104:107], v[48:63]
    v_mfma_f32_32x32x16_bf16 v[64:79], v[132:135], v[108:111], v[64:79]
    ds_read_b128 v[96:99], v3 offset:23552
    ds_read_b128 v[100:103], v3 offset:56320
    ds_read_b128 v[104:107], v7 offset:3072
    ds_read_b128 v[108:111], v7 offset:35840
    s_waitcnt lgkmcnt(4)
    s_setprio 3
    v_mfma_f32_32x32x16_bf16 v[16:31], v[216:219], v[80:83], v[16:31]
    buffer_load_dwordx4 v[132:135], v9, s[8:11], 0 offen offset:0
    v_mfma_f32_32x32x16_bf16 v[32:47], v[216:219], v[84:87], v[32:47]
    v_mfma_f32_32x32x16_bf16 v[48:63], v[136:139], v[88:91], v[48:63]
    v_mfma_f32_32x32x16_bf16 v[64:79], v[136:139], v[92:95], v[64:79]
    ds_read_b128 v[80:83], v3 offset:24576
    ds_read_b128 v[84:87], v3 offset:57344
    ds_read_b128 v[88:91], v7 offset:4096
    ds_read_b128 v[92:95], v7 offset:36864
    s_waitcnt lgkmcnt(4)
    v_mfma_f32_32x32x16_bf16 v[16:31], v[220:223], v[96:99], v[16:31]
    buffer_load_dwordx4 v[136:139], v15, s[8:11], 0 offen offset:1024
    v_mfma_f32_32x32x16_bf16 v[32:47], v[220:223], v[100:103], v[32:47]
    v_mfma_f32_32x32x16_bf16 v[48:63], v[140:143], v[104:107], v[48:63]
    v_mfma_f32_32x32x16_bf16 v[64:79], v[140:143], v[108:111], v[64:79]
    ds_read_b128 v[96:99], v3 offset:25600
    ds_read_b128 v[100:103], v3 offset:58368
    ds_read_b128 v[104:107], v7 offset:5120
    ds_read_b128 v[108:111], v7 offset:37888
    s_waitcnt lgkmcnt(4)
    v_mfma_f32_32x32x16_bf16 v[16:31], v[224:227], v[80:83], v[16:31]
    buffer_load_dwordx4 v[140:143], v9, s[8:11], 0 offen offset:1024
    v_mfma_f32_32x32x16_bf16 v[32:47], v[224:227], v[84:87], v[32:47]
    v_mfma_f32_32x32x16_bf16 v[48:63], v[144:147], v[88:91], v[48:63]
    v_mfma_f32_32x32x16_bf16 v[64:79], v[144:147], v[92:95], v[64:79]
    ds_read_b128 v[80:83], v3 offset:26624
    ds_read_b128 v[84:87], v3 offset:59392
    ds_read_b128 v[88:91], v7 offset:6144
    ds_read_b128 v[92:95], v7 offset:38912
    s_waitcnt lgkmcnt(4)
    v_mfma_f32_32x32x16_bf16 v[16:31], v[228:231], v[96:99], v[16:31]
    buffer_load_dwordx4 v[144:147], v15, s[8:11], 0 offen offset:2048
    v_mfma_f32_32x32x16_bf16 v[32:47], v[228:231], v[100:103], v[32:47]
    v_mfma_f32_32x32x16_bf16 v[48:63], v[148:151], v[104:107], v[48:63]
    v_mfma_f32_32x32x16_bf16 v[64:79], v[148:151], v[108:111], v[64:79]
    ds_read_b128 v[96:99], v3 offset:27648
    ds_read_b128 v[100:103], v3 offset:60416
    ds_read_b128 v[104:107], v7 offset:7168
    ds_read_b128 v[108:111], v7 offset:39936
    s_waitcnt lgkmcnt(4)
    v_mfma_f32_32x32x16_bf16 v[16:31], v[232:235], v[80:83], v[16:31]
    buffer_load_dwordx4 v[148:151], v9, s[8:11], 0 offen offset:2048
    v_mfma_f32_32x32x16_bf16 v[32:47], v[232:235], v[84:87], v[32:47]
    v_mfma_f32_32x32x16_bf16 v[48:63], v[152:155], v[88:91], v[48:63]
    v_mfma_f32_32x32x16_bf16 v[64:79], v[152:155], v[92:95], v[64:79]
    ds_read_b128 v[80:83], v3 offset:28672
    ds_read_b128 v[84:87], v3 offset:61440
    ds_read_b128 v[88:91], v7 offset:8192
    ds_read_b128 v[92:95], v7 offset:40960
    s_waitcnt lgkmcnt(4)
    v_mfma_f32_32x32x16_bf16 v[16:31], v[236:239], v[96:99], v[16:31]
    buffer_load_dwordx4 v[152:155], v15, s[8:11], 0 offen offset:3072
    v_mfma_f32_32x32x16_bf16 v[32:47], v[236:239], v[100:103], v[32:47]
    v_mfma_f32_32x32x16_bf16 v[48:63], v[156:159], v[104:107], v[48:63]
    v_mfma_f32_32x32x16_bf16 v[64:79], v[156:159], v[108:111], v[64:79]
    ds_read_b128 v[96:99], v3 offset:29696
    ds_read_b128 v[100:103], v3 offset:62464
    ds_read_b128 v[104:107], v7 offset:9216
    ds_read_b128 v[108:111], v7 offset:41984
    s_waitcnt lgkmcnt(4)
    v_mfma_f32_32x32x16_bf16 v[16:31], v[240:243], v[80:83], v[16:31]
    buffer_load_dwordx4 v[156:159], v9, s[8:11], 0 offen offset:3072
    v_mfma_f32_32x32x16_bf16 v[32:47], v[240:243], v[84:87], v[32:47]
    v_mfma_f32_32x32x16_bf16 v[48:63], v[160:163], v[88:91], v[48:63]
    v_mfma_f32_32x32x16_bf16 v[64:79], v[160:163], v[92:95], v[64:79]
    s_barrier
    ds_read_b128 v[80:83], v3 offset:30720
    ds_read_b128 v[84:87], v3 offset:63488
    ds_read_b128 v[88:91], v7 offset:10240
    ds_read_b128 v[92:95], v7 offset:43008
    s_waitcnt lgkmcnt(4)
    v_mfma_f32_32x32x16_bf16 v[16:31], v[244:247], v[96:99], v[16:31]
    buffer_load_dwordx4 v[160:163], v15, s[8:11], s41 offen offset:0
    v_mfma_f32_32x32x16_bf16 v[32:47], v[244:247], v[100:103], v[32:47]
    v_mfma_f32_32x32x16_bf16 v[48:63], v[164:167], v[104:107], v[48:63]
    v_mfma_f32_32x32x16_bf16 v[64:79], v[164:167], v[108:111], v[64:79]
    ds_read_b128 v[96:99], v3 offset:31744
    ds_read_b128 v[100:103], v3 offset:64512
    ds_read_b128 v[104:107], v7 offset:11264
    ds_read_b128 v[108:111], v7 offset:44032
    ds_read_b128 v[112:115], v10 offset:0
    ds_read_b128 v[116:119], v10 offset:32
    ds_read_b128 v[120:123], v10 offset:64
    ds_read_b128 v[124:127], v10 offset:96
    s_waitcnt lgkmcnt(8)
    v_mfma_f32_32x32x16_bf16 v[16:31], v[248:251], v[80:83], v[16:31]
    buffer_load_dwordx4 v[164:167], v9, s[8:11], s41 offen offset:0
    v_mfma_f32_32x32x16_bf16 v[32:47], v[248:251], v[84:87], v[32:47]
    v_mfma_f32_32x32x16_bf16 v[48:63], v[168:171], v[88:91], v[48:63]
    v_mfma_f32_32x32x16_bf16 v[64:79], v[168:171], v[92:95], v[64:79]
    ds_read_b128 v[80:83], v7 offset:12288
    ds_read_b128 v[84:87], v7 offset:45056
    ds_read_b128 v[88:91], v7 offset:13312
    ds_read_b128 v[92:95], v7 offset:46080
    ds_read_b128 v[10:13], v8
    s_waitcnt lgkmcnt(9)
    v_mfma_f32_32x32x16_bf16 v[16:31], v[252:255], v[96:99], v[16:31]
    buffer_load_dwordx4 v[168:171], v15, s[8:11], s41 offen offset:1024
    v_mfma_f32_32x32x16_bf16 v[32:47], v[252:255], v[100:103], v[32:47]
    v_mfma_f32_32x32x16_bf16 v[48:63], v[172:175], v[104:107], v[48:63]
    v_mfma_f32_32x32x16_bf16 v[64:79], v[172:175], v[108:111], v[64:79]
    ds_read_b128 v[96:99], v7 offset:14336
    ds_read_b128 v[100:103], v7 offset:47104
    ds_read_b128 v[104:107], v7 offset:15360
    ds_read_b128 v[108:111], v7 offset:48128
    s_waitcnt lgkmcnt(5)
    v_mfma_f32_32x32x16_bf16 v[48:63], v[176:179], v[80:83], v[48:63]
    buffer_load_dwordx4 v[172:175], v9, s[8:11], s41 offen offset:1024
    v_mfma_f32_32x32x16_bf16 v[64:79], v[176:179], v[84:87], v[64:79]
    v_mfma_f32_32x32x16_bf16 v[48:63], v[180:183], v[88:91], v[48:63]
    v_mfma_f32_32x32x16_bf16 v[64:79], v[180:183], v[92:95], v[64:79]
    s_waitcnt lgkmcnt(4)
    s_nop 3
    v_pk_fma_f32 v[16:17], v[10:11], v[112:113], v[16:17]
    v_pk_fma_f32 v[18:19], v[10:11], v[114:115], v[18:19]
    v_pk_fma_f32 v[20:21], v[10:11], v[116:117], v[20:21]
    v_pk_fma_f32 v[22:23], v[10:11], v[118:119], v[22:23]
    v_pk_fma_f32 v[24:25], v[10:11], v[120:121], v[24:25]
    v_pk_fma_f32 v[26:27], v[10:11], v[122:123], v[26:27]
    v_pk_fma_f32 v[28:29], v[10:11], v[124:125], v[28:29]
    v_pk_fma_f32 v[30:31], v[10:11], v[126:127], v[30:31]
    v_pk_mul_f32 v[16:17], v[16:17], v[24:25]
    v_pk_mul_f32 v[18:19], v[18:19], v[26:27]
    v_pk_mul_f32 v[20:21], v[20:21], v[28:29]
    v_pk_mul_f32 v[22:23], v[22:23], v[30:31]
    v_pk_mul_f32 v[16:17], v[16:17], v[12:13]
    v_pk_mul_f32 v[18:19], v[18:19], v[12:13]
    v_pk_mul_f32 v[20:21], v[20:21], v[12:13]
    v_pk_mul_f32 v[22:23], v[22:23], v[12:13]
    v_cvt_pk_bf16_f32 v24, v16, v17
    v_cvt_pk_bf16_f32 v25, v18, v19
    v_cvt_pk_bf16_f32 v26, v20, v21
    v_cvt_pk_bf16_f32 v27, v22, v23
    buffer_store_dwordx4 v[24:27], v3, s[8:11], s39 offen sc0 sc1
    s_add_u32 s39, s39, 114688
    ds_read_b128 v[10:13], v8 offset:1024
    ds_read_b128 v[80:83], v7 offset:16384
    ds_read_b128 v[84:87], v7 offset:49152
    ds_read_b128 v[88:91], v7 offset:17408
    ds_read_b128 v[92:95], v7 offset:50176
    s_waitcnt lgkmcnt(5)
    v_mfma_f32_32x32x16_bf16 v[48:63], v[184:187], v[96:99], v[48:63]
    buffer_load_dwordx4 v[176:179], v15, s[8:11], s41 offen offset:2048
    v_mfma_f32_32x32x16_bf16 v[64:79], v[184:187], v[100:103], v[64:79]
    buffer_load_dwordx4 v[180:183], v9, s[8:11], s41 offen offset:2048
    v_mfma_f32_32x32x16_bf16 v[48:63], v[188:191], v[104:107], v[48:63]
    v_mfma_f32_32x32x16_bf16 v[64:79], v[188:191], v[108:111], v[64:79]
    s_waitcnt lgkmcnt(4)
    v_pk_fma_f32 v[32:33], v[10:11], v[112:113], v[32:33]
    v_pk_fma_f32 v[34:35], v[10:11], v[114:115], v[34:35]
    v_pk_fma_f32 v[36:37], v[10:11], v[116:117], v[36:37]
    v_pk_fma_f32 v[38:39], v[10:11], v[118:119], v[38:39]
    v_pk_fma_f32 v[40:41], v[10:11], v[120:121], v[40:41]
    v_pk_fma_f32 v[42:43], v[10:11], v[122:123], v[42:43]
    v_pk_fma_f32 v[44:45], v[10:11], v[124:125], v[44:45]
    v_pk_fma_f32 v[46:47], v[10:11], v[126:127], v[46:47]
    v_pk_mul_f32 v[32:33], v[32:33], v[40:41]
    v_pk_mul_f32 v[34:35], v[34:35], v[42:43]
    v_pk_mul_f32 v[36:37], v[36:37], v[44:45]
    v_pk_mul_f32 v[38:39], v[38:39], v[46:47]
    v_pk_mul_f32 v[32:33], v[32:33], v[12:13]
    v_pk_mul_f32 v[34:35], v[34:35], v[12:13]
    v_pk_mul_f32 v[36:37], v[36:37], v[12:13]
    v_pk_mul_f32 v[38:39], v[38:39], v[12:13]
    v_cvt_pk_bf16_f32 v40, v32, v33
    v_cvt_pk_bf16_f32 v41, v34, v35
    v_cvt_pk_bf16_f32 v42, v36, v37
    v_cvt_pk_bf16_f32 v43, v38, v39
    buffer_store_dwordx4 v[40:43], v3, s[8:11], s39 offen sc0 sc1
    s_add_u32 s39, s39, 114688
    ds_read_b128 v[96:99], v7 offset:18432
    ds_read_b128 v[100:103], v7 offset:51200
    ds_read_b128 v[104:107], v7 offset:19456
    ds_read_b128 v[108:111], v7 offset:52224
    s_waitcnt lgkmcnt(4)
    s_setprio 2
    v_mfma_f32_32x32x16_bf16 v[48:63], v[192:195], v[80:83], v[48:63]
    buffer_load_dwordx4 v[184:187], v15, s[8:11], s41 offen offset:3072
    v_mfma_f32_32x32x16_bf16 v[64:79], v[192:195], v[84:87], v[64:79]
    buffer_load_dwordx4 v[188:191], v9, s[8:11], s41 offen offset:3072
    v_mfma_f32_32x32x16_bf16 v[48:63], v[196:199], v[88:91], v[48:63]
    v_mfma_f32_32x32x16_bf16 v[64:79], v[196:199], v[92:95], v[64:79]
    ds_read_b128 v[80:83], v7 offset:20480
    ds_read_b128 v[84:87], v7 offset:53248
    ds_read_b128 v[88:91], v7 offset:21504
    ds_read_b128 v[92:95], v7 offset:54272
    ds_read_b128 v[16:19], v8 offset:2048
    ds_read_b128 v[20:23], v8 offset:3072
    s_waitcnt lgkmcnt(6)
    v_mfma_f32_32x32x16_bf16 v[48:63], v[200:203], v[96:99], v[48:63]
    buffer_load_dwordx4 v[192:195], v15, s[8:11], s42 offen offset:0
    v_mfma_f32_32x32x16_bf16 v[64:79], v[200:203], v[100:103], v[64:79]
    buffer_load_dwordx4 v[196:199], v9, s[8:11], s42 offen offset:0
    v_mfma_f32_32x32x16_bf16 v[48:63], v[204:207], v[104:107], v[48:63]
    v_mfma_f32_32x32x16_bf16 v[64:79], v[204:207], v[108:111], v[64:79]
    ds_read_b128 v[96:99], v7 offset:22528
    ds_read_b128 v[100:103], v7 offset:55296
    ds_read_b128 v[104:107], v7 offset:23552
    ds_read_b128 v[108:111], v7 offset:56320
    s_waitcnt lgkmcnt(6)
    v_mfma_f32_32x32x16_bf16 v[48:63], v[208:211], v[80:83], v[48:63]
    buffer_load_dwordx4 v[200:203], v15, s[8:11], s42 offen offset:1024
    v_mfma_f32_32x32x16_bf16 v[64:79], v[208:211], v[84:87], v[64:79]
    buffer_load_dwordx4 v[204:207], v9, s[8:11], s42 offen offset:1024
    v_mfma_f32_32x32x16_bf16 v[48:63], v[212:215], v[88:91], v[48:63]
    v_mfma_f32_32x32x16_bf16 v[64:79], v[212:215], v[92:95], v[64:79]
    s_waitcnt vmcnt(6)
    s_barrier
    ds_read_b128 v[80:83], v7 offset:24576
    ds_read_b128 v[84:87], v7 offset:57344
    ds_read_b128 v[88:91], v7 offset:25600
    ds_read_b128 v[92:95], v7 offset:58368
    s_waitcnt lgkmcnt(4)
    v_mfma_f32_32x32x16_bf16 v[48:63], v[216:219], v[96:99], v[48:63]
    buffer_load_dwordx4 v[208:211], v15, s[8:11], s42 offen offset:2048
    v_mfma_f32_32x32x16_bf16 v[64:79], v[216:219], v[100:103], v[64:79]
    buffer_load_dwordx4 v[212:215], v9, s[8:11], s42 offen offset:2048
    v_mfma_f32_32x32x16_bf16 v[48:63], v[220:223], v[104:107], v[48:63]
    v_mfma_f32_32x32x16_bf16 v[64:79], v[220:223], v[108:111], v[64:79]
    ds_read_b128 v[96:99], v7 offset:26624
    ds_read_b128 v[100:103], v7 offset:59392
    ds_read_b128 v[104:107], v7 offset:27648
    ds_read_b128 v[108:111], v7 offset:60416
    s_waitcnt lgkmcnt(4)
    v_mfma_f32_32x32x16_bf16 v[48:63], v[224:227], v[80:83], v[48:63]
    buffer_load_dwordx4 v[216:219], v15, s[8:11], s42 offen offset:3072
    v_mfma_f32_32x32x16_bf16 v[64:79], v[224:227], v[84:87], v[64:79]
    buffer_load_dwordx4 v[220:223], v9, s[8:11], s42 offen offset:3072
    v_mfma_f32_32x32x16_bf16 v[48:63], v[228:231], v[88:91], v[48:63]
    v_mfma_f32_32x32x16_bf16 v[64:79], v[228:231], v[92:95], v[64:79]
    ds_read_b128 v[80:83], v7 offset:28672
    ds_read_b128 v[84:87], v7 offset:61440
    ds_read_b128 v[88:91], v7 offset:29696
    ds_read_b128 v[92:95], v7 offset:62464
    s_waitcnt lgkmcnt(4)
    s_setprio 0
    v_mfma_f32_32x32x16_bf16 v[48:63], v[232:235], v[96:99], v[48:63]
    buffer_load_dwordx4 v[224:227], v15, s[8:11], s43 offen offset:0
    v_mfma_f32_32x32x16_bf16 v[64:79], v[232:235], v[100:103], v[64:79]
    buffer_load_dwordx4 v[228:231], v9, s[8:11], s43 offen offset:0
    v_mfma_f32_32x32x16_bf16 v[48:63], v[236:239], v[104:107], v[48:63]
    v_mfma_f32_32x32x16_bf16 v[64:79], v[236:239], v[108:111], v[64:79]
    ds_read_b128 v[96:99], v7 offset:30720
    ds_read_b128 v[100:103], v7 offset:63488
    ds_read_b128 v[104:107], v7 offset:31744
    ds_read_b128 v[108:111], v7 offset:64512
    s_waitcnt lgkmcnt(4)
    v_mfma_f32_32x32x16_bf16 v[48:63], v[240:243], v[80:83], v[48:63]
    buffer_load_dwordx4 v[232:235], v15, s[8:11], s43 offen offset:1024
    v_mfma_f32_32x32x16_bf16 v[64:79], v[240:243], v[84:87], v[64:79]
    buffer_load_dwordx4 v[236:239], v9, s[8:11], s43 offen offset:1024
    v_mfma_f32_32x32x16_bf16 v[48:63], v[244:247], v[88:91], v[48:63]
    v_mfma_f32_32x32x16_bf16 v[64:79], v[244:247], v[92:95], v[64:79]
    s_waitcnt lgkmcnt(0)
    v_mfma_f32_32x32x16_bf16 v[48:63], v[248:251], v[96:99], v[48:63]
    v_mfma_f32_32x32x16_bf16 v[64:79], v[248:251], v[100:103], v[64:79]
    v_mfma_f32_32x32x16_bf16 v[48:63], v[252:255], v[104:107], v[48:63]
    v_mfma_f32_32x32x16_bf16 v[64:79], v[252:255], v[108:111], v[64:79]
    s_lshl_b32 s30, s20, 1
    s_lshl_b32 s32, 3, s30
    s_lshl_b32 s35, s21, 8
    s_add_u32 s35, s35, 24764416
    s_mov_b64 exec, s[32:33]
    buffer_load_dword v2, v0, s[8:11], s35 offen sc1
    s_mov_b64 exec, -1
    s_waitcnt lgkmcnt(0)
    s_nop 11
    v_pk_fma_f32 v[48:49], v[16:17], v[112:113], v[48:49]
    v_pk_fma_f32 v[50:51], v[16:17], v[114:115], v[50:51]
    v_pk_fma_f32 v[52:53], v[16:17], v[116:117], v[52:53]
    v_pk_fma_f32 v[54:55], v[16:17], v[118:119], v[54:55]
    v_pk_fma_f32 v[56:57], v[16:17], v[120:121], v[56:57]
    v_pk_fma_f32 v[58:59], v[16:17], v[122:123], v[58:59]
    v_pk_fma_f32 v[60:61], v[16:17], v[124:125], v[60:61]
    v_pk_fma_f32 v[62:63], v[16:17], v[126:127], v[62:63]
    v_pk_mul_f32 v[48:49], v[48:49], v[56:57]
    v_pk_mul_f32 v[50:51], v[50:51], v[58:59]
    v_pk_mul_f32 v[52:53], v[52:53], v[60:61]
    v_pk_mul_f32 v[54:55], v[54:55], v[62:63]
    v_pk_mul_f32 v[48:49], v[48:49], v[18:19]
    v_pk_mul_f32 v[50:51], v[50:51], v[18:19]
    v_pk_mul_f32 v[52:53], v[52:53], v[18:19]
    v_pk_mul_f32 v[54:55], v[54:55], v[18:19]
    v_cvt_pk_bf16_f32 v56, v48, v49
    v_cvt_pk_bf16_f32 v57, v50, v51
    v_cvt_pk_bf16_f32 v58, v52, v53
    v_cvt_pk_bf16_f32 v59, v54, v55
    buffer_store_dwordx4 v[56:59], v3, s[8:11], s39 offen sc0 sc1
    s_add_u32 s39, s39, 114688
    v_pk_fma_f32 v[64:65], v[20:21], v[112:113], v[64:65]
    v_pk_fma_f32 v[66:67], v[20:21], v[114:115], v[66:67]
    v_pk_fma_f32 v[68:69], v[20:21], v[116:117], v[68:69]
    v_pk_fma_f32 v[70:71], v[20:21], v[118:119], v[70:71]
    v_pk_fma_f32 v[72:73], v[20:21], v[120:121], v[72:73]
    v_pk_fma_f32 v[74:75], v[20:21], v[122:123], v[74:75]
    v_pk_fma_f32 v[76:77], v[20:21], v[124:125], v[76:77]
    v_pk_fma_f32 v[78:79], v[20:21], v[126:127], v[78:79]
    v_pk_mul_f32 v[64:65], v[64:65], v[72:73]
    v_pk_mul_f32 v[66:67], v[66:67], v[74:75]
    v_pk_mul_f32 v[68:69], v[68:69], v[76:77]
    v_pk_mul_f32 v[70:71], v[70:71], v[78:79]
    v_pk_mul_f32 v[64:65], v[64:65], v[22:23]
    v_pk_mul_f32 v[66:67], v[66:67], v[22:23]
    v_pk_mul_f32 v[68:69], v[68:69], v[22:23]
    v_pk_mul_f32 v[70:71], v[70:71], v[22:23]
    v_cvt_pk_bf16_f32 v72, v64, v65
    v_cvt_pk_bf16_f32 v73, v66, v67
    v_cvt_pk_bf16_f32 v74, v68, v69
    v_cvt_pk_bf16_f32 v75, v70, v71
    buffer_store_dwordx4 v[72:75], v3, s[8:11], s39 offen sc0 sc1
    s_waitcnt vmcnt(2)
    s_mov_b64 exec, s[32:33]
    s_mov_b32 s31, 0
l1_qa87:
    v_cmp_ne_u32 vcc, 0, v2
    s_cmp_eq_u64 vcc, s[32:33]
    s_cbranch_scc1 l1_qd89
    buffer_load_dword v2, v0, s[8:11], s35 offen sc1
    s_add_u32 s31, s31, 1
    s_waitcnt vmcnt(0)
    s_cmp_lt_u32 s31, 64
    s_cbranch_scc1 l1_qa87
l1_qb88:
    buffer_load_dword v2, v0, s[8:11], s35 offen sc1
    s_waitcnt vmcnt(0)
    v_cmp_ne_u32 s[36:37], 0, v2
    buffer_load_dword v2, v0, s[8:11], s35 offen offset:128 sc0 sc1
    s_waitcnt vmcnt(0)
    v_cmp_ne_u32 vcc, 0, v2
    s_add_u32 s31, s31, 1
    s_or_b64 vcc, vcc, s[36:37]
    s_cmp_eq_u64 vcc, s[32:33]
    s_cbranch_scc1 l1_qd89
    s_sleep 4
    s_cmp_lt_u32 s31, 1048576
    s_cbranch_scc1 l1_qb88
    s_branch k_end
l1_qd89:
    s_mov_b64 exec, -1
    buffer_load_dwordx4 v[24:27], v5, s[8:11], 0 offen offset:0
    buffer_load_dwordx4 v[28:31], v5, s[8:11], 0 offen offset:1024
    buffer_load_dwordx4 v[32:35], v5, s[8:11], 0 offen offset:2048
    buffer_load_dwordx4 v[36:39], v5, s[8:11], 0 offen offset:3072
    buffer_load_dwordx4 v[40:43], v5, s[8:11], s41 offen offset:0
    buffer_load_dwordx4 v[44:47], v5, s[8:11], s41 offen offset:1024
    s_branch l1_ge85
l1_gs84:
    s_mul_i32 s39, s21, 448
    s_add_u32 s39, s39, s40
    s_lshl_b32 s39, s39, 10
    s_add_u32 s39, s39, 33447936
    s_waitcnt vmcnt(2)
    s_barrier
    s_add_u32 m0, s48, 16384
    s_nop 0
    buffer_load_dwordx4 v13, s[8:11], s44 offen offset:0 lds
    buffer_load_dwordx4 v13, s[8:11], s44 offen offset:1024 lds
    s_add_u32 m0, s48, 65536
    s_nop 0
    buffer_load_dwordx4 v14, s[8:11], 0 offen offset:0 lds
    buffer_load_dwordx4 v14, s[8:11], 0 offen offset:1024 lds
    s_add_u32 m0, s48, 24576
    s_nop 0
    buffer_load_dwordx4 v13, s[8:11], s46 offen offset:0 lds
    buffer_load_dwordx4 v13, s[8:11], s46 offen offset:1024 lds
    s_waitcnt vmcnt(6)
    s_barrier
    s_add_u32 m0, s48, 73728
    s_nop 0
    buffer_load_dwordx4 v14, s[8:11], s42 offen offset:0 lds
    buffer_load_dwordx4 v14, s[8:11], s42 offen offset:1024 lds
    s_add_u32 m0, s48, 81920
    s_nop 0
    buffer_load_dwordx4 v14, s[8:11], s44 offen offset:0 lds
    buffer_load_dwordx4 v14, s[8:11], s44 offen offset:1024 lds
    s_add_u32 m0, s48, 90112
    s_nop 0
    buffer_load_dwordx4 v14, s[8:11], s46 offen offset:0 lds
    buffer_load_dwordx4 v14, s[8:11], s46 offen offset:1024 lds
    v_mov_b32 v80, 0
    v_mov_b32 v81, 0
    v_mov_b32 v82, 137216
    ds_write_b64 v82, v[80:81]
    buffer_load_dwordx2 v[16:17], v12, s[8:11], 0 offen offset:0
    buffer_load_dwordx2 v[18:19], v12, s[8:11], 0 offen offset:256
    buffer_load_dwordx2 v[20:21], v12, s[8:11], 0 offen offset:512
    buffer_load_dwordx2 v[22:23], v12, s[8:11], 0 offen offset:768
    buffer_load_dwordx2 v[24:25], v12, s[8:11], 0 offen offset:1024
    buffer_load_dwordx2 v[26:27], v12, s[8:11], 0 offen offset:1280
    buffer_load_dwordx2 v[28:29], v12, s[8:11], 0 offen offset:1536
    buffer_load_dwordx2 v[30:31], v12, s[8:11], 0 offen offset:1792
    buffer_load_dwordx2 v[32:33], v12, s[8:11], 0 offen offset:2048
    buffer_load_dwordx2 v[34:35], v12, s[8:11], 0 offen offset:2304
    buffer_load_dwordx2 v[36:37], v12, s[8:11], 0 offen offset:2560
    buffer_load_dwordx2 v[38:39], v12, s[8:11], 0 offen offset:2816
    buffer_load_dwordx2 v[40:41], v12, s[8:11], 0 offen offset:3072
    buffer_load_dwordx2 v[42:43], v12, s[8:11], 0 offen offset:3328
    buffer_load_dwordx2 v[44:45], v12, s[8:11], 0 offen offset:3584
    buffer_load_dwordx2 v[46:47], v12, s[8:11], 0 offen offset:3840
    buffer_load_dwordx2 v[48:49], v12, s[8:11], s42 offen offset:0
    buffer_load_dwordx2 v[50:51], v12, s[8:11], s42 offen offset:256
    buffer_load_dwordx2 v[52:53], v12, s[8:11], s42 offen offset:512
    buffer_load_dwordx2 v[54:55], v12, s[8:11], s42 offen offset:768
    buffer_load_dwordx2 v[56:57], v12, s[8:11], s42 offen offset:1024
    buffer_load_dwordx2 v[58:59], v12, s[8:11], s42 offen offset:1280
    buffer_load_dwordx2 v[60:61], v12, s[8:11], s42 offen offset:1536
    buffer_load_dwordx2 v[62:63], v12, s[8:11], s42 offen offset:1792
    buffer_load_dwordx2 v[64:65], v12, s[8:11], s42 offen offset:2048
    buffer_load_dwordx2 v[66:67], v12, s[8:11], s42 offen offset:2304
    buffer_load_dwordx2 v[68:69], v12, s[8:11], s42 offen offset:2560
    buffer_load_dwordx2 v[70:71], v12, s[8:11], s42 offen offset:2816
    buffer_load_dwordx2 v[72:73], v12, s[8:11], s42 offen offset:3072
    buffer_load_dwordx2 v[74:75], v12, s[8:11], s42 offen offset:3328
    buffer_load_dwordx2 v[76:77], v12, s[8:11], s42 offen offset:3584
    buffer_load_dwordx2 v[78:79], v12, s[8:11], s42 offen offset:3840
    s_waitcnt vmcnt(40)
    s_barrier
    buffer_load_dwordx4 v[128:131], v15, s[8:11], 0 offen offset:0
    buffer_load_dwordx4 v[132:135], v9, s[8:11], 0 offen offset:0
    buffer_load_dwordx4 v[136:139], v15, s[8:11], 0 offen offset:1024
    buffer_load_dwordx4 v[140:143], v9, s[8:11], 0 offen offset:1024
    s_waitcnt vmcnt(20)
    v_add_f32 v16, v16, v32
    v_add_f32 v17, v17, v33
    v_add_f32 v18, v18, v34
    v_add_f32 v19, v19, v35
    v_add_f32 v20, v20, v36
    v_add_f32 v21, v21, v37
    v_add_f32 v22, v22, v38
    v_add_f32 v23, v23, v39
    v_add_f32 v24, v24, v40
    v_add_f32 v25, v25, v41
    v_add_f32 v26, v26, v42
    v_add_f32 v27, v27, v43
    v_add_f32 v28, v28, v44
    v_add_f32 v29, v29, v45
    v_add_f32 v30, v30, v46
    v_add_f32 v31, v31, v47
    v_add_f32 v16, v16, v24
    v_add_f32 v17, v17, v25
    v_add_f32 v18, v18, v26
    v_add_f32 v19, v19, v27
    v_add_f32 v20, v20, v28
    v_add_f32 v21, v21, v29
    v_add_f32 v22, v22, v30
    v_add_f32 v23, v23, v31
    v_add_f32 v16, v16, v20
    v_add_f32 v17, v17, v21
    v_add_f32 v18, v18, v22
    v_add_f32 v19, v19, v23
    v_add_f32 v16, v16, v18
    v_add_f32 v17, v17, v19
    v_mov_b32 v18, v16
    v_mov_b32 v19, v17
    s_nop 1
    v_permlane32_swap_b32 v16, v18
    v_permlane32_swap_b32 v17, v19
    v_add_f32 v16, v16, v18
    v_add_f32 v17, v17, v19
    v_mul_f32 v16, 0xbb000000, v16
    v_mul_f32 v17, 0x3b000000, v17
    v_fma_f32 v17, -v16, v16, v17
    v_max_f32 v17, 0, v17
    v_add_f32 v17, 0x3727c5ac, v17
    v_rcp_f32 v18, v17
    v_mov_b32 v17, v16
    v_mov_b32 v19, v18
    ds_write_b128 v8, v[16:19] offset:0
    s_waitcnt lgkmcnt(0)
    s_mul_i32 s30, s22, 896
    s_add_u32 s30, s30, 26370048
    buffer_load_dwordx4 v[16:19], v3, s[8:11], s30 offen
    s_add_u32 s30, s30, 14336
    buffer_load_dwordx4 v[20:23], v3, s[8:11], s30 offen
    s_add_u32 s30, s30, 14336
    buffer_load_dwordx4 v[24:27], v3, s[8:11], s30 offen
    s_add_u32 s30, s30, 14336
    buffer_load_dwordx4 v[28:31], v3, s[8:11], s30 offen
    s_add_u32 s30, s30, 14336
    buffer_load_dwordx4 v[32:35], v3, s[8:11], s30 offen
    s_add_u32 s30, s30, 14336
    buffer_load_dwordx4 v[36:39], v3, s[8:11], s30 offen
    s_add_u32 s30, s30, 14336
    buffer_load_dwordx4 v[40:43], v3, s[8:11], s30 offen
    s_add_u32 s30, s30, 14336
    buffer_load_dwordx4 v[44:47], v3, s[8:11], s30 offen
    s_waitcnt vmcnt(12)
    v_add_f32 v48, v48, v64
    v_add_f32 v49, v49, v65
    v_add_f32 v50, v50, v66
    v_add_f32 v51, v51, v67
    v_add_f32 v52, v52, v68
    v_add_f32 v53, v53, v69
    v_add_f32 v54, v54, v70
    v_add_f32 v55, v55, v71
    v_add_f32 v56, v56, v72
    v_add_f32 v57, v57, v73
    v_add_f32 v58, v58, v74
    v_add_f32 v59, v59, v75
    v_add_f32 v60, v60, v76
    v_add_f32 v61, v61, v77
    v_add_f32 v62, v62, v78
    v_add_f32 v63, v63, v79
    v_add_f32 v48, v48, v56
    v_add_f32 v49, v49, v57
    v_add_f32 v50, v50, v58
    v_add_f32 v51, v51, v59
    v_add_f32 v52, v52, v60
    v_add_f32 v53, v53, v61
    v_add_f32 v54, v54, v62
    v_add_f32 v55, v55, v63
    v_add_f32 v48, v48, v52
    v_add_f32 v49, v49, v53
    v_add_f32 v50, v50, v54
    v_add_f32 v51, v51, v55
    v_add_f32 v48, v48, v50
    v_add_f32 v49, v49, v51
    v_mov_b32 v50, v48
    v_mov_b32 v51, v49
    s_nop 1
    v_permlane32_swap_b32 v48, v50
    v_permlane32_swap_b32 v49, v51
    v_add_f32 v48, v48, v50
    v_add_f32 v49, v49, v51
    v_mul_f32 v48, 0xbb000000, v48
    v_mul_f32 v49, 0x3b000000, v49
    v_fma_f32 v49, -v48, v48, v49
    v_max_f32 v49, 0, v49
    v_add_f32 v49, 0x3727c5ac, v49
    v_rcp_f32 v50, v49
    v_mov_b32 v49, v48
    v_mov_b32 v51, v50
    ds_write_b128 v8, v[48:51] offset:1024
    s_waitcnt lgkmcnt(0)
    buffer_load_dwordx2 v[48:49], v12, s[8:11], s46 offen offset:0
    buffer_load_dwordx2 v[50:51], v12, s[8:11], s46 offen offset:256
    buffer_load_dwordx2 v[52:53], v12, s[8:11], s46 offen offset:512
    buffer_load_dwordx2 v[54:55], v12, s[8:11], s46 offen offset:768
    buffer_load_dwordx2 v[56:57], v12, s[8:11], s46 offen offset:1024
    buffer_load_dwordx2 v[58:59], v12, s[8:11], s46 offen offset:1280
    buffer_load_dwordx2 v[60:61], v12, s[8:11], s46 offen offset:1536
    buffer_load_dwordx2 v[62:63], v12, s[8:11], s46 offen offset:1792
    buffer_load_dwordx2 v[64:65], v12, s[8:11], s46 offen offset:2048
    buffer_load_dwordx2 v[66:67], v12, s[8:11], s46 offen offset:2304
    buffer_load_dwordx2 v[68:69], v12, s[8:11], s46 offen offset:2560
    buffer_load_dwordx2 v[70:71], v12, s[8:11], s46 offen offset:2816
    buffer_load_dwordx2 v[72:73], v12, s[8:11], s46 offen offset:3072
    buffer_load_dwordx2 v[74:75], v12, s[8:11], s46 offen offset:3328
    buffer_load_dwordx2 v[76:77], v12, s[8:11], s46 offen offset:3584
    buffer_load_dwordx2 v[78:79], v12, s[8:11], s46 offen offset:3840
    s_cmp_lg_u32 s20, 0
    s_cbranch_scc1 l1_fb90
    s_mov_b64 exec, 1
    buffer_store_dword v4, v0, s[8:11], s34 offen offset:128 sc0 sc1
    s_mov_b64 exec, -1
l1_fb90:
    buffer_load_dwordx4 v[144:147], v15, s[8:11], 0 offen offset:2048
    buffer_load_dwordx4 v[148:151], v9, s[8:11], 0 offen offset:2048
    s_barrier
    buffer_load_dwordx4 v[152:155], v15, s[8:11], 0 offen offset:3072
    buffer_load_dwordx4 v[156:159], v9, s[8:11], 0 offen offset:3072
    buffer_load_dwordx4 v[160:163], v15, s[8:11], s41 offen offset:0
    buffer_load_dwordx4 v[164:167], v9, s[8:11], s41 offen offset:0
    buffer_load_dwordx4 v[168:171], v15, s[8:11], s41 offen offset:1024
    buffer_load_dwordx4 v[172:175], v9, s[8:11], s41 offen offset:1024
    s_waitcnt vmcnt(24)
    v_add_f32 v16, v16, v32
    v_add_f32 v17, v17, v33
    v_add_f32 v18, v18, v34
    v_add_f32 v19, v19, v35
    v_add_f32 v20, v20, v36
    v_add_f32 v21, v21, v37
    v_add_f32 v22, v22, v38
    v_add_f32 v23, v23, v39
    v_add_f32 v24, v24, v40
    v_add_f32 v25, v25, v41
    v_add_f32 v26, v26, v42
    v_add_f32 v27, v27, v43
    v_add_f32 v28, v28, v44
    v_add_f32 v29, v29, v45
    v_add_f32 v30, v30, v46
    v_add_f32 v31, v31, v47
    v_add_f32 v16, v16, v24
    v_add_f32 v17, v17, v25
    v_add_f32 v18, v18, v26
    v_add_f32 v19, v19, v27
    v_add_f32 v20, v20, v28
    v_add_f32 v21, v21, v29
    v_add_f32 v22, v22, v30
    v_add_f32 v23, v23, v31
    v_add_f32 v16, v16, v20
    v_add_f32 v17, v17, v21
    v_add_f32 v18, v18, v22
    v_add_f32 v19, v19, v23
    v_add_u32 v10, 135168, v3
    ds_write_b128 v10, v[16:19]
    s_waitcnt lgkmcnt(0)
    buffer_load_dwordx2 v[16:17], v12, s[8:11], s44 offen offset:0
    buffer_load_dwordx2 v[18:19], v12, s[8:11], s44 offen offset:256
    buffer_load_dwordx2 v[20:21], v12, s[8:11], s44 offen offset:512
    buffer_load_dwordx2 v[22:23], v12, s[8:11], s44 offen offset:768
    buffer_load_dwordx2 v[24:25], v12, s[8:11], s44 offen offset:1024
    buffer_load_dwordx2 v[26:27], v12, s[8:11], s44 offen offset:1280
    buffer_load_dwordx2 v[28:29], v12, s[8:11], s44 offen offset:1536
    buffer_load_dwordx2 v[30:31], v12, s[8:11], s44 offen offset:1792
    buffer_load_dwordx2 v[32:33], v12, s[8:11], s44 offen offset:2048
    buffer_load_dwordx2 v[34:35], v12, s[8:11], s44 offen offset:2304
    buffer_load_dwordx2 v[36:37], v12, s[8:11], s44 offen offset:2560
    buffer_load_dwordx2 v[38:39], v12, s[8:11], s44 offen offset:2816
    buffer_load_dwordx2 v[40:41], v12, s[8:11], s44 offen offset:3072
    buffer_load_dwordx2 v[42:43], v12, s[8:11], s44 offen offset:3328
    buffer_load_dwordx2 v[44:45], v12, s[8:11], s44 offen offset:3584
    buffer_load_dwordx2 v[46:47], v12, s[8:11], s44 offen offset:3840
    s_waitcnt vmcnt(24)
    v_add_f32 v48, v48, v64
    v_add_f32 v49, v49, v65
    v_add_f32 v50, v50, v66
    v_add_f32 v51, v51, v67
    v_add_f32 v52, v52, v68
    v_add_f32 v53, v53, v69
    v_add_f32 v54, v54, v70
    v_add_f32 v55, v55, v71
    v_add_f32 v56, v56, v72
    v_add_f32 v57, v57, v73
    v_add_f32 v58, v58, v74
    v_add_f32 v59, v59, v75
    v_add_f32 v60, v60, v76
    v_add_f32 v61, v61, v77
    v_add_f32 v62, v62, v78
    v_add_f32 v63, v63, v79
    v_add_f32 v48, v48, v56
    v_add_f32 v49, v49, v57
    v_add_f32 v50, v50, v58
    v_add_f32 v51, v51, v59
    v_add_f32 v52, v52, v60
    v_add_f32 v53, v53, v61
    v_add_f32 v54, v54, v62
    v_add_f32 v55, v55, v63
    v_add_f32 v48, v48, v52
    v_add_f32 v49, v49, v53
    v_add_f32 v50, v50, v54
    v_add_f32 v51, v51, v55
    v_add_f32 v48, v48, v50
    v_add_f32 v49, v49, v51
    v_mov_b32 v50, v48
    v_mov_b32 v51, v49
    s_nop 1
    v_permlane32_swap_b32 v48, v50
    v_permlane32_swap_b32 v49, v51
    v_add_f32 v48, v48, v50
    v_add_f32 v49, v49, v51
    v_mul_f32 v48, 0xbb000000, v48
    v_mul_f32 v49, 0x3b000000, v49
    v_fma_f32 v49, -v48, v48, v49
    v_max_f32 v49, 0, v49
    v_add_f32 v49, 0x3727c5ac, v49
    v_rcp_f32 v50, v49
    v_mov_b32 v49, v48
    v_mov_b32 v51, v50
    ds_write_b128 v8, v[48:51] offset:3072
    s_waitcnt lgkmcnt(0)
    s_waitcnt vmcnt(0)
    v_add_f32 v16, v16, v32
    v_add_f32 v17, v17, v33
    v_add_f32 v18, v18, v34
    v_add_f32 v19, v19, v35
    v_add_f32 v20, v20, v36
    v_add_f32 v21, v21, v37
    v_add_f32 v22, v22, v38
    v_add_f32 v23, v23, v39
    v_add_f32 v24, v24, v40
    v_add_f32 v25, v25, v41
    v_add_f32 v26, v26, v42
    v_add_f32 v27, v27, v43
    v_add_f32 v28, v28, v44
    v_add_f32 v29, v29, v45
    v_add_f32 v30, v30, v46
    v_add_f32 v31, v31, v47
    v_add_f32 v16, v16, v24
    v_add_f32 v17, v17, v25
    v_add_f32 v18, v18, v26
    v_add_f32 v19, v19, v27
    v_add_f32 v20, v20, v28
    v_add_f32 v21, v21, v29
    v_add_f32 v22, v22, v30
    v_add_f32 v23, v23, v31
    v_add_f32 v16, v16, v20
    v_add_f32 v17, v17, v21
    v_add_f32 v18, v18, v22
    v_add_f32 v19, v19, v23
    v_add_f32 v16, v16, v18
    v_add_f32 v17, v17, v19
    v_mov_b32 v18, v16
    v_mov_b32 v19, v17
    s_nop 1
    v_permlane32_swap_b32 v16, v18
    v_permlane32_swap_b32 v17, v19
    v_add_f32 v16, v16, v18
    v_add_f32 v17, v17, v19
    v_mul_f32 v16, 0xbb000000, v16
    v_mul_f32 v17, 0x3b000000, v17
    v_fma_f32 v17, -v16, v16, v17
    v_max_f32 v17, 0, v17
    v_add_f32 v17, 0x3727c5ac, v17
    v_rcp_f32 v18, v17
    v_mov_b32 v17, v16
    v_mov_b32 v19, v18
    ds_write_b128 v8, v[16:19] offset:2048
    s_waitcnt lgkmcnt(0)
    buffer_load_dwordx4 v[176:179], v15, s[8:11], s41 offen offset:2048
    buffer_load_dwordx4 v[180:183], v9, s[8:11], s41 offen offset:2048
    buffer_load_dwordx4 v[184:187], v15, s[8:11], s41 offen offset:3072
    buffer_load_dwordx4 v[188:191], v9, s[8:11], s41 offen offset:3072
    buffer_load_dwordx4 v[192:195], v15, s[8:11], s42 offen offset:0
    buffer_load_dwordx4 v[196:199], v9, s[8:11], s42 offen offset:0
    buffer_load_dwordx4 v[200:203], v15, s[8:11], s42 offen offset:1024
    buffer_load_dwordx4 v[204:207], v9, s[8:11], s42 offen offset:1024
    buffer_load_dwordx4 v[208:211], v15, s[8:11], s42 offen offset:2048
    buffer_load_dwordx4 v[212:215], v9, s[8:11], s42 offen offset:2048
    s_barrier
    buffer_load_dwordx4 v[216:219], v15, s[8:11], s42 offen offset:3072
    buffer_load_dwordx4 v[220:223], v9, s[8:11], s42 offen offset:3072
    buffer_load_dwordx4 v[224:227], v15, s[8:11], s43 offen offset:0
    buffer_load_dwordx4 v[228:231], v9, s[8:11], s43 offen offset:0
    buffer_load_dwordx4 v[232:235], v15, s[8:11], s43 offen offset:1024
    buffer_load_dwordx4 v[236:239], v9, s[8:11], s43 offen offset:1024
    s_barrier
    s_cmp_lg_u32 s20, 7
    s_cbranch_scc1 l1_p791
    s_lshl_b32 s30, s21, 8
    s_add_u32 s30, s30, 24764416
    s_lshl_b32 s31, s22, 2
    s_add_u32 s30, s30, s31
    s_mov_b64 exec, 1
    buffer_store_dword v4, v0, s[8:11], s30 offen
    buffer_store_dword v4, v0, s[8:11], s30 offen offset:128 sc0 sc1
    s_mov_b64 exec, -1
l1_p791:
    s_lshl_b32 s30, s20, 1
    s_lshl_b32 s32, 3, s30
    s_lshl_b32 s35, s21, 8
    s_add_u32 s35, s35, 24764416
    s_mov_b64 exec, s[32:33]
    buffer_load_dword v2, v0, s[8:11], s35 offen sc1
    s_mov_b64 exec, -1
    s_waitcnt vmcnt(0)
    s_mov_b64 exec, s[32:33]
    s_mov_b32 s31, 0
l1_qa92:
    v_cmp_ne_u32 vcc, 0, v2
    s_cmp_eq_u64 vcc, s[32:33]
    s_cbranch_scc1 l1_qd94
    buffer_load_dword v2, v0, s[8:11], s35 offen sc1
    s_add_u32 s31, s31, 1
    s_waitcnt vmcnt(0)
    s_cmp_lt_u32 s31, 64
    s_cbranch_scc1 l1_qa92
l1_qb93:
    buffer_load_dword v2, v0, s[8:11], s35 offen sc1
    s_waitcnt vmcnt(0)
    v_cmp_ne_u32 s[36:37], 0, v2
    buffer_load_dword v2, v0, s[8:11], s35 offen offset:128 sc0 sc1
    s_waitcnt vmcnt(0)
    v_cmp_ne_u32 vcc, 0, v2
    s_add_u32 s31, s31, 1
    s_or_b64 vcc, vcc, s[36:37]
    s_cmp_eq_u64 vcc, s[32:33]
    s_cbranch_scc1 l1_qd94
    s_sleep 4
    s_cmp_lt_u32 s31, 1048576
    s_cbranch_scc1 l1_qb93
    s_branch k_end
l1_qd94:
    s_mov_b64 exec, -1
    buffer_load_dwordx4 v[24:27], v5, s[8:11], 0 offen offset:0
    buffer_load_dwordx4 v[28:31], v5, s[8:11], 0 offen offset:1024
    buffer_load_dwordx4 v[32:35], v5, s[8:11], 0 offen offset:2048
    buffer_load_dwordx4 v[36:39], v5, s[8:11], 0 offen offset:3072
    buffer_load_dwordx4 v[40:43], v5, s[8:11], s41 offen offset:0
    buffer_load_dwordx4 v[44:47], v5, s[8:11], s41 offen offset:1024
l1_ge85:
    s_add_u32 s31, s49, 30826496
    buffer_load_dwordx4 v[252:255], v3, s[8:11], s31 offen
    s_lshl_b32 s30, s20, 11
    v_add_u32 v8, s30, v3
    v_add_u32 v7, 0x10000, v8
    s_and_b32 s31, s20, 6
    s_xor_b32 s30, s31, 0
    s_lshl_b32 s30, s30, 11
    s_lshl_b32 s34, s20, 14
    s_add_u32 s30, s30, s34
    v_add_u32 v9, s30, v3
    s_xor_b32 s30, s31, 2
    s_lshl_b32 s30, s30, 11
    s_lshl_b32 s34, s20, 14
    s_add_u32 s30, s30, s34
    v_add_u32 v10, s30, v3
    s_xor_b32 s30, s31, 4
    s_lshl_b32 s30, s30, 11
    s_lshl_b32 s34, s20, 14
    s_add_u32 s30, s30, s34
    v_add_u32 v11, s30, v3
    s_xor_b32 s30, s31, 6
    s_lshl_b32 s30, s30, 11
    s_lshl_b32 s34, s20, 14
    s_add_u32 s30, s30, s34
    v_add_u32 v12, s30, v3
    s_waitcnt vmcnt(6)
    v_mfma_f32_32x32x16_bf16 v[48:63], v[128:131], v[24:27], 0
    v_mfma_f32_32x32x16_bf16 v[64:79], v[132:135], v[24:27], 0
    s_barrier
    s_cmp_lg_u32 s20, 7
    s_cbranch_scc1 l1_p795
    s_lshl_b32 s30, s21, 8
    s_add_u32 s30, s30, 24752128
    s_lshl_b32 s31, s22, 2
    s_add_u32 s30, s30, s31
    s_mov_b64 exec, 1
    buffer_store_dword v4, v0, s[8:11], s30 offen
    buffer_store_dword v4, v0, s[8:11], s30 offen offset:128 sc0 sc1
    s_mov_b64 exec, -1
l1_p795:
    buffer_load_dwordx4 v[80:83], v5, s[8:11], s41 offen offset:2048
    s_waitcnt vmcnt(6)
    v_mfma_f32_32x32x16_bf16 v[48:63], v[136:139], v[28:31], v[48:63]
    v_mfma_f32_32x32x16_bf16 v[64:79], v[140:143], v[28:31], v[64:79]
    buffer_load_dwordx4 v[84:87], v5, s[8:11], s41 offen offset:3072
    s_waitcnt vmcnt(6)
    v_mfma_f32_32x32x16_bf16 v[48:63], v[144:147], v[32:35], v[48:63]
    v_mfma_f32_32x32x16_bf16 v[64:79], v[148:151], v[32:35], v[64:79]
    buffer_load_dwordx4 v[88:91], v5, s[8:11], s42 offen offset:0
    s_waitcnt vmcnt(6)
    v_mfma_f32_32x32x16_bf16 v[48:63], v[152:155], v[36:39], v[48:63]
    v_mfma_f32_32x32x16_bf16 v[64:79], v[156:159], v[36:39], v[64:79]
    buffer_load_dwordx4 v[92:95], v5, s[8:11], s42 offen offset:1024
    s_waitcnt vmcnt(6)
    v_mfma_f32_32x32x16_bf16 v[48:63], v[160:163], v[40:43], v[48:63]
    v_mfma_f32_32x32x16_bf16 v[64:79], v[164:167], v[40:43], v[64:79]
    s_lshl_b32 s35, s21, 8
    s_add_u32 s35, s35, 24752128
    s_mov_b64 exec, s[32:33]
    buffer_load_dword v2, v0, s[8:11], s35 offen sc1
    s_mov_b64 exec, -1
    buffer_load_dwordx4 v[96:99], v5, s[8:11], s42 offen offset:2048
    s_waitcnt vmcnt(7)
    v_mfma_f32_32x32x16_bf16 v[48:63], v[168:171], v[44:47], v[48:63]
    v_mfma_f32_32x32x16_bf16 v[64:79], v[172:175], v[44:47], v[64:79]
    buffer_load_dwordx4 v[100:103], v5, s[8:11], s42 offen offset:3072
    s_waitcnt vmcnt(6)
    v_mfma_f32_32x32x16_bf16 v[48:63], v[176:179], v[80:83], v[48:63]
    v_mfma_f32_32x32x16_bf16 v[64:79], v[180:183], v[80:83], v[64:79]
    buffer_load_dwordx4 v[104:107], v5, s[8:11], s43 offen offset:0
    s_waitcnt vmcnt(6)
    v_mfma_f32_32x32x16_bf16 v[48:63], v[184:187], v[84:87], v[48:63]
    v_mfma_f32_32x32x16_bf16 v[64:79], v[188:191], v[84:87], v[64:79]
    buffer_load_dwordx4 v[108:111], v5, s[8:11], s43 offen offset:1024
    s_waitcnt vmcnt(6)
    v_mfma_f32_32x32x16_bf16 v[48:63], v[192:195], v[88:91], v[48:63]
    v_mfma_f32_32x32x16_bf16 v[64:79], v[196:199], v[88:91], v[64:79]
    s_waitcnt vmcnt(4)
    s_mov_b64 exec, s[32:33]
    s_mov_b32 s31, 0
l1_qa96:
    v_cmp_ne_u32 vcc, 0, v2
    s_cmp_eq_u64 vcc, s[32:33]
    s_cbranch_scc1 l1_qd98
    buffer_load_dword v2, v0, s[8:11], s35 offen sc1
    s_add_u32 s31, s31, 1
    s_waitcnt vmcnt(0)
    s_cmp_lt_u32 s31, 64
    s_cbranch_scc1 l1_qa96
l1_qb97:
    buffer_load_dword v2, v0, s[8:11], s35 offen sc1
    s_waitcnt vmcnt(0)
    v_cmp_ne_u32 s[36:37], 0, v2
    buffer_load_dword v2, v0, s[8:11], s35 offen offset:128 sc0 sc1
    s_waitcnt vmcnt(0)
    v_cmp_ne_u32 vcc, 0, v2
    s_add_u32 s31, s31, 1
    s_or_b64 vcc, vcc, s[36:37]
    s_cmp_eq_u64 vcc, s[32:33]
    s_cbranch_scc1 l1_qd98
    s_sleep 4
    s_cmp_lt_u32 s31, 1048576
    s_cbranch_scc1 l1_qb97
    s_branch k_end
l1_qd98:
    s_mov_b64 exec, -1
    buffer_load_dwordx4 v[112:115], v6, s[8:11], 0 offen offset:0
    v_mfma_f32_32x32x16_bf16 v[48:63], v[200:203], v[92:95], v[48:63]
    v_mfma_f32_32x32x16_bf16 v[64:79], v[204:207], v[92:95], v[64:79]
    buffer_load_dwordx4 v[116:119], v6, s[8:11], 0 offen offset:1024
    s_waitcnt vmcnt(5)
    v_mfma_f32_32x32x16_bf16 v[48:63], v[208:211], v[96:99], v[48:63]
    v_mfma_f32_32x32x16_bf16 v[64:79], v[212:215], v[96:99], v[64:79]
    buffer_load_dwordx4 v[120:123], v6, s[8:11], 0 offen offset:2048
    s_waitcnt vmcnt(5)
    v_mfma_f32_32x32x16_bf16 v[48:63], v[216:219], v[100:103], v[48:63]
    v_mfma_f32_32x32x16_bf16 v[64:79], v[220:223], v[100:103], v[64:79]
    buffer_load_dwordx4 v[124:127], v6, s[8:11], 0 offen offset:3072
    s_waitcnt vmcnt(5)
    v_mfma_f32_32x32x16_bf16 v[48:63], v[224:227], v[104:107], v[48:63]
    v_mfma_f32_32x32x16_bf16 v[64:79], v[228:231], v[104:107], v[64:79]
    buffer_load_dwordx4 v[80:83], v6, s[8:11], s41 offen offset:0
    s_waitcnt vmcnt(5)
    v_mfma_f32_32x32x16_bf16 v[48:63], v[232:235], v[108:111], v[48:63]
    v_mfma_f32_32x32x16_bf16 v[64:79], v[236:239], v[108:111], v[64:79]
    buffer_load_dwordx4 v[84:87], v6, s[8:11], s41 offen offset:1024
    s_waitcnt vmcnt(5)
    v_mfma_f32_32x32x16_bf16 v[16:31], v[128:131], v[112:115], 0
    v_mfma_f32_32x32x16_bf16 v[32:47], v[132:135], v[112:115], 0
    buffer_load_dwordx4 v[88:91], v6, s[8:11], s41 offen offset:2048
    s_waitcnt vmcnt(5)
    v_mfma_f32_32x32x16_bf16 v[16:31], v[136:139], v[116:119], v[16:31]
    v_mfma_f32_32x32x16_bf16 v[32:47], v[140:143], v[116:119], v[32:47]
    buffer_load_dwordx4 v[92:95], v6, s[8:11], s41 offen offset:3072
    s_waitcnt vmcnt(5)
    v_mfma_f32_32x32x16_bf16 v[16:31], v[144:147], v[120:123], v[16:31]
    v_mfma_f32_32x32x16_bf16 v[32:47], v[148:151], v[120:123], v[32:47]
    buffer_load_dwordx4 v[96:99], v6, s[8:11], s42 offen offset:0
    s_nop 2
    s_waitcnt vmcnt(5)
    v_mfma_f32_32x32x16_bf16 v[16:31], v[152:155], v[124:127], v[16:31]
    ds_write_b128 v9, v[48:51] offset:0
    v_mfma_f32_32x32x16_bf16 v[32:47], v[156:159], v[124:127], v[32:47]
    ds_write_b128 v9, v[52:55] offset:1024
    buffer_load_dwordx4 v[100:103], v6, s[8:11], s42 offen offset:1024
    s_waitcnt vmcnt(5)
    v_mfma_f32_32x32x16_bf16 v[16:31], v[160:163], v[80:83], v[16:31]
    ds_write_b128 v11, v[56:59] offset:0
    v_mfma_f32_32x32x16_bf16 v[32:47], v[164:167], v[80:83], v[32:47]
    ds_write_b128 v11, v[60:63] offset:1024
    buffer_load_dwordx4 v[104:107], v6, s[8:11], s42 offen offset:2048
    s_waitcnt vmcnt(5)
    v_mfma_f32_32x32x16_bf16 v[16:31], v[168:171], v[84:87], v[16:31]
    ds_write_b128 v10, v[64:67] offset:0
    v_mfma_f32_32x32x16_bf16 v[32:47], v[172:175], v[84:87], v[32:47]
    ds_write_b128 v10, v[68:71] offset:1024
    buffer_load_dwordx4 v[108:111], v6, s[8:11], s42 offen offset:3072
    s_waitcnt vmcnt(5)
    v_mfma_f32_32x32x16_bf16 v[16:31], v[176:179], v[88:91], v[16:31]
    ds_write_b128 v12, v[72:75] offset:0
    v_mfma_f32_32x32x16_bf16 v[32:47], v[180:183], v[88:91], v[32:47]
    ds_write_b128 v12, v[76:79] offset:1024
    buffer_load_dwordx4 v[112:115], v6, s[8:11], s43 offen offset:0
    s_waitcnt vmcnt(5)
    v_mfma_f32_32x32x16_bf16 v[16:31], v[184:187], v[92:95], v[16:31]
    v_mfma_f32_32x32x16_bf16 v[32:47], v[188:191], v[92:95], v[32:47]
    buffer_load_dwordx4 v[116:119], v6, s[8:11], s43 offen offset:1024
    s_waitcnt vmcnt(5)
    v_mfma_f32_32x32x16_bf16 v[16:31], v[192:195], v[96:99], v[16:31]
    v_mfma_f32_32x32x16_bf16 v[32:47], v[196:199], v[96:99], v[32:47]
    s_waitcnt vmcnt(4)
    v_mfma_f32_32x32x16_bf16 v[16:31], v[200:203], v[100:103], v[16:31]
    v_mfma_f32_32x32x16_bf16 v[32:47], v[204:207], v[100:103], v[32:47]
    s_waitcnt vmcnt(3)
    v_mfma_f32_32x32x16_bf16 v[16:31], v[208:211], v[104:107], v[16:31]
    v_mfma_f32_32x32x16_bf16 v[32:47], v[212:215], v[104:107], v[32:47]
    s_waitcnt vmcnt(2)
    v_mfma_f32_32x32x16_bf16 v[16:31], v[216:219], v[108:111], v[16:31]
    v_mfma_f32_32x32x16_bf16 v[32:47], v[220:223], v[108:111], v[32:47]
    s_waitcnt vmcnt(1)
    v_mfma_f32_32x32x16_bf16 v[16:31], v[224:227], v[112:115], v[16:31]
    v_mfma_f32_32x32x16_bf16 v[32:47], v[228:231], v[112:115], v[32:47]
    s_waitcnt vmcnt(0)
    v_mfma_f32_32x32x16_bf16 v[16:31], v[232:235], v[116:119], v[16:31]
    v_mfma_f32_32x32x16_bf16 v[32:47], v[236:239], v[116:119], v[32:47]
    v_lshlrev_b32 v80, 16, v252
    v_and_b32 v81, 0xffff0000, v252
    v_lshlrev_b32 v82, 16, v253
    v_and_b32 v83, 0xffff0000, v253
    v_lshlrev_b32 v84, 16, v254
    v_and_b32 v85, 0xffff0000, v254
    v_lshlrev_b32 v86, 16, v255
    v_and_b32 v87, 0xffff0000, v255
    s_nop 2
    ds_write_b128 v9, v[16:19] offset:2048
    ds_write_b128 v9, v[20:23] offset:3072
    ds_write_b128 v11, v[24:27] offset:2048
    ds_write_b128 v11, v[28:31] offset:3072
    ds_write_b128 v10, v[32:35] offset:2048
    ds_write_b128 v10, v[36:39] offset:3072
    ds_write_b128 v12, v[40:43] offset:2048
    ds_write_b128 v12, v[44:47] offset:3072
    s_waitcnt lgkmcnt(0)
    s_barrier
    ds_read_b128 v[16:19], v8 offset:0
    ds_read_b128 v[20:23], v8 offset:1024
    ds_read_b128 v[24:27], v8 offset:16384
    ds_read_b128 v[28:31], v8 offset:17408
    ds_read_b128 v[32:35], v8 offset:32768
    ds_read_b128 v[36:39], v8 offset:33792
    ds_read_b128 v[40:43], v8 offset:49152
    ds_read_b128 v[44:47], v8 offset:50176
    ds_read_b128 v[48:51], v7 offset:0
    ds_read_b128 v[52:55], v7 offset:1024
    ds_read_b128 v[56:59], v7 offset:16384
    ds_read_b128 v[60:63], v7 offset:17408
    ds_read_b128 v[64:67], v7 offset:32768
    ds_read_b128 v[68:71], v7 offset:33792
    s_waitcnt lgkmcnt(10)
    v_add_f32 v16, v16, v80
    v_add_f32 v17, v17, v81
    v_add_f32 v18, v18, v82
    v_add_f32 v19, v19, v83
    v_add_f32 v20, v20, v84
    v_add_f32 v21, v21, v85
    v_add_f32 v22, v22, v86
    v_add_f32 v23, v23, v87
    ds_read_b128 v[72:75], v7 offset:49152
    ds_read_b128 v[76:79], v7 offset:50176
    s_waitcnt lgkmcnt(0)
    v_add_f32 v16, v16, v48
    v_add_f32 v17, v17, v49
    v_add_f32 v18, v18, v50
    v_add_f32 v19, v19, v51
    v_add_f32 v20, v20, v52
    v_add_f32 v21, v21, v53
    v_add_f32 v22, v22, v54
    v_add_f32 v23, v23, v55
    v_add_f32 v24, v24, v56
    v_add_f32 v25, v25, v57
    v_add_f32 v26, v26, v58
    v_add_f32 v27, v27, v59
    v_add_f32 v28, v28, v60
    v_add_f32 v29, v29, v61
    v_add_f32 v30, v30, v62
    v_add_f32 v31, v31, v63
    v_add_f32 v32, v32, v64
    v_add_f32 v33, v33, v65
    v_add_f32 v34, v34, v66
    v_add_f32 v35, v35, v67
    v_add_f32 v36, v36, v68
    v_add_f32 v37, v37, v69
    v_add_f32 v38, v38, v70
    v_add_f32 v39, v39, v71
    v_add_f32 v40, v40, v72
    v_add_f32 v41, v41, v73
    v_add_f32 v42, v42, v74
    v_add_f32 v43, v43, v75
    v_add_f32 v44, v44, v76
    v_add_f32 v45, v45, v77
    v_add_f32 v46, v46, v78
    v_add_f32 v47, v47, v79
    v_add_f32 v16, v16, v32
    v_add_f32 v17, v17, v33
    v_add_f32 v18, v18, v34
    v_add_f32 v19, v19, v35
    v_add_f32 v20, v20, v36
    v_add_f32 v21, v21, v37
    v_add_f32 v22, v22, v38
    v_add_f32 v23, v23, v39
    v_add_f32 v24, v24, v40
    v_add_f32 v25, v25, v41
    v_add_f32 v26, v26, v42
    v_add_f32 v27, v27, v43
    v_add_f32 v28, v28, v44
    v_add_f32 v29, v29, v45
    v_add_f32 v30, v30, v46
    v_add_f32 v31, v31, v47
    v_add_f32 v16, v16, v24
    v_add_f32 v17, v17, v25
    v_add_f32 v18, v18, v26
    v_add_f32 v19, v19, v27
    v_add_f32 v20, v20, v28
    v_add_f32 v21, v21, v29
    v_add_f32 v22, v22, v30
    v_add_f32 v23, v23, v31
    v_cvt_pk_bf16_f32 v24, v16, v17
    v_cvt_pk_bf16_f32 v25, v18, v19
    v_cvt_pk_bf16_f32 v26, v20, v21
    v_cvt_pk_bf16_f32 v27, v22, v23
    v_and_b32 v4, 31, v1
    v_lshlrev_b32 v4, 10, v4
    v_lshrrev_b32 v5, 5, v1
    v_lshl_add_u32 v4, v5, 4, v4
    s_and_b32 s30, s49, 0xffff8000
    s_and_b32 s31, s49, 0x7fff
    s_lshr_b32 s31, s31, 5
    s_add_u32 s30, s30, s31
    v_permlane32_swap_b32 v24, v26
    v_permlane32_swap_b32 v25, v27
    buffer_store_dwordx4 v[24:27], v4, s[12:15], s30 offen
    s_add_u32 s30, s2, s20
    s_cmp_lg_u32 s30, 0
    s_cbranch_scc1 k_fin
    s_load_dwordx2 s[4:5], s[0:1], 80
    s_mov_b32 s6, 256
    v_mov_b32 v2, 0
    s_mov_b64 exec, 1
    s_waitcnt lgkmcnt(0)
    buffer_store_dword v2, v2, s[4:7], 0 offen sc0 sc1
    s_mov_b64 exec, -1
k_fin:
k_end:
    s_endpgm
l0_slow:
    v_subrev_u32 v104, 136192, v104
    v_subrev_u32 v105, 136192, v105
    v_subrev_u32 v111, 136192, v111
    v_mov_b32 v56, 0
    v_mov_b32 v57, 0
    v_mov_b32 v58, 0
    v_mov_b32 v59, 0
    v_mov_b32 v60, 0
    v_mov_b32 v61, 0
    v_mov_b32 v62, 0
    v_mov_b32 v63, 0
    v_mov_b32 v64, 0
    v_mov_b32 v65, 0
    v_mov_b32 v66, 0
    v_mov_b32 v67, 0
    v_mov_b32 v68, 0
    v_mov_b32 v69, 0
    v_mov_b32 v70, 0
    v_mov_b32 v71, 0
    v_sub_f32 v110, 0, v8
l0_sloop:
    ds_read_b128 v[80:83], v104 offset:0
    ds_read_b128 v[88:91], v105 offset:0
    ds_read_b128 v[92:95], v111 offset:0
    s_waitcnt lgkmcnt(0)
    v_mfma_f32_32x32x16_bf16 v[24:39], v[80:83], v[124:127], 0
    s_nop 11
    v_max3_f32 v106, v24, v25, v26
    v_max3_f32 v106, v106, v27, v28
    v_max3_f32 v106, v106, v29, v30
    v_max3_f32 v106, v106, v31, v32
    v_max3_f32 v106, v106, v33, v34
    v_max3_f32 v106, v106, v35, v36
    v_max3_f32 v106, v106, v37, v38
    v_max3_f32 v106, v106, v39, v110
    v_mov_b32 v107, v106
    s_nop 1
    v_permlane32_swap_b32 v106, v107
    v_max_f32 v106, v106, v107
    v_sub_f32 v107, v110, v106
    v_exp_f32 v107, v107
    v_mov_b32 v110, v106
    v_sub_f32 v24, v24, v106
    v_sub_f32 v25, v25, v106
    v_sub_f32 v26, v26, v106
    v_sub_f32 v27, v27, v106
    v_sub_f32 v28, v28, v106
    v_sub_f32 v29, v29, v106
    v_sub_f32 v30, v30, v106
    v_sub_f32 v31, v31, v106
    v_sub_f32 v32, v32, v106
    v_sub_f32 v33, v33, v106
    v_sub_f32 v34, v34, v106
    v_sub_f32 v35, v35, v106
    v_sub_f32 v36, v36, v106
    v_sub_f32 v37, v37, v106
    v_sub_f32 v38, v38, v106
    v_sub_f32 v39, v39, v106
    v_exp_f32 v24, v24
    v_exp_f32 v25, v25
    v_exp_f32 v26, v26
    v_exp_f32 v27, v27
    v_exp_f32 v28, v28
    v_exp_f32 v29, v29
    v_exp_f32 v30, v30
    v_exp_f32 v31, v31
    v_exp_f32 v32, v32
    v_exp_f32 v33, v33
    v_exp_f32 v34, v34
    v_exp_f32 v35, v35
    v_exp_f32 v36, v36
    v_exp_f32 v37, v37
    v_exp_f32 v38, v38
    v_exp_f32 v39, v39
    v_mul_f32 v56, v107, v56
    v_mul_f32 v57, v107, v57
    v_mul_f32 v58, v107, v58
    v_mul_f32 v59, v107, v59
    v_mul_f32 v60, v107, v60
    v_mul_f32 v61, v107, v61
    v_mul_f32 v62, v107, v62
    v_mul_f32 v63, v107, v63
    v_mul_f32 v64, v107, v64
    v_mul_f32 v65, v107, v65
    v_mul_f32 v66, v107, v66
    v_mul_f32 v67, v107, v67
    v_mul_f32 v68, v107, v68
    v_mul_f32 v69, v107, v69
    v_mul_f32 v70, v107, v70
    v_mul_f32 v71, v107, v71
    v_cvt_pk_bf16_f32 v72, v24, v25
    v_cvt_pk_bf16_f32 v73, v26, v27
    v_cvt_pk_bf16_f32 v74, v28, v29
    v_cvt_pk_bf16_f32 v75, v30, v31
    v_cvt_pk_bf16_f32 v76, v32, v33
    v_cvt_pk_bf16_f32 v77, v34, v35
    v_cvt_pk_bf16_f32 v78, v36, v37
    v_cvt_pk_bf16_f32 v79, v38, v39
    s_nop 1
    v_mfma_f32_32x32x16_bf16 v[56:71], v[88:91], v[72:75], v[56:71]
    v_mfma_f32_32x32x16_bf16 v[56:71], v[92:95], v[76:79], v[56:71]
    v_add_u32 v104, 2128, v104
    v_add_u32 v105, 2128, v105
    v_add_u32 v111, 2128, v111
    s_nop 11
    s_add_u32 s39, s39, 1
    s_cmp_lt_u32 s39, 64
    s_cbranch_scc1 l0_sloop
    s_mov_b32 s39, 99
    s_branch l0_fin
l1_slow:
    v_subrev_u32 v104, 136192, v104
    v_subrev_u32 v105, 136192, v105
    v_subrev_u32 v111, 136192, v111
    v_mov_b32 v56, 0
    v_mov_b32 v57, 0
    v_mov_b32 v58, 0
    v_mov_b32 v59, 0
    v_mov_b32 v60, 0
    v_mov_b32 v61, 0
    v_mov_b32 v62, 0
    v_mov_b32 v63, 0
    v_mov_b32 v64, 0
    v_mov_b32 v65, 0
    v_mov_b32 v66, 0
    v_mov_b32 v67, 0
    v_mov_b32 v68, 0
    v_mov_b32 v69, 0
    v_mov_b32 v70, 0
    v_mov_b32 v71, 0
    v_sub_f32 v110, 0, v8
l1_sloop:
    ds_read_b128 v[80:83], v104 offset:0
    ds_read_b128 v[88:91], v105 offset:0
    ds_read_b128 v[92:95], v111 offset:0
    s_waitcnt lgkmcnt(0)
    v_mfma_f32_32x32x16_bf16 v[24:39], v[80:83], v[124:127], 0
    s_nop 11
    v_max3_f32 v106, v24, v25, v26
    v_max3_f32 v106, v106, v27, v28
    v_max3_f32 v106, v106, v29, v30
    v_max3_f32 v106, v106, v31, v32
    v_max3_f32 v106, v106, v33, v34
    v_max3_f32 v106, v106, v35, v36
    v_max3_f32 v106, v106, v37, v38
    v_max3_f32 v106, v106, v39, v110
    v_mov_b32 v107, v106
    s_nop 1
    v_permlane32_swap_b32 v106, v107
    v_max_f32 v106, v106, v107
    v_sub_f32 v107, v110, v106
    v_exp_f32 v107, v107
    v_mov_b32 v110, v106
    v_sub_f32 v24, v24, v106
    v_sub_f32 v25, v25, v106
    v_sub_f32 v26, v26, v106
    v_sub_f32 v27, v27, v106
    v_sub_f32 v28, v28, v106
    v_sub_f32 v29, v29, v106
    v_sub_f32 v30, v30, v106
    v_sub_f32 v31, v31, v106
    v_sub_f32 v32, v32, v106
    v_sub_f32 v33, v33, v106
    v_sub_f32 v34, v34, v106
    v_sub_f32 v35, v35, v106
    v_sub_f32 v36, v36, v106
    v_sub_f32 v37, v37, v106
    v_sub_f32 v38, v38, v106
    v_sub_f32 v39, v39, v106
    v_exp_f32 v24, v24
    v_exp_f32 v25, v25
    v_exp_f32 v26, v26
    v_exp_f32 v27, v27
    v_exp_f32 v28, v28
    v_exp_f32 v29, v29
    v_exp_f32 v30, v30
    v_exp_f32 v31, v31
    v_exp_f32 v32, v32
    v_exp_f32 v33, v33
    v_exp_f32 v34, v34
    v_exp_f32 v35, v35
    v_exp_f32 v36, v36
    v_exp_f32 v37, v37
    v_exp_f32 v38, v38
    v_exp_f32 v39, v39
    v_mul_f32 v56, v107, v56
    v_mul_f32 v57, v107, v57
    v_mul_f32 v58, v107, v58
    v_mul_f32 v59, v107, v59
    v_mul_f32 v60, v107, v60
    v_mul_f32 v61, v107, v61
    v_mul_f32 v62, v107, v62
    v_mul_f32 v63, v107, v63
    v_mul_f32 v64, v107, v64
    v_mul_f32 v65, v107, v65
    v_mul_f32 v66, v107, v66
    v_mul_f32 v67, v107, v67
    v_mul_f32 v68, v107, v68
    v_mul_f32 v69, v107, v69
    v_mul_f32 v70, v107, v70
    v_mul_f32 v71, v107, v71
    v_cvt_pk_bf16_f32 v72, v24, v25
    v_cvt_pk_bf16_f32 v73, v26, v27
    v_cvt_pk_bf16_f32 v74, v28, v29
    v_cvt_pk_bf16_f32 v75, v30, v31
    v_cvt_pk_bf16_f32 v76, v32, v33
    v_cvt_pk_bf16_f32 v77, v34, v35
    v_cvt_pk_bf16_f32 v78, v36, v37
    v_cvt_pk_bf16_f32 v79, v38, v39
    s_nop 1
    v_mfma_f32_32x32x16_bf16 v[56:71], v[88:91], v[72:75], v[56:71]
    v_mfma_f32_32x32x16_bf16 v[56:71], v[92:95], v[76:79], v[56:71]
    v_add_u32 v104, 2128, v104
    v_add_u32 v105, 2128, v105
    v_add_u32 v111, 2128, v111
    s_nop 11
    s_add_u32 s39, s39, 1
    s_cmp_lt_u32 s39, 64
    s_cbranch_scc1 l1_sloop
    s_mov_b32 s39, 99
    s_branch l1_fin
.section .rodata,"a"
.p2align 6
.amdhsa_kernel interleave_layers__grouped_kv_mqa__glu_gated_bilinear__prompt_kernel
  .amdhsa_next_free_vgpr 256
  .amdhsa_next_free_sgpr 100
  .amdhsa_accum_offset 256
  .amdhsa_group_segment_fixed_size 0
  .amdhsa_kernarg_size 96
  .amdhsa_user_sgpr_count 2
  .amdhsa_user_sgpr_kernarg_segment_ptr 1
  .amdhsa_system_sgpr_workgroup_id_x 1
  .amdhsa_float_denorm_mode_32 3
  .amdhsa_float_denorm_mode_16_64 3
.end_amdhsa_kernel
```
